```python
import torch

def _softmax(x, axis=-1):
    return torch.softmax(x, dim=axis)
def _gelu(x):
    return torch.nn.functional.gelu(x, approximate="tanh")
def _silu(x):
    return torch.nn.functional.silu(x)
def _sigmoid(x):
    return torch.sigmoid(x)
def _layernorm(x, axis=-1, eps=1e-5):
    m = x.mean(dim=axis, keepdim=True)
    v = x.var(dim=axis, keepdim=True, unbiased=False)
    return (x - m) / torch.sqrt(v + eps)
def _scatter_add(tgt, idx, src, axis=0):
    return tgt.clone().index_add_(axis, idx, src)
def _segment_sum(src, seg, n):
    out = torch.zeros((n,) + src.shape[1:], dtype=src.dtype)
    return out.index_add_(0, seg, src)
def _pad(x, pw):
    flat = tuple(v for pair in reversed(pw) for v in pair)
    return torch.nn.functional.pad(x, flat)

kernel_name = 'standalone__mha_block_cached__near_ridge'

def setup_inputs():

    _w = (lambda a: (lambda t: t.to(torch.bfloat16) if t.is_floating_point() else t)(torch.as_tensor(a)))
    B, Sq, D = 16, 144, 448
    H, Sk, Dh = 16, 512, 256
    return {
        "x": _w((lambda *s: torch.randn(*s, dtype=torch.bfloat16) * 0.8)(B, Sq, D)),
        "k_cache": _w((lambda *s: torch.randn(*s, dtype=torch.bfloat16) * 0.8)(B, H, Sk, Dh)),
        "v_cache": _w((lambda *s: torch.randn(*s, dtype=torch.bfloat16) * 0.05)(B, H, Sk, Dh)),
        "wq": _w((lambda *s: torch.randn(*s, dtype=torch.bfloat16) * 0.8)(D, H * Dh) * (D ** -0.5)),
        "wo": _w((lambda *s: torch.randn(*s, dtype=torch.bfloat16) * 0.05)(H * Dh, D) * ((H * Dh) ** -0.5)),
    }

def reference(x, k_cache, v_cache, wq, wo):
    B, Sq, D = x.shape
    H, Dh = 16, 256
    q = (lambda x, *d: x.permute(*d))((x @ wq).reshape(B, Sq, H, Dh), 0, 2, 1, 3)
    scores = torch.einsum("bhqd,bhkd->bhqk", q, k_cache) * (Dh ** -0.5)
    p = _softmax(scores, axis=-1)
    o = torch.einsum("bhqk,bhkd->bhqd", p, v_cache)
    return (lambda x, *d: x.permute(*d))(o, 0, 2, 1, 3).reshape(B, Sq, H * Dh) @ wo
```

```asm
; @launch kernel=standalone__mha_block_cached__near_ridge_kernel grid=(256,1,1) block=(256,1,1) lds=160256
; @launch kernel=oproj_kernel grid=(256,1,1) block=(512,1,1) lds=131072
.amdgcn_target "amdgcn-amd-amdhsa--gfx950"
.text
.globl standalone__mha_block_cached__near_ridge_kernel
.p2align 8
.type standalone__mha_block_cached__near_ridge_kernel,@function
standalone__mha_block_cached__near_ridge_kernel:
    s_cmp_ge_u32 s2, 256
    s_cbranch_scc1 L_attn_end
    s_load_dwordx8 s[36:43], s[0:1], 0
    s_load_dwordx2 s[44:45], s[0:1], 56
    s_load_dwordx2 s[88:89], s[0:1], 32
    v_and_b32 v1, 63, v0
    v_and_b32 v2, 15, v0
    v_lshrrev_b32 v3, 4, v1
    v_lshrrev_b32 v27, 6, v0
    s_lshr_b32 s6, s2, 3
    s_and_b32 s7, s2, 7
    s_and_b32 s4, s7, 3
    s_lshl_b32 s4, s4, 2
    s_and_b32 s3, s6, 3
    s_add_u32 s4, s4, s3
    s_lshr_b32 s3, s7, 2
    s_lshl_b32 s3, s3, 3
    s_lshr_b32 s6, s6, 2
    s_add_u32 s3, s3, s6
    s_lshl_b32 s7, s3, 4
    s_add_u32 s7, s7, s4
    v_readfirstlane_b32 s5, v27
    s_mov_b32 s33, 0x3db8aa3b
    s_mov_b32 s34, 0x05040100
    s_mov_b32 s35, 0x07060302
    v_lshrrev_b32 v28, 1, v3
    v_xor_b32 v29, v3, v28
    v_and_b32 v29, 1, v29
    v_lshl_or_b32 v29, v29, 1, v28
    v_and_b32 v30, 3, v1
    v_xor_b32 v29, v29, v30
    v_lshrrev_b32 v30, 2, v1
    v_mul_u32_u24 v4, 896, v30
    v_lshl_add_u32 v4, v29, 4, v4
    v_lshl_add_u32 v4, v27, 6, v4
    v_lshrrev_b32 v30, 2, v2
    v_lshrrev_b32 v28, 1, v30
    v_xor_b32 v29, v30, v28
    v_and_b32 v29, 1, v29
    v_lshl_or_b32 v29, v29, 1, v28
    v_xor_b32 v29, v29, v3
    v_lshlrev_b32 v5, 6, v2
    v_lshl_add_u32 v5, v29, 4, v5
    v_add_u32 v6, 0x10000, v5
    v_and_b32 v28, 7, v2
    v_lshlrev_b32 v7, 4, v28
    v_lshl_add_u32 v7, v3, 16, v7
    v_lshrrev_b32 v28, 3, v2
    v_lshl_add_u32 v7, v28, 15, v7
    s_mov_b32 s82, 0xff00ff00
    s_mov_b32 s83, 0xff00ff00
    v_lshrrev_b32 v28, 1, v3
    v_xor_b32 v29, v3, v28
    v_and_b32 v29, 1, v29
    v_lshl_or_b32 v29, v29, 1, v28
    v_and_b32 v30, 3, v1
    v_xor_b32 v29, v29, v30
    v_lshrrev_b32 v30, 2, v1
    v_lshlrev_b32 v8, 9, v30
    v_lshl_add_u32 v8, v29, 4, v8
    v_lshlrev_b32 v0, 4, v1
    v_lshl_add_u32 v0, v27, 12, v0
    v_add_u32 v0, 73728, v0
    v_lshlrev_b32 v9, 3, v2
    v_lshl_add_u32 v9, v3, 12, v9
    v_xor_b32 v28, v3, v2
    v_lshlrev_b32 v28, 4, v28
    v_lshl_add_u32 v18, v2, 9, v28
    v_lshl_add_u32 v23, v2, 10, v28
    v_lshrrev_b32 v28, 1, v3
    v_xor_b32 v28, v28, v2
    v_lshlrev_b32 v28, 4, v28
    v_lshl_add_u32 v21, v2, 10, v28
    v_lshl_add_u32 v21, v27, 8, v21
    v_and_b32 v28, 1, v3
    v_lshl_add_u32 v21, v28, 3, v21
    s_lshl_b32 s28, s5, 10
    s_lshl_b32 s29, s4, 9
    s_lshl_b32 s6, s5, 7
    s_add_u32 s29, s29, s6
    s_lshl_b32 s30, s5, 16
    s_mov_b32 s31, s6
    s_mul_i32 s32, s3, 1179648
    s_lshl_b32 s6, s4, 13
    s_add_u32 s32, s32, s6
    s_lshl_b32 s6, s5, 11
    s_add_u32 s32, s32, s6
    s_add_u32 s48, s30, 0
    s_add_u32 s49, s30, 8192
    s_add_u32 s50, s30, 16384
    s_add_u32 s51, s30, 24576
    s_add_u32 s52, s30, 32768
    s_add_u32 s53, s30, 40960
    s_add_u32 s54, s30, 49152
    s_add_u32 s55, s30, 57344
    s_waitcnt lgkmcnt(0)
    s_mul_i32 s6, s3, 129024
    s_add_u32 s8, s36, s6
    s_addc_u32 s9, s37, 0
    s_mov_b32 s10, 129024
    s_mov_b32 s11, 0x20000
    s_mov_b32 s12, s42
    s_mov_b32 s13, s43
    s_mov_b32 s14, 3670016
    s_mov_b32 s15, 0x20000
    s_lshl_b32 s6, s7, 18
    s_add_u32 s16, s38, s6
    s_addc_u32 s17, s39, 0
    s_mov_b32 s18, 262144
    s_mov_b32 s19, 0x20000
    s_add_u32 s20, s40, s6
    s_addc_u32 s21, s41, 0
    s_mov_b32 s22, 262144
    s_mov_b32 s23, 0x20000
    s_mov_b32 s24, s44
    s_mov_b32 s25, s45
    s_mov_b32 s26, 18874368
    s_mov_b32 s27, 0x20000
    s_mov_b32 s90, 3670016
    s_mov_b32 s91, 0x20000
    s_add_u32 s84, s44, 33554432
    s_addc_u32 s85, s45, 0
    s_mov_b32 s86, 3670016
    s_mov_b32 s87, 0x20000
    s_cmp_ge_u32 s5, 2
    s_cbranch_scc1 L_skipdma
    s_add_u32 m0, s28, 12288
    s_mov_b32 s46, 768
    buffer_load_dwordx4 v4, s[8:11], s46 offen lds
    s_add_u32 m0, s28, 26624
    s_mov_b32 s46, 15104
    buffer_load_dwordx4 v4, s[8:11], s46 offen lds
    s_add_u32 m0, s28, 40960
    s_mov_b32 s46, 29440
    buffer_load_dwordx4 v4, s[8:11], s46 offen lds
    s_add_u32 m0, s28, 55296
    s_mov_b32 s46, 43776
    buffer_load_dwordx4 v4, s[8:11], s46 offen lds
    s_add_u32 m0, s28, 69632
    s_mov_b32 s46, 58112
    buffer_load_dwordx4 v4, s[8:11], s46 offen lds
    s_add_u32 m0, s28, 83968
    s_mov_b32 s46, 72448
    buffer_load_dwordx4 v4, s[8:11], s46 offen lds
    s_add_u32 m0, s28, 98304
    s_mov_b32 s46, 86784
    buffer_load_dwordx4 v4, s[8:11], s46 offen lds
    s_add_u32 m0, s28, 112640
    s_mov_b32 s46, 101120
    buffer_load_dwordx4 v4, s[8:11], s46 offen lds
    s_add_u32 m0, s28, 126976
    s_mov_b32 s46, 115456
    buffer_load_dwordx4 v4, s[8:11], s46 offen lds
L_skipdma:
    s_add_u32 m0, s28, 0
    s_mov_b32 s46, 0
    buffer_load_dwordx4 v4, s[8:11], s46 offen lds
    s_add_u32 m0, s28, 14336
    s_mov_b32 s46, 14336
    buffer_load_dwordx4 v4, s[8:11], s46 offen lds
    s_add_u32 m0, s28, 28672
    s_mov_b32 s46, 28672
    buffer_load_dwordx4 v4, s[8:11], s46 offen lds
    s_add_u32 m0, s28, 43008
    s_mov_b32 s46, 43008
    buffer_load_dwordx4 v4, s[8:11], s46 offen lds
    s_add_u32 m0, s28, 57344
    s_mov_b32 s46, 57344
    buffer_load_dwordx4 v4, s[8:11], s46 offen lds
    s_add_u32 m0, s28, 71680
    s_mov_b32 s46, 71680
    buffer_load_dwordx4 v4, s[8:11], s46 offen lds
    s_add_u32 m0, s28, 86016
    s_mov_b32 s46, 86016
    buffer_load_dwordx4 v4, s[8:11], s46 offen lds
    s_add_u32 m0, s28, 100352
    s_mov_b32 s46, 100352
    buffer_load_dwordx4 v4, s[8:11], s46 offen lds
    s_add_u32 m0, s28, 114688
    s_mov_b32 s46, 114688
    buffer_load_dwordx4 v4, s[8:11], s46 offen lds
    s_add_u32 s47, s29, 0
    buffer_load_dwordx4 v[32:35], v7, s[12:15], s47 offen
    s_add_u32 s58, s29, 8192
    buffer_load_dwordx4 v[36:39], v7, s[12:15], s58 offen
    s_add_u32 s59, s29, 16384
    buffer_load_dwordx4 v[40:43], v7, s[12:15], s59 offen
    s_add_u32 s46, s29, 24576
    buffer_load_dwordx4 v[44:47], v7, s[12:15], s46 offen
    s_add_u32 s47, s29, 262144
    buffer_load_dwordx4 v[48:51], v7, s[12:15], s47 offen
    s_add_u32 s58, s29, 270336
    buffer_load_dwordx4 v[52:55], v7, s[12:15], s58 offen
    s_add_u32 s59, s29, 278528
    buffer_load_dwordx4 v[56:59], v7, s[12:15], s59 offen
    s_add_u32 s46, s29, 286720
    buffer_load_dwordx4 v[60:63], v7, s[12:15], s46 offen
    s_add_u32 s47, s29, 524288
    buffer_load_dwordx4 v[64:67], v7, s[12:15], s47 offen
    s_add_u32 s58, s29, 532480
    buffer_load_dwordx4 v[68:71], v7, s[12:15], s58 offen
    s_add_u32 s59, s29, 540672
    buffer_load_dwordx4 v[72:75], v7, s[12:15], s59 offen
    s_add_u32 s46, s29, 548864
    buffer_load_dwordx4 v[76:79], v7, s[12:15], s46 offen
    buffer_load_dwordx4 v[128:131], v8, s[16:19], s52 offen nt
    buffer_load_dwordx4 v[132:135], v8, s[16:19], s52 offen offset:64 nt
    buffer_load_dwordx4 v[136:139], v8, s[16:19], s53 offen nt
    buffer_load_dwordx4 v[140:143], v8, s[16:19], s53 offen offset:64 nt
    buffer_load_dwordx4 v[144:147], v8, s[16:19], s54 offen nt
    buffer_load_dwordx4 v[148:151], v8, s[16:19], s54 offen offset:64 nt
    buffer_load_dwordx4 v[152:155], v8, s[16:19], s55 offen nt
    buffer_load_dwordx4 v[156:159], v8, s[16:19], s55 offen offset:64 nt
    s_waitcnt vmcnt(20)
    s_barrier
    ds_read_b128 v[176:179], v5
    ds_read_b128 v[180:183], v5 offset:14336
    ds_read_b128 v[184:187], v5 offset:28672
    ds_read_b128 v[188:191], v5 offset:43008
    ds_read_b128 v[192:195], v5 offset:57344
    ds_read_b128 v[196:199], v6 offset:6144
    ds_read_b128 v[200:203], v6 offset:20480
    ds_read_b128 v[204:207], v6 offset:34816
    ds_read_b128 v[208:211], v6 offset:49152
    s_waitcnt vmcnt(16)
    v_cndmask_b32 v244, v34, v32, s[82:83]
    v_cndmask_b32 v245, v35, v33, s[82:83]
    v_cndmask_b32 v246, v38, v36, s[82:83]
    v_cndmask_b32 v247, v39, v37, s[82:83]
    v_cndmask_b32 v248, v42, v40, s[82:83]
    v_cndmask_b32 v249, v43, v41, s[82:83]
    v_cndmask_b32 v250, v46, v44, s[82:83]
    v_cndmask_b32 v251, v47, v45, s[82:83]
    v_mov_b32_dpp v244, v244 row_ror:8 row_mask:0xf bank_mask:0xf
    v_mov_b32_dpp v245, v245 row_ror:8 row_mask:0xf bank_mask:0xf
    v_mov_b32_dpp v246, v246 row_ror:8 row_mask:0xf bank_mask:0xf
    v_mov_b32_dpp v247, v247 row_ror:8 row_mask:0xf bank_mask:0xf
    v_mov_b32_dpp v248, v248 row_ror:8 row_mask:0xf bank_mask:0xf
    v_mov_b32_dpp v249, v249 row_ror:8 row_mask:0xf bank_mask:0xf
    v_mov_b32_dpp v250, v250 row_ror:8 row_mask:0xf bank_mask:0xf
    v_mov_b32_dpp v251, v251 row_ror:8 row_mask:0xf bank_mask:0xf
    v_cndmask_b32 v32, v32, v244, s[82:83]
    v_cndmask_b32 v34, v244, v34, s[82:83]
    v_cndmask_b32 v33, v33, v245, s[82:83]
    v_cndmask_b32 v35, v245, v35, s[82:83]
    v_cndmask_b32 v36, v36, v246, s[82:83]
    v_cndmask_b32 v38, v246, v38, s[82:83]
    v_cndmask_b32 v37, v37, v247, s[82:83]
    v_cndmask_b32 v39, v247, v39, s[82:83]
    v_cndmask_b32 v40, v40, v248, s[82:83]
    v_cndmask_b32 v42, v248, v42, s[82:83]
    v_cndmask_b32 v41, v41, v249, s[82:83]
    v_cndmask_b32 v43, v249, v43, s[82:83]
    v_cndmask_b32 v44, v44, v250, s[82:83]
    v_cndmask_b32 v46, v250, v46, s[82:83]
    v_cndmask_b32 v45, v45, v251, s[82:83]
    v_cndmask_b32 v47, v251, v47, s[82:83]
    v_perm_b32 v96, v36, v32, s34
    v_perm_b32 v97, v44, v40, s34
    v_perm_b32 v98, v38, v34, s34
    v_perm_b32 v99, v46, v42, s34
    v_perm_b32 v100, v36, v32, s35
    v_perm_b32 v101, v44, v40, s35
    v_perm_b32 v102, v38, v34, s35
    v_perm_b32 v103, v46, v42, s35
    v_perm_b32 v104, v37, v33, s34
    v_perm_b32 v105, v45, v41, s34
    v_perm_b32 v106, v39, v35, s34
    v_perm_b32 v107, v47, v43, s34
    v_perm_b32 v108, v37, v33, s35
    v_perm_b32 v109, v45, v41, s35
    v_perm_b32 v110, v39, v35, s35
    v_perm_b32 v111, v47, v43, s35
    s_waitcnt lgkmcnt(8)
    v_mfma_f32_16x16x32_bf16 a[0:3], v[176:179], v[96:99], 0
    s_add_u32 s47, s29, 786432
    buffer_load_dwordx4 v[80:83], v7, s[12:15], s47 offen
    v_mfma_f32_16x16x32_bf16 a[4:7], v[176:179], v[100:103], 0
    v_mfma_f32_16x16x32_bf16 a[8:11], v[176:179], v[104:107], 0
    s_add_u32 s58, s29, 794624
    buffer_load_dwordx4 v[84:87], v7, s[12:15], s58 offen
    v_mfma_f32_16x16x32_bf16 a[12:15], v[176:179], v[108:111], 0
    ds_read_b128 v[176:179], v5 offset:1024
    s_waitcnt lgkmcnt(8)
    v_mfma_f32_16x16x32_bf16 a[16:19], v[180:183], v[96:99], 0
    s_add_u32 s59, s29, 802816
    buffer_load_dwordx4 v[88:91], v7, s[12:15], s59 offen
    v_mfma_f32_16x16x32_bf16 a[20:23], v[180:183], v[100:103], 0
    v_mfma_f32_16x16x32_bf16 a[24:27], v[180:183], v[104:107], 0
    s_add_u32 s46, s29, 811008
    buffer_load_dwordx4 v[92:95], v7, s[12:15], s46 offen
    s_waitcnt vmcnt(16)
    v_cndmask_b32 v244, v50, v48, s[82:83]
    v_mfma_f32_16x16x32_bf16 a[28:31], v[180:183], v[108:111], 0
    v_cndmask_b32 v245, v51, v49, s[82:83]
    v_cndmask_b32 v246, v54, v52, s[82:83]
    ds_read_b128 v[180:183], v5 offset:15360
    s_waitcnt lgkmcnt(8)
    v_mfma_f32_16x16x32_bf16 a[32:35], v[184:187], v[96:99], 0
    s_add_u32 m0, s28, 4096
    s_mov_b32 s46, 256
    buffer_load_dwordx4 v4, s[8:11], s46 offen lds
    v_cndmask_b32 v247, v55, v53, s[82:83]
    v_cndmask_b32 v248, v58, v56, s[82:83]
    v_mfma_f32_16x16x32_bf16 a[36:39], v[184:187], v[100:103], 0
    v_cndmask_b32 v249, v59, v57, s[82:83]
    v_cndmask_b32 v250, v62, v60, s[82:83]
    v_mfma_f32_16x16x32_bf16 a[40:43], v[184:187], v[104:107], 0
    s_add_u32 m0, s28, 18432
    s_mov_b32 s46, 14592
    buffer_load_dwordx4 v4, s[8:11], s46 offen lds
    v_cndmask_b32 v251, v63, v61, s[82:83]
    v_mov_b32_dpp v244, v244 row_ror:8 row_mask:0xf bank_mask:0xf
    v_mfma_f32_16x16x32_bf16 a[44:47], v[184:187], v[108:111], 0
    v_mov_b32_dpp v245, v245 row_ror:8 row_mask:0xf bank_mask:0xf
    v_mov_b32_dpp v246, v246 row_ror:8 row_mask:0xf bank_mask:0xf
    ds_read_b128 v[184:187], v5 offset:29696
    s_waitcnt lgkmcnt(8)
    v_mfma_f32_16x16x32_bf16 a[48:51], v[188:191], v[96:99], 0
    s_add_u32 m0, s28, 32768
    s_mov_b32 s46, 28928
    buffer_load_dwordx4 v4, s[8:11], s46 offen lds
    v_mov_b32_dpp v247, v247 row_ror:8 row_mask:0xf bank_mask:0xf
    v_mov_b32_dpp v248, v248 row_ror:8 row_mask:0xf bank_mask:0xf
    v_mfma_f32_16x16x32_bf16 a[52:55], v[188:191], v[100:103], 0
    v_mov_b32_dpp v249, v249 row_ror:8 row_mask:0xf bank_mask:0xf
    v_mov_b32_dpp v250, v250 row_ror:8 row_mask:0xf bank_mask:0xf
    v_mfma_f32_16x16x32_bf16 a[56:59], v[188:191], v[104:107], 0
    s_add_u32 m0, s28, 47104
    s_mov_b32 s46, 43264
    buffer_load_dwordx4 v4, s[8:11], s46 offen lds
    v_mov_b32_dpp v251, v251 row_ror:8 row_mask:0xf bank_mask:0xf
    v_cndmask_b32 v48, v48, v244, s[82:83]
    v_mfma_f32_16x16x32_bf16 a[60:63], v[188:191], v[108:111], 0
    v_cndmask_b32 v50, v244, v50, s[82:83]
    v_cndmask_b32 v49, v49, v245, s[82:83]
    ds_read_b128 v[188:191], v5 offset:44032
    s_waitcnt lgkmcnt(8)
    v_mfma_f32_16x16x32_bf16 a[64:67], v[192:195], v[96:99], 0
    s_add_u32 m0, s28, 61440
    s_mov_b32 s46, 57600
    buffer_load_dwordx4 v4, s[8:11], s46 offen lds
    v_cndmask_b32 v51, v245, v51, s[82:83]
    v_cndmask_b32 v52, v52, v246, s[82:83]
    v_mfma_f32_16x16x32_bf16 a[68:71], v[192:195], v[100:103], 0
    v_cndmask_b32 v54, v246, v54, s[82:83]
    v_cndmask_b32 v53, v53, v247, s[82:83]
    v_mfma_f32_16x16x32_bf16 a[72:75], v[192:195], v[104:107], 0
    s_add_u32 m0, s28, 75776
    s_mov_b32 s46, 71936
    buffer_load_dwordx4 v4, s[8:11], s46 offen lds
    v_cndmask_b32 v55, v247, v55, s[82:83]
    v_cndmask_b32 v56, v56, v248, s[82:83]
    v_mfma_f32_16x16x32_bf16 a[76:79], v[192:195], v[108:111], 0
    v_cndmask_b32 v58, v248, v58, s[82:83]
    v_cndmask_b32 v57, v57, v249, s[82:83]
    ds_read_b128 v[192:195], v5 offset:58368
    s_waitcnt lgkmcnt(8)
    v_mfma_f32_16x16x32_bf16 a[80:83], v[196:199], v[96:99], 0
    s_add_u32 m0, s28, 90112
    s_mov_b32 s46, 86272
    buffer_load_dwordx4 v4, s[8:11], s46 offen lds
    v_cndmask_b32 v59, v249, v59, s[82:83]
    v_cndmask_b32 v60, v60, v250, s[82:83]
    v_mfma_f32_16x16x32_bf16 a[84:87], v[196:199], v[100:103], 0
    v_cndmask_b32 v62, v250, v62, s[82:83]
    v_cndmask_b32 v61, v61, v251, s[82:83]
    v_mfma_f32_16x16x32_bf16 a[88:91], v[196:199], v[104:107], 0
    s_add_u32 m0, s28, 104448
    s_mov_b32 s46, 100608
    buffer_load_dwordx4 v4, s[8:11], s46 offen lds
    v_cndmask_b32 v63, v251, v63, s[82:83]
    v_perm_b32 v112, v52, v48, s34
    v_mfma_f32_16x16x32_bf16 a[92:95], v[196:199], v[108:111], 0
    v_perm_b32 v113, v60, v56, s34
    v_perm_b32 v114, v54, v50, s34
    ds_read_b128 v[196:199], v6 offset:7168
    s_waitcnt lgkmcnt(8)
    v_mfma_f32_16x16x32_bf16 a[96:99], v[200:203], v[96:99], 0
    s_add_u32 m0, s28, 118784
    s_mov_b32 s46, 114944
    buffer_load_dwordx4 v4, s[8:11], s46 offen lds
    v_perm_b32 v115, v62, v58, s34
    v_perm_b32 v116, v52, v48, s35
    v_mfma_f32_16x16x32_bf16 a[100:103], v[200:203], v[100:103], 0
    v_perm_b32 v117, v60, v56, s35
    v_perm_b32 v118, v54, v50, s35
    v_mfma_f32_16x16x32_bf16 a[104:107], v[200:203], v[104:107], 0
    s_add_u32 m0, s28, 8192
    s_mov_b32 s46, 512
    buffer_load_dwordx4 v4, s[8:11], s46 offen lds
    v_perm_b32 v119, v62, v58, s35
    v_perm_b32 v120, v53, v49, s34
    v_mfma_f32_16x16x32_bf16 a[108:111], v[200:203], v[108:111], 0
    v_perm_b32 v121, v61, v57, s34
    v_perm_b32 v122, v55, v51, s34
    ds_read_b128 v[200:203], v6 offset:21504
    s_waitcnt lgkmcnt(8)
    v_mfma_f32_16x16x32_bf16 a[112:115], v[204:207], v[96:99], 0
    s_add_u32 m0, s28, 22528
    s_mov_b32 s46, 14848
    buffer_load_dwordx4 v4, s[8:11], s46 offen lds
    v_perm_b32 v123, v63, v59, s34
    v_perm_b32 v124, v53, v49, s35
    v_mfma_f32_16x16x32_bf16 a[116:119], v[204:207], v[100:103], 0
    v_perm_b32 v125, v61, v57, s35
    v_perm_b32 v126, v55, v51, s35
    v_mfma_f32_16x16x32_bf16 a[120:123], v[204:207], v[104:107], 0
    s_add_u32 m0, s28, 36864
    s_mov_b32 s46, 29184
    buffer_load_dwordx4 v4, s[8:11], s46 offen lds
    v_perm_b32 v127, v63, v59, s35
    v_mfma_f32_16x16x32_bf16 a[124:127], v[204:207], v[108:111], 0
    ds_read_b128 v[204:207], v6 offset:35840
    s_waitcnt lgkmcnt(8)
    v_mfma_f32_16x16x32_bf16 a[128:131], v[208:211], v[96:99], 0
    s_add_u32 m0, s28, 51200
    s_mov_b32 s46, 43520
    buffer_load_dwordx4 v4, s[8:11], s46 offen lds
    v_mfma_f32_16x16x32_bf16 a[132:135], v[208:211], v[100:103], 0
    v_mfma_f32_16x16x32_bf16 a[136:139], v[208:211], v[104:107], 0
    s_add_u32 m0, s28, 65536
    s_mov_b32 s46, 57856
    buffer_load_dwordx4 v4, s[8:11], s46 offen lds
    v_mfma_f32_16x16x32_bf16 a[140:143], v[208:211], v[108:111], 0
    ds_read_b128 v[208:211], v6 offset:50176
    s_waitcnt lgkmcnt(8)
    v_mfma_f32_16x16x32_bf16 a[0:3], v[176:179], v[112:115], a[0:3]
    s_add_u32 s47, s29, 1048576
    buffer_load_dwordx4 v[32:35], v7, s[12:15], s47 offen
    v_mfma_f32_16x16x32_bf16 a[4:7], v[176:179], v[116:119], a[4:7]
    v_mfma_f32_16x16x32_bf16 a[8:11], v[176:179], v[120:123], a[8:11]
    s_add_u32 s58, s29, 1056768
    buffer_load_dwordx4 v[36:39], v7, s[12:15], s58 offen
    v_mfma_f32_16x16x32_bf16 a[12:15], v[176:179], v[124:127], a[12:15]
    ds_read_b128 v[176:179], v5 offset:2048
    s_waitcnt lgkmcnt(8)
    v_mfma_f32_16x16x32_bf16 a[16:19], v[180:183], v[112:115], a[16:19]
    s_add_u32 s59, s29, 1064960
    buffer_load_dwordx4 v[40:43], v7, s[12:15], s59 offen
    v_mfma_f32_16x16x32_bf16 a[20:23], v[180:183], v[116:119], a[20:23]
    v_mfma_f32_16x16x32_bf16 a[24:27], v[180:183], v[120:123], a[24:27]
    s_add_u32 s46, s29, 1073152
    buffer_load_dwordx4 v[44:47], v7, s[12:15], s46 offen
    s_waitcnt vmcnt(30)
    v_cndmask_b32 v244, v66, v64, s[82:83]
    v_mfma_f32_16x16x32_bf16 a[28:31], v[180:183], v[124:127], a[28:31]
    v_cndmask_b32 v245, v67, v65, s[82:83]
    v_cndmask_b32 v246, v70, v68, s[82:83]
    ds_read_b128 v[180:183], v5 offset:16384
    s_waitcnt lgkmcnt(8)
    v_mfma_f32_16x16x32_bf16 a[32:35], v[184:187], v[112:115], a[32:35]
    s_add_u32 m0, s28, 79872
    s_mov_b32 s46, 72192
    buffer_load_dwordx4 v4, s[8:11], s46 offen lds
    v_cndmask_b32 v247, v71, v69, s[82:83]
    v_cndmask_b32 v248, v74, v72, s[82:83]
    v_mfma_f32_16x16x32_bf16 a[36:39], v[184:187], v[116:119], a[36:39]
    v_cndmask_b32 v249, v75, v73, s[82:83]
    v_cndmask_b32 v250, v78, v76, s[82:83]
    v_mfma_f32_16x16x32_bf16 a[40:43], v[184:187], v[120:123], a[40:43]
    s_add_u32 m0, s28, 94208
    s_mov_b32 s46, 86528
    buffer_load_dwordx4 v4, s[8:11], s46 offen lds
    v_cndmask_b32 v251, v79, v77, s[82:83]
    v_mov_b32_dpp v244, v244 row_ror:8 row_mask:0xf bank_mask:0xf
    v_mfma_f32_16x16x32_bf16 a[44:47], v[184:187], v[124:127], a[44:47]
    v_mov_b32_dpp v245, v245 row_ror:8 row_mask:0xf bank_mask:0xf
    v_mov_b32_dpp v246, v246 row_ror:8 row_mask:0xf bank_mask:0xf
    ds_read_b128 v[184:187], v5 offset:30720
    s_waitcnt lgkmcnt(8)
    v_mfma_f32_16x16x32_bf16 a[48:51], v[188:191], v[112:115], a[48:51]
    s_add_u32 m0, s28, 108544
    s_mov_b32 s46, 100864
    buffer_load_dwordx4 v4, s[8:11], s46 offen lds
    v_mov_b32_dpp v247, v247 row_ror:8 row_mask:0xf bank_mask:0xf
    v_mov_b32_dpp v248, v248 row_ror:8 row_mask:0xf bank_mask:0xf
    v_mfma_f32_16x16x32_bf16 a[52:55], v[188:191], v[116:119], a[52:55]
    v_mov_b32_dpp v249, v249 row_ror:8 row_mask:0xf bank_mask:0xf
    v_mov_b32_dpp v250, v250 row_ror:8 row_mask:0xf bank_mask:0xf
    v_mfma_f32_16x16x32_bf16 a[56:59], v[188:191], v[120:123], a[56:59]
    s_add_u32 m0, s28, 122880
    s_mov_b32 s46, 115200
    buffer_load_dwordx4 v4, s[8:11], s46 offen lds
    v_mov_b32_dpp v251, v251 row_ror:8 row_mask:0xf bank_mask:0xf
    v_cndmask_b32 v64, v64, v244, s[82:83]
    v_mfma_f32_16x16x32_bf16 a[60:63], v[188:191], v[124:127], a[60:63]
    v_cndmask_b32 v66, v244, v66, s[82:83]
    v_cndmask_b32 v65, v65, v245, s[82:83]
    ds_read_b128 v[188:191], v5 offset:45056
    s_waitcnt lgkmcnt(8)
    v_mfma_f32_16x16x32_bf16 a[64:67], v[192:195], v[112:115], a[64:67]
    buffer_load_dwordx4 v[160:163], v8, s[16:19], s52 offen offset:128 nt
    v_cndmask_b32 v67, v245, v67, s[82:83]
    v_cndmask_b32 v68, v68, v246, s[82:83]
    v_mfma_f32_16x16x32_bf16 a[68:71], v[192:195], v[116:119], a[68:71]
    v_cndmask_b32 v70, v246, v70, s[82:83]
    v_cndmask_b32 v69, v69, v247, s[82:83]
    v_mfma_f32_16x16x32_bf16 a[72:75], v[192:195], v[120:123], a[72:75]
    buffer_load_dwordx4 v[164:167], v8, s[16:19], s52 offen offset:192 nt
    v_cndmask_b32 v71, v247, v71, s[82:83]
    v_cndmask_b32 v72, v72, v248, s[82:83]
    v_mfma_f32_16x16x32_bf16 a[76:79], v[192:195], v[124:127], a[76:79]
    v_cndmask_b32 v74, v248, v74, s[82:83]
    v_cndmask_b32 v73, v73, v249, s[82:83]
    ds_read_b128 v[192:195], v5 offset:59392
    s_waitcnt lgkmcnt(8)
    v_mfma_f32_16x16x32_bf16 a[80:83], v[196:199], v[112:115], a[80:83]
    buffer_load_dwordx4 v[168:171], v8, s[16:19], s53 offen offset:128 nt
    v_cndmask_b32 v75, v249, v75, s[82:83]
    v_cndmask_b32 v76, v76, v250, s[82:83]
    v_mfma_f32_16x16x32_bf16 a[84:87], v[196:199], v[116:119], a[84:87]
    v_cndmask_b32 v78, v250, v78, s[82:83]
    v_cndmask_b32 v77, v77, v251, s[82:83]
    v_mfma_f32_16x16x32_bf16 a[88:91], v[196:199], v[120:123], a[88:91]
    buffer_load_dwordx4 v[172:175], v8, s[16:19], s53 offen offset:192 nt
    v_cndmask_b32 v79, v251, v79, s[82:83]
    v_perm_b32 v96, v68, v64, s34
    v_mfma_f32_16x16x32_bf16 a[92:95], v[196:199], v[124:127], a[92:95]
    v_perm_b32 v97, v76, v72, s34
    v_perm_b32 v98, v70, v66, s34
    ds_read_b128 v[196:199], v6 offset:8192
    s_waitcnt lgkmcnt(8)
    v_mfma_f32_16x16x32_bf16 a[96:99], v[200:203], v[112:115], a[96:99]
    v_perm_b32 v99, v78, v74, s34
    v_perm_b32 v100, v68, v64, s35
    v_mfma_f32_16x16x32_bf16 a[100:103], v[200:203], v[116:119], a[100:103]
    v_perm_b32 v101, v76, v72, s35
    v_perm_b32 v102, v70, v66, s35
    v_mfma_f32_16x16x32_bf16 a[104:107], v[200:203], v[120:123], a[104:107]
    v_perm_b32 v103, v78, v74, s35
    v_perm_b32 v104, v69, v65, s34
    v_mfma_f32_16x16x32_bf16 a[108:111], v[200:203], v[124:127], a[108:111]
    v_perm_b32 v105, v77, v73, s34
    v_perm_b32 v106, v71, v67, s34
    ds_read_b128 v[200:203], v6 offset:22528
    s_waitcnt lgkmcnt(8)
    v_mfma_f32_16x16x32_bf16 a[112:115], v[204:207], v[112:115], a[112:115]
    v_perm_b32 v107, v79, v75, s34
    v_perm_b32 v108, v69, v65, s35
    v_mfma_f32_16x16x32_bf16 a[116:119], v[204:207], v[116:119], a[116:119]
    v_perm_b32 v109, v77, v73, s35
    v_perm_b32 v110, v71, v67, s35
    v_mfma_f32_16x16x32_bf16 a[120:123], v[204:207], v[120:123], a[120:123]
    v_perm_b32 v111, v79, v75, s35
    v_mfma_f32_16x16x32_bf16 a[124:127], v[204:207], v[124:127], a[124:127]
    ds_read_b128 v[204:207], v6 offset:36864
    s_waitcnt lgkmcnt(8)
    v_mfma_f32_16x16x32_bf16 a[128:131], v[208:211], v[112:115], a[128:131]
    v_mfma_f32_16x16x32_bf16 a[132:135], v[208:211], v[116:119], a[132:135]
    v_mfma_f32_16x16x32_bf16 a[136:139], v[208:211], v[120:123], a[136:139]
    v_mfma_f32_16x16x32_bf16 a[140:143], v[208:211], v[124:127], a[140:143]
    ds_read_b128 v[208:211], v6 offset:51200
    s_waitcnt lgkmcnt(8)
    v_mfma_f32_16x16x32_bf16 a[0:3], v[176:179], v[96:99], a[0:3]
    s_add_u32 s47, s29, 1310720
    buffer_load_dwordx4 v[48:51], v7, s[12:15], s47 offen
    v_mfma_f32_16x16x32_bf16 a[4:7], v[176:179], v[100:103], a[4:7]
    v_mfma_f32_16x16x32_bf16 a[8:11], v[176:179], v[104:107], a[8:11]
    s_add_u32 s58, s29, 1318912
    buffer_load_dwordx4 v[52:55], v7, s[12:15], s58 offen
    v_mfma_f32_16x16x32_bf16 a[12:15], v[176:179], v[108:111], a[12:15]
    ds_read_b128 v[176:179], v5 offset:3072
    s_waitcnt lgkmcnt(8)
    v_mfma_f32_16x16x32_bf16 a[16:19], v[180:183], v[96:99], a[16:19]
    s_add_u32 s59, s29, 1327104
    buffer_load_dwordx4 v[56:59], v7, s[12:15], s59 offen
    v_mfma_f32_16x16x32_bf16 a[20:23], v[180:183], v[100:103], a[20:23]
    v_mfma_f32_16x16x32_bf16 a[24:27], v[180:183], v[104:107], a[24:27]
    s_add_u32 s46, s29, 1335296
    buffer_load_dwordx4 v[60:63], v7, s[12:15], s46 offen
    s_waitcnt vmcnt(30)
    v_cndmask_b32 v244, v82, v80, s[82:83]
    v_mfma_f32_16x16x32_bf16 a[28:31], v[180:183], v[108:111], a[28:31]
    v_cndmask_b32 v245, v83, v81, s[82:83]
    v_cndmask_b32 v246, v86, v84, s[82:83]
    ds_read_b128 v[180:183], v5 offset:17408
    s_waitcnt lgkmcnt(8)
    v_mfma_f32_16x16x32_bf16 a[32:35], v[184:187], v[96:99], a[32:35]
    buffer_load_dwordx4 v[212:215], v8, s[16:19], s54 offen offset:128 nt
    v_cndmask_b32 v247, v87, v85, s[82:83]
    v_cndmask_b32 v248, v90, v88, s[82:83]
    v_mfma_f32_16x16x32_bf16 a[36:39], v[184:187], v[100:103], a[36:39]
    v_cndmask_b32 v249, v91, v89, s[82:83]
    v_cndmask_b32 v250, v94, v92, s[82:83]
    v_mfma_f32_16x16x32_bf16 a[40:43], v[184:187], v[104:107], a[40:43]
    buffer_load_dwordx4 v[216:219], v8, s[16:19], s54 offen offset:192 nt
    v_cndmask_b32 v251, v95, v93, s[82:83]
    v_mov_b32_dpp v244, v244 row_ror:8 row_mask:0xf bank_mask:0xf
    v_mfma_f32_16x16x32_bf16 a[44:47], v[184:187], v[108:111], a[44:47]
    v_mov_b32_dpp v245, v245 row_ror:8 row_mask:0xf bank_mask:0xf
    v_mov_b32_dpp v246, v246 row_ror:8 row_mask:0xf bank_mask:0xf
    ds_read_b128 v[184:187], v5 offset:31744
    s_waitcnt lgkmcnt(8)
    v_mfma_f32_16x16x32_bf16 a[48:51], v[188:191], v[96:99], a[48:51]
    v_mov_b32_dpp v247, v247 row_ror:8 row_mask:0xf bank_mask:0xf
    v_mov_b32_dpp v248, v248 row_ror:8 row_mask:0xf bank_mask:0xf
    v_mfma_f32_16x16x32_bf16 a[52:55], v[188:191], v[100:103], a[52:55]
    v_mov_b32_dpp v249, v249 row_ror:8 row_mask:0xf bank_mask:0xf
    v_mov_b32_dpp v250, v250 row_ror:8 row_mask:0xf bank_mask:0xf
    v_mfma_f32_16x16x32_bf16 a[56:59], v[188:191], v[104:107], a[56:59]
    v_mov_b32_dpp v251, v251 row_ror:8 row_mask:0xf bank_mask:0xf
    v_cndmask_b32 v80, v80, v244, s[82:83]
    v_mfma_f32_16x16x32_bf16 a[60:63], v[188:191], v[108:111], a[60:63]
    v_cndmask_b32 v82, v244, v82, s[82:83]
    v_cndmask_b32 v81, v81, v245, s[82:83]
    ds_read_b128 v[188:191], v5 offset:46080
    s_waitcnt lgkmcnt(8)
    v_mfma_f32_16x16x32_bf16 a[64:67], v[192:195], v[96:99], a[64:67]
    v_cndmask_b32 v83, v245, v83, s[82:83]
    v_cndmask_b32 v84, v84, v246, s[82:83]
    v_mfma_f32_16x16x32_bf16 a[68:71], v[192:195], v[100:103], a[68:71]
    v_cndmask_b32 v86, v246, v86, s[82:83]
    v_cndmask_b32 v85, v85, v247, s[82:83]
    v_mfma_f32_16x16x32_bf16 a[72:75], v[192:195], v[104:107], a[72:75]
    v_cndmask_b32 v87, v247, v87, s[82:83]
    v_cndmask_b32 v88, v88, v248, s[82:83]
    v_mfma_f32_16x16x32_bf16 a[76:79], v[192:195], v[108:111], a[76:79]
    v_cndmask_b32 v90, v248, v90, s[82:83]
    v_cndmask_b32 v89, v89, v249, s[82:83]
    ds_read_b128 v[192:195], v5 offset:60416
    s_waitcnt lgkmcnt(8)
    v_mfma_f32_16x16x32_bf16 a[80:83], v[196:199], v[96:99], a[80:83]
    v_cndmask_b32 v91, v249, v91, s[82:83]
    v_cndmask_b32 v92, v92, v250, s[82:83]
    v_mfma_f32_16x16x32_bf16 a[84:87], v[196:199], v[100:103], a[84:87]
    v_cndmask_b32 v94, v250, v94, s[82:83]
    v_cndmask_b32 v93, v93, v251, s[82:83]
    v_mfma_f32_16x16x32_bf16 a[88:91], v[196:199], v[104:107], a[88:91]
    v_cndmask_b32 v95, v251, v95, s[82:83]
    v_perm_b32 v112, v84, v80, s34
    v_mfma_f32_16x16x32_bf16 a[92:95], v[196:199], v[108:111], a[92:95]
    v_perm_b32 v113, v92, v88, s34
    v_perm_b32 v114, v86, v82, s34
    ds_read_b128 v[196:199], v6 offset:9216
    s_waitcnt lgkmcnt(8)
    v_mfma_f32_16x16x32_bf16 a[96:99], v[200:203], v[96:99], a[96:99]
    v_perm_b32 v115, v94, v90, s34
    v_perm_b32 v116, v84, v80, s35
    v_mfma_f32_16x16x32_bf16 a[100:103], v[200:203], v[100:103], a[100:103]
    v_perm_b32 v117, v92, v88, s35
    v_perm_b32 v118, v86, v82, s35
    v_mfma_f32_16x16x32_bf16 a[104:107], v[200:203], v[104:107], a[104:107]
    v_perm_b32 v119, v94, v90, s35
    v_perm_b32 v120, v85, v81, s34
    v_mfma_f32_16x16x32_bf16 a[108:111], v[200:203], v[108:111], a[108:111]
    v_perm_b32 v121, v93, v89, s34
    v_perm_b32 v122, v87, v83, s34
    ds_read_b128 v[200:203], v6 offset:23552
    s_waitcnt lgkmcnt(8)
    v_mfma_f32_16x16x32_bf16 a[112:115], v[204:207], v[96:99], a[112:115]
    v_perm_b32 v123, v95, v91, s34
    v_perm_b32 v124, v85, v81, s35
    v_mfma_f32_16x16x32_bf16 a[116:119], v[204:207], v[100:103], a[116:119]
    v_perm_b32 v125, v93, v89, s35
    v_perm_b32 v126, v87, v83, s35
    v_mfma_f32_16x16x32_bf16 a[120:123], v[204:207], v[104:107], a[120:123]
    v_perm_b32 v127, v95, v91, s35
    v_mfma_f32_16x16x32_bf16 a[124:127], v[204:207], v[108:111], a[124:127]
    ds_read_b128 v[204:207], v6 offset:37888
    s_waitcnt lgkmcnt(8)
    v_mfma_f32_16x16x32_bf16 a[128:131], v[208:211], v[96:99], a[128:131]
    v_mfma_f32_16x16x32_bf16 a[132:135], v[208:211], v[100:103], a[132:135]
    v_mfma_f32_16x16x32_bf16 a[136:139], v[208:211], v[104:107], a[136:139]
    v_mfma_f32_16x16x32_bf16 a[140:143], v[208:211], v[108:111], a[140:143]
    ds_read_b128 v[208:211], v6 offset:52224
    s_waitcnt vmcnt(23)
    s_barrier
    s_waitcnt lgkmcnt(8)
    v_mfma_f32_16x16x32_bf16 a[0:3], v[176:179], v[112:115], a[0:3]
    s_add_u32 s47, s29, 1572864
    buffer_load_dwordx4 v[64:67], v7, s[12:15], s47 offen
    v_mfma_f32_16x16x32_bf16 a[4:7], v[176:179], v[116:119], a[4:7]
    v_mfma_f32_16x16x32_bf16 a[8:11], v[176:179], v[120:123], a[8:11]
    s_add_u32 s58, s29, 1581056
    buffer_load_dwordx4 v[68:71], v7, s[12:15], s58 offen
    v_mfma_f32_16x16x32_bf16 a[12:15], v[176:179], v[124:127], a[12:15]
    ds_read_b128 v[176:179], v5 offset:4096
    s_waitcnt lgkmcnt(8)
    v_mfma_f32_16x16x32_bf16 a[16:19], v[180:183], v[112:115], a[16:19]
    s_add_u32 s59, s29, 1589248
    buffer_load_dwordx4 v[72:75], v7, s[12:15], s59 offen
    v_mfma_f32_16x16x32_bf16 a[20:23], v[180:183], v[116:119], a[20:23]
    v_mfma_f32_16x16x32_bf16 a[24:27], v[180:183], v[120:123], a[24:27]
    s_add_u32 s46, s29, 1597440
    buffer_load_dwordx4 v[76:79], v7, s[12:15], s46 offen
    s_waitcnt vmcnt(18)
    v_cndmask_b32 v244, v34, v32, s[82:83]
    v_mfma_f32_16x16x32_bf16 a[28:31], v[180:183], v[124:127], a[28:31]
    v_cndmask_b32 v245, v35, v33, s[82:83]
    v_cndmask_b32 v246, v38, v36, s[82:83]
    ds_read_b128 v[180:183], v5 offset:18432
    s_waitcnt lgkmcnt(8)
    v_mfma_f32_16x16x32_bf16 a[32:35], v[184:187], v[112:115], a[32:35]
    buffer_load_dwordx4 v[220:223], v8, s[16:19], s55 offen offset:128 nt
    v_cndmask_b32 v247, v39, v37, s[82:83]
    v_cndmask_b32 v248, v42, v40, s[82:83]
    v_mfma_f32_16x16x32_bf16 a[36:39], v[184:187], v[116:119], a[36:39]
    v_cndmask_b32 v249, v43, v41, s[82:83]
    v_cndmask_b32 v250, v46, v44, s[82:83]
    v_mfma_f32_16x16x32_bf16 a[40:43], v[184:187], v[120:123], a[40:43]
    buffer_load_dwordx4 v[224:227], v8, s[16:19], s55 offen offset:192 nt
    v_cndmask_b32 v251, v47, v45, s[82:83]
    v_mov_b32_dpp v244, v244 row_ror:8 row_mask:0xf bank_mask:0xf
    v_mfma_f32_16x16x32_bf16 a[44:47], v[184:187], v[124:127], a[44:47]
    v_mov_b32_dpp v245, v245 row_ror:8 row_mask:0xf bank_mask:0xf
    v_mov_b32_dpp v246, v246 row_ror:8 row_mask:0xf bank_mask:0xf
    ds_read_b128 v[184:187], v5 offset:32768
    s_waitcnt lgkmcnt(8)
    v_mfma_f32_16x16x32_bf16 a[48:51], v[188:191], v[112:115], a[48:51]
    v_mov_b32_dpp v247, v247 row_ror:8 row_mask:0xf bank_mask:0xf
    v_mov_b32_dpp v248, v248 row_ror:8 row_mask:0xf bank_mask:0xf
    v_mfma_f32_16x16x32_bf16 a[52:55], v[188:191], v[116:119], a[52:55]
    v_mov_b32_dpp v249, v249 row_ror:8 row_mask:0xf bank_mask:0xf
    v_mov_b32_dpp v250, v250 row_ror:8 row_mask:0xf bank_mask:0xf
    v_mfma_f32_16x16x32_bf16 a[56:59], v[188:191], v[120:123], a[56:59]
    v_mov_b32_dpp v251, v251 row_ror:8 row_mask:0xf bank_mask:0xf
    v_cndmask_b32 v32, v32, v244, s[82:83]
    v_mfma_f32_16x16x32_bf16 a[60:63], v[188:191], v[124:127], a[60:63]
    v_cndmask_b32 v34, v244, v34, s[82:83]
    v_cndmask_b32 v33, v33, v245, s[82:83]
    ds_read_b128 v[188:191], v5 offset:47104
    s_waitcnt lgkmcnt(8)
    v_mfma_f32_16x16x32_bf16 a[64:67], v[192:195], v[112:115], a[64:67]
    v_cndmask_b32 v35, v245, v35, s[82:83]
    v_cndmask_b32 v36, v36, v246, s[82:83]
    v_mfma_f32_16x16x32_bf16 a[68:71], v[192:195], v[116:119], a[68:71]
    v_cndmask_b32 v38, v246, v38, s[82:83]
    v_cndmask_b32 v37, v37, v247, s[82:83]
    v_mfma_f32_16x16x32_bf16 a[72:75], v[192:195], v[120:123], a[72:75]
    v_cndmask_b32 v39, v247, v39, s[82:83]
    v_cndmask_b32 v40, v40, v248, s[82:83]
    v_mfma_f32_16x16x32_bf16 a[76:79], v[192:195], v[124:127], a[76:79]
    v_cndmask_b32 v42, v248, v42, s[82:83]
    v_cndmask_b32 v41, v41, v249, s[82:83]
    ds_read_b128 v[192:195], v5 offset:61440
    s_waitcnt lgkmcnt(8)
    v_mfma_f32_16x16x32_bf16 a[80:83], v[196:199], v[112:115], a[80:83]
    v_cndmask_b32 v43, v249, v43, s[82:83]
    v_cndmask_b32 v44, v44, v250, s[82:83]
    v_mfma_f32_16x16x32_bf16 a[84:87], v[196:199], v[116:119], a[84:87]
    v_cndmask_b32 v46, v250, v46, s[82:83]
    v_cndmask_b32 v45, v45, v251, s[82:83]
    v_mfma_f32_16x16x32_bf16 a[88:91], v[196:199], v[120:123], a[88:91]
    v_cndmask_b32 v47, v251, v47, s[82:83]
    v_perm_b32 v96, v36, v32, s34
    v_mfma_f32_16x16x32_bf16 a[92:95], v[196:199], v[124:127], a[92:95]
    v_perm_b32 v97, v44, v40, s34
    v_perm_b32 v98, v38, v34, s34
    ds_read_b128 v[196:199], v6 offset:10240
    s_waitcnt lgkmcnt(8)
    v_mfma_f32_16x16x32_bf16 a[96:99], v[200:203], v[112:115], a[96:99]
    v_perm_b32 v99, v46, v42, s34
    v_perm_b32 v100, v36, v32, s35
    v_mfma_f32_16x16x32_bf16 a[100:103], v[200:203], v[116:119], a[100:103]
    v_perm_b32 v101, v44, v40, s35
    v_perm_b32 v102, v38, v34, s35
    v_mfma_f32_16x16x32_bf16 a[104:107], v[200:203], v[120:123], a[104:107]
    v_perm_b32 v103, v46, v42, s35
    v_perm_b32 v104, v37, v33, s34
    v_mfma_f32_16x16x32_bf16 a[108:111], v[200:203], v[124:127], a[108:111]
    v_perm_b32 v105, v45, v41, s34
    v_perm_b32 v106, v39, v35, s34
    ds_read_b128 v[200:203], v6 offset:24576
    s_waitcnt lgkmcnt(8)
    v_mfma_f32_16x16x32_bf16 a[112:115], v[204:207], v[112:115], a[112:115]
    v_perm_b32 v107, v47, v43, s34
    v_perm_b32 v108, v37, v33, s35
    v_mfma_f32_16x16x32_bf16 a[116:119], v[204:207], v[116:119], a[116:119]
    v_perm_b32 v109, v45, v41, s35
    v_perm_b32 v110, v39, v35, s35
    v_mfma_f32_16x16x32_bf16 a[120:123], v[204:207], v[120:123], a[120:123]
    v_perm_b32 v111, v47, v43, s35
    v_mfma_f32_16x16x32_bf16 a[124:127], v[204:207], v[124:127], a[124:127]
    ds_read_b128 v[204:207], v6 offset:38912
    s_waitcnt lgkmcnt(8)
    v_mfma_f32_16x16x32_bf16 a[128:131], v[208:211], v[112:115], a[128:131]
    v_mfma_f32_16x16x32_bf16 a[132:135], v[208:211], v[116:119], a[132:135]
    v_mfma_f32_16x16x32_bf16 a[136:139], v[208:211], v[120:123], a[136:139]
    v_mfma_f32_16x16x32_bf16 a[140:143], v[208:211], v[124:127], a[140:143]
    ds_read_b128 v[208:211], v6 offset:53248
    s_waitcnt lgkmcnt(8)
    v_mfma_f32_16x16x32_bf16 a[0:3], v[176:179], v[96:99], a[0:3]
    s_add_u32 s47, s29, 1835008
    buffer_load_dwordx4 v[80:83], v7, s[12:15], s47 offen
    v_mfma_f32_16x16x32_bf16 a[4:7], v[176:179], v[100:103], a[4:7]
    v_mfma_f32_16x16x32_bf16 a[8:11], v[176:179], v[104:107], a[8:11]
    s_add_u32 s58, s29, 1843200
    buffer_load_dwordx4 v[84:87], v7, s[12:15], s58 offen
    v_mfma_f32_16x16x32_bf16 a[12:15], v[176:179], v[108:111], a[12:15]
    ds_read_b128 v[176:179], v5 offset:5120
    s_waitcnt lgkmcnt(8)
    v_mfma_f32_16x16x32_bf16 a[16:19], v[180:183], v[96:99], a[16:19]
    s_add_u32 s59, s29, 1851392
    buffer_load_dwordx4 v[88:91], v7, s[12:15], s59 offen
    v_mfma_f32_16x16x32_bf16 a[20:23], v[180:183], v[100:103], a[20:23]
    v_mfma_f32_16x16x32_bf16 a[24:27], v[180:183], v[104:107], a[24:27]
    s_add_u32 s46, s29, 1859584
    buffer_load_dwordx4 v[92:95], v7, s[12:15], s46 offen
    s_waitcnt vmcnt(12)
    v_cndmask_b32 v244, v50, v48, s[82:83]
    v_mfma_f32_16x16x32_bf16 a[28:31], v[180:183], v[108:111], a[28:31]
    v_cndmask_b32 v245, v51, v49, s[82:83]
    v_cndmask_b32 v246, v54, v52, s[82:83]
    ds_read_b128 v[180:183], v5 offset:19456
    s_waitcnt lgkmcnt(8)
    v_mfma_f32_16x16x32_bf16 a[32:35], v[184:187], v[96:99], a[32:35]
    buffer_load_dwordx4 v[228:231], v8, s[16:19], s52 offen offset:256 nt
    v_cndmask_b32 v247, v55, v53, s[82:83]
    v_cndmask_b32 v248, v58, v56, s[82:83]
    v_mfma_f32_16x16x32_bf16 a[36:39], v[184:187], v[100:103], a[36:39]
    v_cndmask_b32 v249, v59, v57, s[82:83]
    v_cndmask_b32 v250, v62, v60, s[82:83]
    v_mfma_f32_16x16x32_bf16 a[40:43], v[184:187], v[104:107], a[40:43]
    buffer_load_dwordx4 v[232:235], v8, s[16:19], s52 offen offset:320 nt
    v_cndmask_b32 v251, v63, v61, s[82:83]
    v_mov_b32_dpp v244, v244 row_ror:8 row_mask:0xf bank_mask:0xf
    v_mfma_f32_16x16x32_bf16 a[44:47], v[184:187], v[108:111], a[44:47]
    v_mov_b32_dpp v245, v245 row_ror:8 row_mask:0xf bank_mask:0xf
    v_mov_b32_dpp v246, v246 row_ror:8 row_mask:0xf bank_mask:0xf
    ds_read_b128 v[184:187], v5 offset:33792
    s_waitcnt lgkmcnt(8)
    v_mfma_f32_16x16x32_bf16 a[48:51], v[188:191], v[96:99], a[48:51]
    v_mov_b32_dpp v247, v247 row_ror:8 row_mask:0xf bank_mask:0xf
    v_mov_b32_dpp v248, v248 row_ror:8 row_mask:0xf bank_mask:0xf
    v_mfma_f32_16x16x32_bf16 a[52:55], v[188:191], v[100:103], a[52:55]
    v_mov_b32_dpp v249, v249 row_ror:8 row_mask:0xf bank_mask:0xf
    v_mov_b32_dpp v250, v250 row_ror:8 row_mask:0xf bank_mask:0xf
    v_mfma_f32_16x16x32_bf16 a[56:59], v[188:191], v[104:107], a[56:59]
    v_mov_b32_dpp v251, v251 row_ror:8 row_mask:0xf bank_mask:0xf
    v_cndmask_b32 v48, v48, v244, s[82:83]
    v_mfma_f32_16x16x32_bf16 a[60:63], v[188:191], v[108:111], a[60:63]
    v_cndmask_b32 v50, v244, v50, s[82:83]
    v_cndmask_b32 v49, v49, v245, s[82:83]
    ds_read_b128 v[188:191], v5 offset:48128
    s_waitcnt lgkmcnt(8)
    v_mfma_f32_16x16x32_bf16 a[64:67], v[192:195], v[96:99], a[64:67]
    v_cndmask_b32 v51, v245, v51, s[82:83]
    v_cndmask_b32 v52, v52, v246, s[82:83]
    v_mfma_f32_16x16x32_bf16 a[68:71], v[192:195], v[100:103], a[68:71]
    v_cndmask_b32 v54, v246, v54, s[82:83]
    v_cndmask_b32 v53, v53, v247, s[82:83]
    v_mfma_f32_16x16x32_bf16 a[72:75], v[192:195], v[104:107], a[72:75]
    v_cndmask_b32 v55, v247, v55, s[82:83]
    v_cndmask_b32 v56, v56, v248, s[82:83]
    v_mfma_f32_16x16x32_bf16 a[76:79], v[192:195], v[108:111], a[76:79]
    v_cndmask_b32 v58, v248, v58, s[82:83]
    v_cndmask_b32 v57, v57, v249, s[82:83]
    ds_read_b128 v[192:195], v5 offset:62464
    s_waitcnt lgkmcnt(8)
    v_mfma_f32_16x16x32_bf16 a[80:83], v[196:199], v[96:99], a[80:83]
    v_cndmask_b32 v59, v249, v59, s[82:83]
    v_cndmask_b32 v60, v60, v250, s[82:83]
    v_mfma_f32_16x16x32_bf16 a[84:87], v[196:199], v[100:103], a[84:87]
    v_cndmask_b32 v62, v250, v62, s[82:83]
    v_cndmask_b32 v61, v61, v251, s[82:83]
    v_mfma_f32_16x16x32_bf16 a[88:91], v[196:199], v[104:107], a[88:91]
    v_cndmask_b32 v63, v251, v63, s[82:83]
    v_perm_b32 v112, v52, v48, s34
    v_mfma_f32_16x16x32_bf16 a[92:95], v[196:199], v[108:111], a[92:95]
    v_perm_b32 v113, v60, v56, s34
    v_perm_b32 v114, v54, v50, s34
    ds_read_b128 v[196:199], v6 offset:11264
    s_waitcnt lgkmcnt(8)
    v_mfma_f32_16x16x32_bf16 a[96:99], v[200:203], v[96:99], a[96:99]
    v_perm_b32 v115, v62, v58, s34
    v_perm_b32 v116, v52, v48, s35
    v_mfma_f32_16x16x32_bf16 a[100:103], v[200:203], v[100:103], a[100:103]
    v_perm_b32 v117, v60, v56, s35
    v_perm_b32 v118, v54, v50, s35
    v_mfma_f32_16x16x32_bf16 a[104:107], v[200:203], v[104:107], a[104:107]
    v_perm_b32 v119, v62, v58, s35
    v_perm_b32 v120, v53, v49, s34
    v_mfma_f32_16x16x32_bf16 a[108:111], v[200:203], v[108:111], a[108:111]
    v_perm_b32 v121, v61, v57, s34
    v_perm_b32 v122, v55, v51, s34
    ds_read_b128 v[200:203], v6 offset:25600
    s_waitcnt lgkmcnt(8)
    v_mfma_f32_16x16x32_bf16 a[112:115], v[204:207], v[96:99], a[112:115]
    v_perm_b32 v123, v63, v59, s34
    v_perm_b32 v124, v53, v49, s35
    v_mfma_f32_16x16x32_bf16 a[116:119], v[204:207], v[100:103], a[116:119]
    v_perm_b32 v125, v61, v57, s35
    v_perm_b32 v126, v55, v51, s35
    v_mfma_f32_16x16x32_bf16 a[120:123], v[204:207], v[104:107], a[120:123]
    v_perm_b32 v127, v63, v59, s35
    v_mfma_f32_16x16x32_bf16 a[124:127], v[204:207], v[108:111], a[124:127]
    ds_read_b128 v[204:207], v6 offset:39936
    s_waitcnt lgkmcnt(8)
    v_mfma_f32_16x16x32_bf16 a[128:131], v[208:211], v[96:99], a[128:131]
    v_mfma_f32_16x16x32_bf16 a[132:135], v[208:211], v[100:103], a[132:135]
    v_mfma_f32_16x16x32_bf16 a[136:139], v[208:211], v[104:107], a[136:139]
    v_mfma_f32_16x16x32_bf16 a[140:143], v[208:211], v[108:111], a[140:143]
    ds_read_b128 v[208:211], v6 offset:54272
    s_waitcnt lgkmcnt(8)
    v_mfma_f32_16x16x32_bf16 a[0:3], v[176:179], v[112:115], a[0:3]
    s_add_u32 s47, s29, 2097152
    buffer_load_dwordx4 v[32:35], v7, s[12:15], s47 offen
    v_mfma_f32_16x16x32_bf16 a[4:7], v[176:179], v[116:119], a[4:7]
    v_mfma_f32_16x16x32_bf16 a[8:11], v[176:179], v[120:123], a[8:11]
    s_add_u32 s58, s29, 2105344
    buffer_load_dwordx4 v[36:39], v7, s[12:15], s58 offen
    v_mfma_f32_16x16x32_bf16 a[12:15], v[176:179], v[124:127], a[12:15]
    ds_read_b128 v[176:179], v5 offset:6144
    s_waitcnt lgkmcnt(8)
    v_mfma_f32_16x16x32_bf16 a[16:19], v[180:183], v[112:115], a[16:19]
    s_add_u32 s59, s29, 2113536
    buffer_load_dwordx4 v[40:43], v7, s[12:15], s59 offen
    v_mfma_f32_16x16x32_bf16 a[20:23], v[180:183], v[116:119], a[20:23]
    v_mfma_f32_16x16x32_bf16 a[24:27], v[180:183], v[120:123], a[24:27]
    s_add_u32 s46, s29, 2121728
    buffer_load_dwordx4 v[44:47], v7, s[12:15], s46 offen
    s_waitcnt vmcnt(12)
    v_cndmask_b32 v244, v66, v64, s[82:83]
    v_mfma_f32_16x16x32_bf16 a[28:31], v[180:183], v[124:127], a[28:31]
    v_cndmask_b32 v245, v67, v65, s[82:83]
    v_cndmask_b32 v246, v70, v68, s[82:83]
    ds_read_b128 v[180:183], v5 offset:20480
    s_waitcnt lgkmcnt(8)
    v_mfma_f32_16x16x32_bf16 a[32:35], v[184:187], v[112:115], a[32:35]
    buffer_load_dwordx4 v[236:239], v8, s[16:19], s53 offen offset:256 nt
    v_cndmask_b32 v247, v71, v69, s[82:83]
    v_cndmask_b32 v248, v74, v72, s[82:83]
    v_mfma_f32_16x16x32_bf16 a[36:39], v[184:187], v[116:119], a[36:39]
    v_cndmask_b32 v249, v75, v73, s[82:83]
    v_cndmask_b32 v250, v78, v76, s[82:83]
    v_mfma_f32_16x16x32_bf16 a[40:43], v[184:187], v[120:123], a[40:43]
    buffer_load_dwordx4 v[240:243], v8, s[16:19], s53 offen offset:320 nt
    v_cndmask_b32 v251, v79, v77, s[82:83]
    v_mov_b32_dpp v244, v244 row_ror:8 row_mask:0xf bank_mask:0xf
    v_mfma_f32_16x16x32_bf16 a[44:47], v[184:187], v[124:127], a[44:47]
    v_mov_b32_dpp v245, v245 row_ror:8 row_mask:0xf bank_mask:0xf
    v_mov_b32_dpp v246, v246 row_ror:8 row_mask:0xf bank_mask:0xf
    ds_read_b128 v[184:187], v5 offset:34816
    s_waitcnt lgkmcnt(8)
    v_mfma_f32_16x16x32_bf16 a[48:51], v[188:191], v[112:115], a[48:51]
    v_mov_b32_dpp v247, v247 row_ror:8 row_mask:0xf bank_mask:0xf
    v_mov_b32_dpp v248, v248 row_ror:8 row_mask:0xf bank_mask:0xf
    v_mfma_f32_16x16x32_bf16 a[52:55], v[188:191], v[116:119], a[52:55]
    v_mov_b32_dpp v249, v249 row_ror:8 row_mask:0xf bank_mask:0xf
    v_mov_b32_dpp v250, v250 row_ror:8 row_mask:0xf bank_mask:0xf
    v_mfma_f32_16x16x32_bf16 a[56:59], v[188:191], v[120:123], a[56:59]
    v_mov_b32_dpp v251, v251 row_ror:8 row_mask:0xf bank_mask:0xf
    v_cndmask_b32 v64, v64, v244, s[82:83]
    v_mfma_f32_16x16x32_bf16 a[60:63], v[188:191], v[124:127], a[60:63]
    v_cndmask_b32 v66, v244, v66, s[82:83]
    v_cndmask_b32 v65, v65, v245, s[82:83]
    ds_read_b128 v[188:191], v5 offset:49152
    s_waitcnt lgkmcnt(8)
    v_mfma_f32_16x16x32_bf16 a[64:67], v[192:195], v[112:115], a[64:67]
    v_cndmask_b32 v67, v245, v67, s[82:83]
    v_cndmask_b32 v68, v68, v246, s[82:83]
    v_mfma_f32_16x16x32_bf16 a[68:71], v[192:195], v[116:119], a[68:71]
    v_cndmask_b32 v70, v246, v70, s[82:83]
    v_cndmask_b32 v69, v69, v247, s[82:83]
    v_mfma_f32_16x16x32_bf16 a[72:75], v[192:195], v[120:123], a[72:75]
    v_cndmask_b32 v71, v247, v71, s[82:83]
    v_cndmask_b32 v72, v72, v248, s[82:83]
    v_mfma_f32_16x16x32_bf16 a[76:79], v[192:195], v[124:127], a[76:79]
    v_cndmask_b32 v74, v248, v74, s[82:83]
    v_cndmask_b32 v73, v73, v249, s[82:83]
    ds_read_b128 v[192:195], v5 offset:63488
    s_waitcnt lgkmcnt(8)
    v_mfma_f32_16x16x32_bf16 a[80:83], v[196:199], v[112:115], a[80:83]
    v_cndmask_b32 v75, v249, v75, s[82:83]
    v_cndmask_b32 v76, v76, v250, s[82:83]
    v_mfma_f32_16x16x32_bf16 a[84:87], v[196:199], v[116:119], a[84:87]
    v_cndmask_b32 v78, v250, v78, s[82:83]
    v_cndmask_b32 v77, v77, v251, s[82:83]
    v_mfma_f32_16x16x32_bf16 a[88:91], v[196:199], v[120:123], a[88:91]
    v_cndmask_b32 v79, v251, v79, s[82:83]
    v_perm_b32 v96, v68, v64, s34
    v_mfma_f32_16x16x32_bf16 a[92:95], v[196:199], v[124:127], a[92:95]
    v_perm_b32 v97, v76, v72, s34
    v_perm_b32 v98, v70, v66, s34
    ds_read_b128 v[196:199], v6 offset:12288
    s_waitcnt lgkmcnt(8)
    v_mfma_f32_16x16x32_bf16 a[96:99], v[200:203], v[112:115], a[96:99]
    v_perm_b32 v99, v78, v74, s34
    v_perm_b32 v100, v68, v64, s35
    v_mfma_f32_16x16x32_bf16 a[100:103], v[200:203], v[116:119], a[100:103]
    v_perm_b32 v101, v76, v72, s35
    v_perm_b32 v102, v70, v66, s35
    v_mfma_f32_16x16x32_bf16 a[104:107], v[200:203], v[120:123], a[104:107]
    v_perm_b32 v103, v78, v74, s35
    v_perm_b32 v104, v69, v65, s34
    v_mfma_f32_16x16x32_bf16 a[108:111], v[200:203], v[124:127], a[108:111]
    v_perm_b32 v105, v77, v73, s34
    v_perm_b32 v106, v71, v67, s34
    ds_read_b128 v[200:203], v6 offset:26624
    s_waitcnt lgkmcnt(8)
    v_mfma_f32_16x16x32_bf16 a[112:115], v[204:207], v[112:115], a[112:115]
    v_perm_b32 v107, v79, v75, s34
    v_perm_b32 v108, v69, v65, s35
    v_mfma_f32_16x16x32_bf16 a[116:119], v[204:207], v[116:119], a[116:119]
    v_perm_b32 v109, v77, v73, s35
    v_perm_b32 v110, v71, v67, s35
    v_mfma_f32_16x16x32_bf16 a[120:123], v[204:207], v[120:123], a[120:123]
    v_perm_b32 v111, v79, v75, s35
    v_mfma_f32_16x16x32_bf16 a[124:127], v[204:207], v[124:127], a[124:127]
    ds_read_b128 v[204:207], v6 offset:40960
    s_waitcnt lgkmcnt(8)
    v_mfma_f32_16x16x32_bf16 a[128:131], v[208:211], v[112:115], a[128:131]
    v_mfma_f32_16x16x32_bf16 a[132:135], v[208:211], v[116:119], a[132:135]
    v_mfma_f32_16x16x32_bf16 a[136:139], v[208:211], v[120:123], a[136:139]
    v_mfma_f32_16x16x32_bf16 a[140:143], v[208:211], v[124:127], a[140:143]
    ds_read_b128 v[208:211], v6 offset:55296
    s_waitcnt lgkmcnt(8)
    v_mfma_f32_16x16x32_bf16 a[0:3], v[176:179], v[96:99], a[0:3]
    s_add_u32 s47, s29, 2359296
    buffer_load_dwordx4 v[48:51], v7, s[12:15], s47 offen
    v_mfma_f32_16x16x32_bf16 a[4:7], v[176:179], v[100:103], a[4:7]
    v_mfma_f32_16x16x32_bf16 a[8:11], v[176:179], v[104:107], a[8:11]
    s_add_u32 s58, s29, 2367488
    buffer_load_dwordx4 v[52:55], v7, s[12:15], s58 offen
    v_mfma_f32_16x16x32_bf16 a[12:15], v[176:179], v[108:111], a[12:15]
    ds_read_b128 v[176:179], v5 offset:7168
    s_waitcnt lgkmcnt(8)
    v_mfma_f32_16x16x32_bf16 a[16:19], v[180:183], v[96:99], a[16:19]
    s_add_u32 s59, s29, 2375680
    buffer_load_dwordx4 v[56:59], v7, s[12:15], s59 offen
    v_mfma_f32_16x16x32_bf16 a[20:23], v[180:183], v[100:103], a[20:23]
    v_mfma_f32_16x16x32_bf16 a[24:27], v[180:183], v[104:107], a[24:27]
    s_add_u32 s46, s29, 2383872
    buffer_load_dwordx4 v[60:63], v7, s[12:15], s46 offen
    s_waitcnt vmcnt(12)
    v_cndmask_b32 v244, v82, v80, s[82:83]
    v_mfma_f32_16x16x32_bf16 a[28:31], v[180:183], v[108:111], a[28:31]
    v_cndmask_b32 v245, v83, v81, s[82:83]
    v_cndmask_b32 v246, v86, v84, s[82:83]
    ds_read_b128 v[180:183], v5 offset:21504
    s_waitcnt lgkmcnt(8)
    v_mfma_f32_16x16x32_bf16 a[32:35], v[184:187], v[96:99], a[32:35]
    buffer_load_dwordx4 a[144:147], v8, s[16:19], s54 offen offset:256 nt
    v_cndmask_b32 v247, v87, v85, s[82:83]
    v_cndmask_b32 v248, v90, v88, s[82:83]
    v_mfma_f32_16x16x32_bf16 a[36:39], v[184:187], v[100:103], a[36:39]
    v_cndmask_b32 v249, v91, v89, s[82:83]
    v_cndmask_b32 v250, v94, v92, s[82:83]
    v_mfma_f32_16x16x32_bf16 a[40:43], v[184:187], v[104:107], a[40:43]
    buffer_load_dwordx4 a[148:151], v8, s[16:19], s54 offen offset:320 nt
    v_cndmask_b32 v251, v95, v93, s[82:83]
    v_mov_b32_dpp v244, v244 row_ror:8 row_mask:0xf bank_mask:0xf
    v_mfma_f32_16x16x32_bf16 a[44:47], v[184:187], v[108:111], a[44:47]
    v_mov_b32_dpp v245, v245 row_ror:8 row_mask:0xf bank_mask:0xf
    v_mov_b32_dpp v246, v246 row_ror:8 row_mask:0xf bank_mask:0xf
    ds_read_b128 v[184:187], v5 offset:35840
    s_waitcnt lgkmcnt(8)
    v_mfma_f32_16x16x32_bf16 a[48:51], v[188:191], v[96:99], a[48:51]
    v_mov_b32_dpp v247, v247 row_ror:8 row_mask:0xf bank_mask:0xf
    v_mov_b32_dpp v248, v248 row_ror:8 row_mask:0xf bank_mask:0xf
    v_mfma_f32_16x16x32_bf16 a[52:55], v[188:191], v[100:103], a[52:55]
    v_mov_b32_dpp v249, v249 row_ror:8 row_mask:0xf bank_mask:0xf
    v_mov_b32_dpp v250, v250 row_ror:8 row_mask:0xf bank_mask:0xf
    v_mfma_f32_16x16x32_bf16 a[56:59], v[188:191], v[104:107], a[56:59]
    v_mov_b32_dpp v251, v251 row_ror:8 row_mask:0xf bank_mask:0xf
    v_cndmask_b32 v80, v80, v244, s[82:83]
    v_mfma_f32_16x16x32_bf16 a[60:63], v[188:191], v[108:111], a[60:63]
    v_cndmask_b32 v82, v244, v82, s[82:83]
    v_cndmask_b32 v81, v81, v245, s[82:83]
    ds_read_b128 v[188:191], v5 offset:50176
    s_waitcnt lgkmcnt(8)
    v_mfma_f32_16x16x32_bf16 a[64:67], v[192:195], v[96:99], a[64:67]
    v_cndmask_b32 v83, v245, v83, s[82:83]
    v_cndmask_b32 v84, v84, v246, s[82:83]
    v_mfma_f32_16x16x32_bf16 a[68:71], v[192:195], v[100:103], a[68:71]
    v_cndmask_b32 v86, v246, v86, s[82:83]
    v_cndmask_b32 v85, v85, v247, s[82:83]
    v_mfma_f32_16x16x32_bf16 a[72:75], v[192:195], v[104:107], a[72:75]
    v_cndmask_b32 v87, v247, v87, s[82:83]
    v_cndmask_b32 v88, v88, v248, s[82:83]
    v_mfma_f32_16x16x32_bf16 a[76:79], v[192:195], v[108:111], a[76:79]
    v_cndmask_b32 v90, v248, v90, s[82:83]
    v_cndmask_b32 v89, v89, v249, s[82:83]
    ds_read_b128 v[192:195], v5 offset:64512
    s_waitcnt lgkmcnt(8)
    v_mfma_f32_16x16x32_bf16 a[80:83], v[196:199], v[96:99], a[80:83]
    v_cndmask_b32 v91, v249, v91, s[82:83]
    v_cndmask_b32 v92, v92, v250, s[82:83]
    v_mfma_f32_16x16x32_bf16 a[84:87], v[196:199], v[100:103], a[84:87]
    v_cndmask_b32 v94, v250, v94, s[82:83]
    v_cndmask_b32 v93, v93, v251, s[82:83]
    v_mfma_f32_16x16x32_bf16 a[88:91], v[196:199], v[104:107], a[88:91]
    v_cndmask_b32 v95, v251, v95, s[82:83]
    v_perm_b32 v112, v84, v80, s34
    v_mfma_f32_16x16x32_bf16 a[92:95], v[196:199], v[108:111], a[92:95]
    v_perm_b32 v113, v92, v88, s34
    v_perm_b32 v114, v86, v82, s34
    ds_read_b128 v[196:199], v6 offset:13312
    s_waitcnt lgkmcnt(8)
    v_mfma_f32_16x16x32_bf16 a[96:99], v[200:203], v[96:99], a[96:99]
    v_perm_b32 v115, v94, v90, s34
    v_perm_b32 v116, v84, v80, s35
    v_mfma_f32_16x16x32_bf16 a[100:103], v[200:203], v[100:103], a[100:103]
    v_perm_b32 v117, v92, v88, s35
    v_perm_b32 v118, v86, v82, s35
    v_mfma_f32_16x16x32_bf16 a[104:107], v[200:203], v[104:107], a[104:107]
    v_perm_b32 v119, v94, v90, s35
    v_perm_b32 v120, v85, v81, s34
    v_mfma_f32_16x16x32_bf16 a[108:111], v[200:203], v[108:111], a[108:111]
    v_perm_b32 v121, v93, v89, s34
    v_perm_b32 v122, v87, v83, s34
    ds_read_b128 v[200:203], v6 offset:27648
    s_waitcnt lgkmcnt(8)
    v_mfma_f32_16x16x32_bf16 a[112:115], v[204:207], v[96:99], a[112:115]
    v_perm_b32 v123, v95, v91, s34
    v_perm_b32 v124, v85, v81, s35
    v_mfma_f32_16x16x32_bf16 a[116:119], v[204:207], v[100:103], a[116:119]
    v_perm_b32 v125, v93, v89, s35
    v_perm_b32 v126, v87, v83, s35
    v_mfma_f32_16x16x32_bf16 a[120:123], v[204:207], v[104:107], a[120:123]
    v_perm_b32 v127, v95, v91, s35
    v_mfma_f32_16x16x32_bf16 a[124:127], v[204:207], v[108:111], a[124:127]
    ds_read_b128 v[204:207], v6 offset:41984
    s_waitcnt lgkmcnt(8)
    v_mfma_f32_16x16x32_bf16 a[128:131], v[208:211], v[96:99], a[128:131]
    v_mfma_f32_16x16x32_bf16 a[132:135], v[208:211], v[100:103], a[132:135]
    v_mfma_f32_16x16x32_bf16 a[136:139], v[208:211], v[104:107], a[136:139]
    v_mfma_f32_16x16x32_bf16 a[140:143], v[208:211], v[108:111], a[140:143]
    ds_read_b128 v[208:211], v6 offset:56320
    s_barrier
    s_waitcnt lgkmcnt(8)
    v_mfma_f32_16x16x32_bf16 a[0:3], v[176:179], v[112:115], a[0:3]
    s_add_u32 s47, s29, 2621440
    buffer_load_dwordx4 v[64:67], v7, s[12:15], s47 offen
    v_mfma_f32_16x16x32_bf16 a[4:7], v[176:179], v[116:119], a[4:7]
    v_mfma_f32_16x16x32_bf16 a[8:11], v[176:179], v[120:123], a[8:11]
    s_add_u32 s58, s29, 2629632
    buffer_load_dwordx4 v[68:71], v7, s[12:15], s58 offen
    v_mfma_f32_16x16x32_bf16 a[12:15], v[176:179], v[124:127], a[12:15]
    ds_read_b128 v[176:179], v5 offset:8192
    s_waitcnt lgkmcnt(8)
    v_mfma_f32_16x16x32_bf16 a[16:19], v[180:183], v[112:115], a[16:19]
    s_add_u32 s59, s29, 2637824
    buffer_load_dwordx4 v[72:75], v7, s[12:15], s59 offen
    v_mfma_f32_16x16x32_bf16 a[20:23], v[180:183], v[116:119], a[20:23]
    v_mfma_f32_16x16x32_bf16 a[24:27], v[180:183], v[120:123], a[24:27]
    s_add_u32 s46, s29, 2646016
    buffer_load_dwordx4 v[76:79], v7, s[12:15], s46 offen
    s_waitcnt vmcnt(12)
    v_cndmask_b32 v244, v34, v32, s[82:83]
    v_mfma_f32_16x16x32_bf16 a[28:31], v[180:183], v[124:127], a[28:31]
    v_cndmask_b32 v245, v35, v33, s[82:83]
    v_cndmask_b32 v246, v38, v36, s[82:83]
    ds_read_b128 v[180:183], v5 offset:22528
    s_waitcnt lgkmcnt(8)
    v_mfma_f32_16x16x32_bf16 a[32:35], v[184:187], v[112:115], a[32:35]
    buffer_load_dwordx4 a[152:155], v8, s[16:19], s55 offen offset:256 nt
    v_cndmask_b32 v247, v39, v37, s[82:83]
    v_cndmask_b32 v248, v42, v40, s[82:83]
    v_mfma_f32_16x16x32_bf16 a[36:39], v[184:187], v[116:119], a[36:39]
    v_cndmask_b32 v249, v43, v41, s[82:83]
    v_cndmask_b32 v250, v46, v44, s[82:83]
    v_mfma_f32_16x16x32_bf16 a[40:43], v[184:187], v[120:123], a[40:43]
    buffer_load_dwordx4 a[156:159], v8, s[16:19], s55 offen offset:320 nt
    v_cndmask_b32 v251, v47, v45, s[82:83]
    v_mov_b32_dpp v244, v244 row_ror:8 row_mask:0xf bank_mask:0xf
    v_mfma_f32_16x16x32_bf16 a[44:47], v[184:187], v[124:127], a[44:47]
    v_mov_b32_dpp v245, v245 row_ror:8 row_mask:0xf bank_mask:0xf
    v_mov_b32_dpp v246, v246 row_ror:8 row_mask:0xf bank_mask:0xf
    ds_read_b128 v[184:187], v5 offset:36864
    s_waitcnt lgkmcnt(8)
    v_mfma_f32_16x16x32_bf16 a[48:51], v[188:191], v[112:115], a[48:51]
    v_mov_b32_dpp v247, v247 row_ror:8 row_mask:0xf bank_mask:0xf
    v_mov_b32_dpp v248, v248 row_ror:8 row_mask:0xf bank_mask:0xf
    v_mfma_f32_16x16x32_bf16 a[52:55], v[188:191], v[116:119], a[52:55]
    v_mov_b32_dpp v249, v249 row_ror:8 row_mask:0xf bank_mask:0xf
    v_mov_b32_dpp v250, v250 row_ror:8 row_mask:0xf bank_mask:0xf
    v_mfma_f32_16x16x32_bf16 a[56:59], v[188:191], v[120:123], a[56:59]
    v_mov_b32_dpp v251, v251 row_ror:8 row_mask:0xf bank_mask:0xf
    v_cndmask_b32 v32, v32, v244, s[82:83]
    v_mfma_f32_16x16x32_bf16 a[60:63], v[188:191], v[124:127], a[60:63]
    v_cndmask_b32 v34, v244, v34, s[82:83]
    v_cndmask_b32 v33, v33, v245, s[82:83]
    ds_read_b128 v[188:191], v5 offset:51200
    s_waitcnt lgkmcnt(8)
    v_mfma_f32_16x16x32_bf16 a[64:67], v[192:195], v[112:115], a[64:67]
    v_cndmask_b32 v35, v245, v35, s[82:83]
    v_cndmask_b32 v36, v36, v246, s[82:83]
    v_mfma_f32_16x16x32_bf16 a[68:71], v[192:195], v[116:119], a[68:71]
    v_cndmask_b32 v38, v246, v38, s[82:83]
    v_cndmask_b32 v37, v37, v247, s[82:83]
    v_mfma_f32_16x16x32_bf16 a[72:75], v[192:195], v[120:123], a[72:75]
    v_cndmask_b32 v39, v247, v39, s[82:83]
    v_cndmask_b32 v40, v40, v248, s[82:83]
    v_mfma_f32_16x16x32_bf16 a[76:79], v[192:195], v[124:127], a[76:79]
    v_cndmask_b32 v42, v248, v42, s[82:83]
    v_cndmask_b32 v41, v41, v249, s[82:83]
    ds_read_b128 v[192:195], v6
    s_waitcnt lgkmcnt(8)
    v_mfma_f32_16x16x32_bf16 a[80:83], v[196:199], v[112:115], a[80:83]
    v_cndmask_b32 v43, v249, v43, s[82:83]
    v_cndmask_b32 v44, v44, v250, s[82:83]
    v_mfma_f32_16x16x32_bf16 a[84:87], v[196:199], v[116:119], a[84:87]
    v_cndmask_b32 v46, v250, v46, s[82:83]
    v_cndmask_b32 v45, v45, v251, s[82:83]
    v_mfma_f32_16x16x32_bf16 a[88:91], v[196:199], v[120:123], a[88:91]
    v_cndmask_b32 v47, v251, v47, s[82:83]
    v_perm_b32 v96, v36, v32, s34
    v_mfma_f32_16x16x32_bf16 a[92:95], v[196:199], v[124:127], a[92:95]
    v_perm_b32 v97, v44, v40, s34
    v_perm_b32 v98, v38, v34, s34
    ds_read_b128 v[196:199], v6 offset:14336
    s_waitcnt lgkmcnt(8)
    v_mfma_f32_16x16x32_bf16 a[96:99], v[200:203], v[112:115], a[96:99]
    v_perm_b32 v99, v46, v42, s34
    v_perm_b32 v100, v36, v32, s35
    v_mfma_f32_16x16x32_bf16 a[100:103], v[200:203], v[116:119], a[100:103]
    v_perm_b32 v101, v44, v40, s35
    v_perm_b32 v102, v38, v34, s35
    v_mfma_f32_16x16x32_bf16 a[104:107], v[200:203], v[120:123], a[104:107]
    v_perm_b32 v103, v46, v42, s35
    v_perm_b32 v104, v37, v33, s34
    v_mfma_f32_16x16x32_bf16 a[108:111], v[200:203], v[124:127], a[108:111]
    v_perm_b32 v105, v45, v41, s34
    v_perm_b32 v106, v39, v35, s34
    ds_read_b128 v[200:203], v6 offset:28672
    s_waitcnt lgkmcnt(8)
    v_mfma_f32_16x16x32_bf16 a[112:115], v[204:207], v[112:115], a[112:115]
    v_perm_b32 v107, v47, v43, s34
    v_perm_b32 v108, v37, v33, s35
    v_mfma_f32_16x16x32_bf16 a[116:119], v[204:207], v[116:119], a[116:119]
    v_perm_b32 v109, v45, v41, s35
    v_perm_b32 v110, v39, v35, s35
    v_mfma_f32_16x16x32_bf16 a[120:123], v[204:207], v[120:123], a[120:123]
    v_perm_b32 v111, v47, v43, s35
    v_mfma_f32_16x16x32_bf16 a[124:127], v[204:207], v[124:127], a[124:127]
    ds_read_b128 v[204:207], v6 offset:43008
    s_waitcnt lgkmcnt(8)
    v_mfma_f32_16x16x32_bf16 a[128:131], v[208:211], v[112:115], a[128:131]
    v_mfma_f32_16x16x32_bf16 a[132:135], v[208:211], v[116:119], a[132:135]
    v_mfma_f32_16x16x32_bf16 a[136:139], v[208:211], v[120:123], a[136:139]
    v_mfma_f32_16x16x32_bf16 a[140:143], v[208:211], v[124:127], a[140:143]
    ds_read_b128 v[208:211], v6 offset:57344
    s_waitcnt lgkmcnt(8)
    v_mfma_f32_16x16x32_bf16 a[0:3], v[176:179], v[96:99], a[0:3]
    s_add_u32 s47, s29, 2883584
    buffer_load_dwordx4 v[80:83], v7, s[12:15], s47 offen
    v_mfma_f32_16x16x32_bf16 a[4:7], v[176:179], v[100:103], a[4:7]
    v_mfma_f32_16x16x32_bf16 a[8:11], v[176:179], v[104:107], a[8:11]
    s_add_u32 s58, s29, 2891776
    buffer_load_dwordx4 v[84:87], v7, s[12:15], s58 offen
    v_mfma_f32_16x16x32_bf16 a[12:15], v[176:179], v[108:111], a[12:15]
    ds_read_b128 v[176:179], v5 offset:9216
    s_waitcnt lgkmcnt(8)
    v_mfma_f32_16x16x32_bf16 a[16:19], v[180:183], v[96:99], a[16:19]
    s_add_u32 s59, s29, 2899968
    buffer_load_dwordx4 v[88:91], v7, s[12:15], s59 offen
    v_mfma_f32_16x16x32_bf16 a[20:23], v[180:183], v[100:103], a[20:23]
    v_mfma_f32_16x16x32_bf16 a[24:27], v[180:183], v[104:107], a[24:27]
    s_add_u32 s46, s29, 2908160
    buffer_load_dwordx4 v[92:95], v7, s[12:15], s46 offen
    s_waitcnt vmcnt(12)
    v_cndmask_b32 v244, v50, v48, s[82:83]
    v_mfma_f32_16x16x32_bf16 a[28:31], v[180:183], v[108:111], a[28:31]
    v_cndmask_b32 v245, v51, v49, s[82:83]
    v_cndmask_b32 v246, v54, v52, s[82:83]
    ds_read_b128 v[180:183], v5 offset:23552
    s_waitcnt lgkmcnt(8)
    v_mfma_f32_16x16x32_bf16 a[32:35], v[184:187], v[96:99], a[32:35]
    buffer_load_dwordx4 a[160:163], v8, s[16:19], s52 offen offset:384 nt
    v_cndmask_b32 v247, v55, v53, s[82:83]
    v_cndmask_b32 v248, v58, v56, s[82:83]
    v_mfma_f32_16x16x32_bf16 a[36:39], v[184:187], v[100:103], a[36:39]
    v_cndmask_b32 v249, v59, v57, s[82:83]
    v_cndmask_b32 v250, v62, v60, s[82:83]
    v_mfma_f32_16x16x32_bf16 a[40:43], v[184:187], v[104:107], a[40:43]
    buffer_load_dwordx4 a[164:167], v8, s[16:19], s52 offen offset:448 nt
    v_cndmask_b32 v251, v63, v61, s[82:83]
    v_mov_b32_dpp v244, v244 row_ror:8 row_mask:0xf bank_mask:0xf
    v_mfma_f32_16x16x32_bf16 a[44:47], v[184:187], v[108:111], a[44:47]
    v_mov_b32_dpp v245, v245 row_ror:8 row_mask:0xf bank_mask:0xf
    v_mov_b32_dpp v246, v246 row_ror:8 row_mask:0xf bank_mask:0xf
    ds_read_b128 v[184:187], v5 offset:37888
    s_waitcnt lgkmcnt(8)
    v_mfma_f32_16x16x32_bf16 a[48:51], v[188:191], v[96:99], a[48:51]
    v_mov_b32_dpp v247, v247 row_ror:8 row_mask:0xf bank_mask:0xf
    v_mov_b32_dpp v248, v248 row_ror:8 row_mask:0xf bank_mask:0xf
    v_mfma_f32_16x16x32_bf16 a[52:55], v[188:191], v[100:103], a[52:55]
    v_mov_b32_dpp v249, v249 row_ror:8 row_mask:0xf bank_mask:0xf
    v_mov_b32_dpp v250, v250 row_ror:8 row_mask:0xf bank_mask:0xf
    v_mfma_f32_16x16x32_bf16 a[56:59], v[188:191], v[104:107], a[56:59]
    v_mov_b32_dpp v251, v251 row_ror:8 row_mask:0xf bank_mask:0xf
    v_cndmask_b32 v48, v48, v244, s[82:83]
    v_mfma_f32_16x16x32_bf16 a[60:63], v[188:191], v[108:111], a[60:63]
    v_cndmask_b32 v50, v244, v50, s[82:83]
    v_cndmask_b32 v49, v49, v245, s[82:83]
    ds_read_b128 v[188:191], v5 offset:52224
    s_waitcnt lgkmcnt(8)
    v_mfma_f32_16x16x32_bf16 a[64:67], v[192:195], v[96:99], a[64:67]
    v_cndmask_b32 v51, v245, v51, s[82:83]
    v_cndmask_b32 v52, v52, v246, s[82:83]
    v_mfma_f32_16x16x32_bf16 a[68:71], v[192:195], v[100:103], a[68:71]
    v_cndmask_b32 v54, v246, v54, s[82:83]
    v_cndmask_b32 v53, v53, v247, s[82:83]
    v_mfma_f32_16x16x32_bf16 a[72:75], v[192:195], v[104:107], a[72:75]
    v_cndmask_b32 v55, v247, v55, s[82:83]
    v_cndmask_b32 v56, v56, v248, s[82:83]
    v_mfma_f32_16x16x32_bf16 a[76:79], v[192:195], v[108:111], a[76:79]
    v_cndmask_b32 v58, v248, v58, s[82:83]
    v_cndmask_b32 v57, v57, v249, s[82:83]
    ds_read_b128 v[192:195], v6 offset:1024
    s_waitcnt lgkmcnt(8)
    v_mfma_f32_16x16x32_bf16 a[80:83], v[196:199], v[96:99], a[80:83]
    v_cndmask_b32 v59, v249, v59, s[82:83]
    v_cndmask_b32 v60, v60, v250, s[82:83]
    v_mfma_f32_16x16x32_bf16 a[84:87], v[196:199], v[100:103], a[84:87]
    v_cndmask_b32 v62, v250, v62, s[82:83]
    v_cndmask_b32 v61, v61, v251, s[82:83]
    v_mfma_f32_16x16x32_bf16 a[88:91], v[196:199], v[104:107], a[88:91]
    v_cndmask_b32 v63, v251, v63, s[82:83]
    v_perm_b32 v112, v52, v48, s34
    v_mfma_f32_16x16x32_bf16 a[92:95], v[196:199], v[108:111], a[92:95]
    v_perm_b32 v113, v60, v56, s34
    v_perm_b32 v114, v54, v50, s34
    ds_read_b128 v[196:199], v6 offset:15360
    s_waitcnt lgkmcnt(8)
    v_mfma_f32_16x16x32_bf16 a[96:99], v[200:203], v[96:99], a[96:99]
    v_perm_b32 v115, v62, v58, s34
    v_perm_b32 v116, v52, v48, s35
    v_mfma_f32_16x16x32_bf16 a[100:103], v[200:203], v[100:103], a[100:103]
    v_perm_b32 v117, v60, v56, s35
    v_perm_b32 v118, v54, v50, s35
    v_mfma_f32_16x16x32_bf16 a[104:107], v[200:203], v[104:107], a[104:107]
    v_perm_b32 v119, v62, v58, s35
    v_perm_b32 v120, v53, v49, s34
    v_mfma_f32_16x16x32_bf16 a[108:111], v[200:203], v[108:111], a[108:111]
    v_perm_b32 v121, v61, v57, s34
    v_perm_b32 v122, v55, v51, s34
    ds_read_b128 v[200:203], v6 offset:29696
    s_waitcnt lgkmcnt(8)
    v_mfma_f32_16x16x32_bf16 a[112:115], v[204:207], v[96:99], a[112:115]
    v_perm_b32 v123, v63, v59, s34
    v_perm_b32 v124, v53, v49, s35
    v_mfma_f32_16x16x32_bf16 a[116:119], v[204:207], v[100:103], a[116:119]
    v_perm_b32 v125, v61, v57, s35
    v_perm_b32 v126, v55, v51, s35
    v_mfma_f32_16x16x32_bf16 a[120:123], v[204:207], v[104:107], a[120:123]
    v_perm_b32 v127, v63, v59, s35
    v_mfma_f32_16x16x32_bf16 a[124:127], v[204:207], v[108:111], a[124:127]
    ds_read_b128 v[204:207], v6 offset:44032
    s_waitcnt lgkmcnt(8)
    v_mfma_f32_16x16x32_bf16 a[128:131], v[208:211], v[96:99], a[128:131]
    v_mfma_f32_16x16x32_bf16 a[132:135], v[208:211], v[100:103], a[132:135]
    v_mfma_f32_16x16x32_bf16 a[136:139], v[208:211], v[104:107], a[136:139]
    v_mfma_f32_16x16x32_bf16 a[140:143], v[208:211], v[108:111], a[140:143]
    ds_read_b128 v[208:211], v6 offset:58368
    s_waitcnt lgkmcnt(8)
    v_mfma_f32_16x16x32_bf16 a[0:3], v[176:179], v[112:115], a[0:3]
    s_add_u32 s47, s29, 3145728
    buffer_load_dwordx4 v[32:35], v7, s[12:15], s47 offen
    v_mfma_f32_16x16x32_bf16 a[4:7], v[176:179], v[116:119], a[4:7]
    v_mfma_f32_16x16x32_bf16 a[8:11], v[176:179], v[120:123], a[8:11]
    s_add_u32 s58, s29, 3153920
    buffer_load_dwordx4 v[36:39], v7, s[12:15], s58 offen
    v_mfma_f32_16x16x32_bf16 a[12:15], v[176:179], v[124:127], a[12:15]
    ds_read_b128 v[176:179], v5 offset:10240
    s_waitcnt lgkmcnt(8)
    v_mfma_f32_16x16x32_bf16 a[16:19], v[180:183], v[112:115], a[16:19]
    s_add_u32 s59, s29, 3162112
    buffer_load_dwordx4 v[40:43], v7, s[12:15], s59 offen
    v_mfma_f32_16x16x32_bf16 a[20:23], v[180:183], v[116:119], a[20:23]
    v_mfma_f32_16x16x32_bf16 a[24:27], v[180:183], v[120:123], a[24:27]
    s_add_u32 s46, s29, 3170304
    buffer_load_dwordx4 v[44:47], v7, s[12:15], s46 offen
    s_waitcnt vmcnt(12)
    v_cndmask_b32 v244, v66, v64, s[82:83]
    v_mfma_f32_16x16x32_bf16 a[28:31], v[180:183], v[124:127], a[28:31]
    v_cndmask_b32 v245, v67, v65, s[82:83]
    v_cndmask_b32 v246, v70, v68, s[82:83]
    ds_read_b128 v[180:183], v5 offset:24576
    s_waitcnt lgkmcnt(8)
    v_mfma_f32_16x16x32_bf16 a[32:35], v[184:187], v[112:115], a[32:35]
    buffer_load_dwordx4 a[168:171], v8, s[16:19], s53 offen offset:384 nt
    v_cndmask_b32 v247, v71, v69, s[82:83]
    v_cndmask_b32 v248, v74, v72, s[82:83]
    v_mfma_f32_16x16x32_bf16 a[36:39], v[184:187], v[116:119], a[36:39]
    v_cndmask_b32 v249, v75, v73, s[82:83]
    v_cndmask_b32 v250, v78, v76, s[82:83]
    v_mfma_f32_16x16x32_bf16 a[40:43], v[184:187], v[120:123], a[40:43]
    buffer_load_dwordx4 a[172:175], v8, s[16:19], s53 offen offset:448 nt
    v_cndmask_b32 v251, v79, v77, s[82:83]
    v_mov_b32_dpp v244, v244 row_ror:8 row_mask:0xf bank_mask:0xf
    v_mfma_f32_16x16x32_bf16 a[44:47], v[184:187], v[124:127], a[44:47]
    v_mov_b32_dpp v245, v245 row_ror:8 row_mask:0xf bank_mask:0xf
    v_mov_b32_dpp v246, v246 row_ror:8 row_mask:0xf bank_mask:0xf
    ds_read_b128 v[184:187], v5 offset:38912
    s_waitcnt lgkmcnt(8)
    v_mfma_f32_16x16x32_bf16 a[48:51], v[188:191], v[112:115], a[48:51]
    v_mov_b32_dpp v247, v247 row_ror:8 row_mask:0xf bank_mask:0xf
    v_mov_b32_dpp v248, v248 row_ror:8 row_mask:0xf bank_mask:0xf
    v_mfma_f32_16x16x32_bf16 a[52:55], v[188:191], v[116:119], a[52:55]
    v_mov_b32_dpp v249, v249 row_ror:8 row_mask:0xf bank_mask:0xf
    v_mov_b32_dpp v250, v250 row_ror:8 row_mask:0xf bank_mask:0xf
    v_mfma_f32_16x16x32_bf16 a[56:59], v[188:191], v[120:123], a[56:59]
    v_mov_b32_dpp v251, v251 row_ror:8 row_mask:0xf bank_mask:0xf
    v_cndmask_b32 v64, v64, v244, s[82:83]
    v_mfma_f32_16x16x32_bf16 a[60:63], v[188:191], v[124:127], a[60:63]
    v_cndmask_b32 v66, v244, v66, s[82:83]
    v_cndmask_b32 v65, v65, v245, s[82:83]
    ds_read_b128 v[188:191], v5 offset:53248
    s_waitcnt lgkmcnt(8)
    v_mfma_f32_16x16x32_bf16 a[64:67], v[192:195], v[112:115], a[64:67]
    v_cndmask_b32 v67, v245, v67, s[82:83]
    v_cndmask_b32 v68, v68, v246, s[82:83]
    v_mfma_f32_16x16x32_bf16 a[68:71], v[192:195], v[116:119], a[68:71]
    v_cndmask_b32 v70, v246, v70, s[82:83]
    v_cndmask_b32 v69, v69, v247, s[82:83]
    v_mfma_f32_16x16x32_bf16 a[72:75], v[192:195], v[120:123], a[72:75]
    v_cndmask_b32 v71, v247, v71, s[82:83]
    v_cndmask_b32 v72, v72, v248, s[82:83]
    v_mfma_f32_16x16x32_bf16 a[76:79], v[192:195], v[124:127], a[76:79]
    v_cndmask_b32 v74, v248, v74, s[82:83]
    v_cndmask_b32 v73, v73, v249, s[82:83]
    ds_read_b128 v[192:195], v6 offset:2048
    s_waitcnt lgkmcnt(8)
    v_mfma_f32_16x16x32_bf16 a[80:83], v[196:199], v[112:115], a[80:83]
    v_cndmask_b32 v75, v249, v75, s[82:83]
    v_cndmask_b32 v76, v76, v250, s[82:83]
    v_mfma_f32_16x16x32_bf16 a[84:87], v[196:199], v[116:119], a[84:87]
    v_cndmask_b32 v78, v250, v78, s[82:83]
    v_cndmask_b32 v77, v77, v251, s[82:83]
    v_mfma_f32_16x16x32_bf16 a[88:91], v[196:199], v[120:123], a[88:91]
    v_cndmask_b32 v79, v251, v79, s[82:83]
    v_perm_b32 v96, v68, v64, s34
    v_mfma_f32_16x16x32_bf16 a[92:95], v[196:199], v[124:127], a[92:95]
    v_perm_b32 v97, v76, v72, s34
    v_perm_b32 v98, v70, v66, s34
    ds_read_b128 v[196:199], v6 offset:16384
    s_waitcnt lgkmcnt(8)
    v_mfma_f32_16x16x32_bf16 a[96:99], v[200:203], v[112:115], a[96:99]
    v_perm_b32 v99, v78, v74, s34
    v_perm_b32 v100, v68, v64, s35
    v_mfma_f32_16x16x32_bf16 a[100:103], v[200:203], v[116:119], a[100:103]
    v_perm_b32 v101, v76, v72, s35
    v_perm_b32 v102, v70, v66, s35
    v_mfma_f32_16x16x32_bf16 a[104:107], v[200:203], v[120:123], a[104:107]
    v_perm_b32 v103, v78, v74, s35
    v_perm_b32 v104, v69, v65, s34
    v_mfma_f32_16x16x32_bf16 a[108:111], v[200:203], v[124:127], a[108:111]
    v_perm_b32 v105, v77, v73, s34
    v_perm_b32 v106, v71, v67, s34
    ds_read_b128 v[200:203], v6 offset:30720
    s_waitcnt lgkmcnt(8)
    v_mfma_f32_16x16x32_bf16 a[112:115], v[204:207], v[112:115], a[112:115]
    v_perm_b32 v107, v79, v75, s34
    v_perm_b32 v108, v69, v65, s35
    v_mfma_f32_16x16x32_bf16 a[116:119], v[204:207], v[116:119], a[116:119]
    v_perm_b32 v109, v77, v73, s35
    v_perm_b32 v110, v71, v67, s35
    v_mfma_f32_16x16x32_bf16 a[120:123], v[204:207], v[120:123], a[120:123]
    v_perm_b32 v111, v79, v75, s35
    v_mfma_f32_16x16x32_bf16 a[124:127], v[204:207], v[124:127], a[124:127]
    ds_read_b128 v[204:207], v6 offset:45056
    s_waitcnt lgkmcnt(8)
    v_mfma_f32_16x16x32_bf16 a[128:131], v[208:211], v[112:115], a[128:131]
    v_mfma_f32_16x16x32_bf16 a[132:135], v[208:211], v[116:119], a[132:135]
    v_mfma_f32_16x16x32_bf16 a[136:139], v[208:211], v[120:123], a[136:139]
    v_mfma_f32_16x16x32_bf16 a[140:143], v[208:211], v[124:127], a[140:143]
    ds_read_b128 v[208:211], v6 offset:59392
    s_waitcnt lgkmcnt(8)
    v_mfma_f32_16x16x32_bf16 a[0:3], v[176:179], v[96:99], a[0:3]
    s_add_u32 s47, s29, 3407872
    buffer_load_dwordx4 v[48:51], v7, s[12:15], s47 offen
    v_mfma_f32_16x16x32_bf16 a[4:7], v[176:179], v[100:103], a[4:7]
    v_mfma_f32_16x16x32_bf16 a[8:11], v[176:179], v[104:107], a[8:11]
    s_add_u32 s58, s29, 3416064
    buffer_load_dwordx4 v[52:55], v7, s[12:15], s58 offen
    v_mfma_f32_16x16x32_bf16 a[12:15], v[176:179], v[108:111], a[12:15]
    ds_read_b128 v[176:179], v5 offset:11264
    s_waitcnt lgkmcnt(8)
    v_mfma_f32_16x16x32_bf16 a[16:19], v[180:183], v[96:99], a[16:19]
    s_add_u32 s59, s29, 3424256
    buffer_load_dwordx4 v[56:59], v7, s[12:15], s59 offen
    v_mfma_f32_16x16x32_bf16 a[20:23], v[180:183], v[100:103], a[20:23]
    v_mfma_f32_16x16x32_bf16 a[24:27], v[180:183], v[104:107], a[24:27]
    s_add_u32 s46, s29, 3432448
    buffer_load_dwordx4 v[60:63], v7, s[12:15], s46 offen
    s_waitcnt vmcnt(12)
    v_cndmask_b32 v244, v82, v80, s[82:83]
    v_mfma_f32_16x16x32_bf16 a[28:31], v[180:183], v[108:111], a[28:31]
    v_cndmask_b32 v245, v83, v81, s[82:83]
    v_cndmask_b32 v246, v86, v84, s[82:83]
    ds_read_b128 v[180:183], v5 offset:25600
    s_waitcnt lgkmcnt(8)
    v_mfma_f32_16x16x32_bf16 a[32:35], v[184:187], v[96:99], a[32:35]
    buffer_load_dwordx4 a[176:179], v8, s[16:19], s54 offen offset:384 nt
    v_cndmask_b32 v247, v87, v85, s[82:83]
    v_cndmask_b32 v248, v90, v88, s[82:83]
    v_mfma_f32_16x16x32_bf16 a[36:39], v[184:187], v[100:103], a[36:39]
    v_cndmask_b32 v249, v91, v89, s[82:83]
    v_cndmask_b32 v250, v94, v92, s[82:83]
    v_mfma_f32_16x16x32_bf16 a[40:43], v[184:187], v[104:107], a[40:43]
    buffer_load_dwordx4 a[180:183], v8, s[16:19], s54 offen offset:448 nt
    v_cndmask_b32 v251, v95, v93, s[82:83]
    v_mov_b32_dpp v244, v244 row_ror:8 row_mask:0xf bank_mask:0xf
    v_mfma_f32_16x16x32_bf16 a[44:47], v[184:187], v[108:111], a[44:47]
    v_mov_b32_dpp v245, v245 row_ror:8 row_mask:0xf bank_mask:0xf
    v_mov_b32_dpp v246, v246 row_ror:8 row_mask:0xf bank_mask:0xf
    ds_read_b128 v[184:187], v5 offset:39936
    s_waitcnt lgkmcnt(8)
    v_mfma_f32_16x16x32_bf16 a[48:51], v[188:191], v[96:99], a[48:51]
    v_mov_b32_dpp v247, v247 row_ror:8 row_mask:0xf bank_mask:0xf
    v_mov_b32_dpp v248, v248 row_ror:8 row_mask:0xf bank_mask:0xf
    v_mfma_f32_16x16x32_bf16 a[52:55], v[188:191], v[100:103], a[52:55]
    v_mov_b32_dpp v249, v249 row_ror:8 row_mask:0xf bank_mask:0xf
    v_mov_b32_dpp v250, v250 row_ror:8 row_mask:0xf bank_mask:0xf
    v_mfma_f32_16x16x32_bf16 a[56:59], v[188:191], v[104:107], a[56:59]
    v_mov_b32_dpp v251, v251 row_ror:8 row_mask:0xf bank_mask:0xf
    v_cndmask_b32 v80, v80, v244, s[82:83]
    v_mfma_f32_16x16x32_bf16 a[60:63], v[188:191], v[108:111], a[60:63]
    v_cndmask_b32 v82, v244, v82, s[82:83]
    v_cndmask_b32 v81, v81, v245, s[82:83]
    ds_read_b128 v[188:191], v5 offset:54272
    s_waitcnt lgkmcnt(8)
    v_mfma_f32_16x16x32_bf16 a[64:67], v[192:195], v[96:99], a[64:67]
    v_cndmask_b32 v83, v245, v83, s[82:83]
    v_cndmask_b32 v84, v84, v246, s[82:83]
    v_mfma_f32_16x16x32_bf16 a[68:71], v[192:195], v[100:103], a[68:71]
    v_cndmask_b32 v86, v246, v86, s[82:83]
    v_cndmask_b32 v85, v85, v247, s[82:83]
    v_mfma_f32_16x16x32_bf16 a[72:75], v[192:195], v[104:107], a[72:75]
    v_cndmask_b32 v87, v247, v87, s[82:83]
    v_cndmask_b32 v88, v88, v248, s[82:83]
    v_mfma_f32_16x16x32_bf16 a[76:79], v[192:195], v[108:111], a[76:79]
    v_cndmask_b32 v90, v248, v90, s[82:83]
    v_cndmask_b32 v89, v89, v249, s[82:83]
    ds_read_b128 v[192:195], v6 offset:3072
    s_waitcnt lgkmcnt(8)
    v_mfma_f32_16x16x32_bf16 a[80:83], v[196:199], v[96:99], a[80:83]
    v_cndmask_b32 v91, v249, v91, s[82:83]
    v_cndmask_b32 v92, v92, v250, s[82:83]
    v_mfma_f32_16x16x32_bf16 a[84:87], v[196:199], v[100:103], a[84:87]
    v_cndmask_b32 v94, v250, v94, s[82:83]
    v_cndmask_b32 v93, v93, v251, s[82:83]
    v_mfma_f32_16x16x32_bf16 a[88:91], v[196:199], v[104:107], a[88:91]
    v_cndmask_b32 v95, v251, v95, s[82:83]
    v_perm_b32 v112, v84, v80, s34
    v_mfma_f32_16x16x32_bf16 a[92:95], v[196:199], v[108:111], a[92:95]
    v_perm_b32 v113, v92, v88, s34
    v_perm_b32 v114, v86, v82, s34
    ds_read_b128 v[196:199], v6 offset:17408
    s_waitcnt lgkmcnt(8)
    v_mfma_f32_16x16x32_bf16 a[96:99], v[200:203], v[96:99], a[96:99]
    v_perm_b32 v115, v94, v90, s34
    v_perm_b32 v116, v84, v80, s35
    v_mfma_f32_16x16x32_bf16 a[100:103], v[200:203], v[100:103], a[100:103]
    v_perm_b32 v117, v92, v88, s35
    v_perm_b32 v118, v86, v82, s35
    v_mfma_f32_16x16x32_bf16 a[104:107], v[200:203], v[104:107], a[104:107]
    v_perm_b32 v119, v94, v90, s35
    v_perm_b32 v120, v85, v81, s34
    v_mfma_f32_16x16x32_bf16 a[108:111], v[200:203], v[108:111], a[108:111]
    v_perm_b32 v121, v93, v89, s34
    v_perm_b32 v122, v87, v83, s34
    ds_read_b128 v[200:203], v6 offset:31744
    s_waitcnt lgkmcnt(8)
    v_mfma_f32_16x16x32_bf16 a[112:115], v[204:207], v[96:99], a[112:115]
    v_perm_b32 v123, v95, v91, s34
    v_perm_b32 v124, v85, v81, s35
    v_mfma_f32_16x16x32_bf16 a[116:119], v[204:207], v[100:103], a[116:119]
    v_perm_b32 v125, v93, v89, s35
    v_perm_b32 v126, v87, v83, s35
    v_mfma_f32_16x16x32_bf16 a[120:123], v[204:207], v[104:107], a[120:123]
    v_perm_b32 v127, v95, v91, s35
    v_mfma_f32_16x16x32_bf16 a[124:127], v[204:207], v[108:111], a[124:127]
    ds_read_b128 v[204:207], v6 offset:46080
    s_waitcnt lgkmcnt(8)
    v_mfma_f32_16x16x32_bf16 a[128:131], v[208:211], v[96:99], a[128:131]
    v_mfma_f32_16x16x32_bf16 a[132:135], v[208:211], v[100:103], a[132:135]
    v_mfma_f32_16x16x32_bf16 a[136:139], v[208:211], v[104:107], a[136:139]
    v_mfma_f32_16x16x32_bf16 a[140:143], v[208:211], v[108:111], a[140:143]
    ds_read_b128 v[208:211], v6 offset:60416
    s_waitcnt lgkmcnt(8)
    v_mfma_f32_16x16x32_bf16 a[0:3], v[176:179], v[112:115], a[0:3]
    buffer_load_dwordx4 a[184:187], v8, s[16:19], s55 offen offset:384 nt
    v_mfma_f32_16x16x32_bf16 a[4:7], v[176:179], v[116:119], a[4:7]
    v_mfma_f32_16x16x32_bf16 a[8:11], v[176:179], v[120:123], a[8:11]
    buffer_load_dwordx4 a[188:191], v8, s[16:19], s55 offen offset:448 nt
    v_mfma_f32_16x16x32_bf16 a[12:15], v[176:179], v[124:127], a[12:15]
    ds_read_b128 v[176:179], v5 offset:12288
    s_waitcnt lgkmcnt(8)
    v_mfma_f32_16x16x32_bf16 a[16:19], v[180:183], v[112:115], a[16:19]
    v_mfma_f32_16x16x32_bf16 a[20:23], v[180:183], v[116:119], a[20:23]
    v_mfma_f32_16x16x32_bf16 a[24:27], v[180:183], v[120:123], a[24:27]
    s_waitcnt vmcnt(10)
    v_cndmask_b32 v244, v34, v32, s[82:83]
    v_mfma_f32_16x16x32_bf16 a[28:31], v[180:183], v[124:127], a[28:31]
    v_cndmask_b32 v245, v35, v33, s[82:83]
    v_cndmask_b32 v246, v38, v36, s[82:83]
    ds_read_b128 v[180:183], v5 offset:26624
    s_waitcnt lgkmcnt(8)
    v_mfma_f32_16x16x32_bf16 a[32:35], v[184:187], v[112:115], a[32:35]
    v_cndmask_b32 v247, v39, v37, s[82:83]
    v_cndmask_b32 v248, v42, v40, s[82:83]
    v_mfma_f32_16x16x32_bf16 a[36:39], v[184:187], v[116:119], a[36:39]
    v_cndmask_b32 v249, v43, v41, s[82:83]
    v_cndmask_b32 v250, v46, v44, s[82:83]
    v_mfma_f32_16x16x32_bf16 a[40:43], v[184:187], v[120:123], a[40:43]
    v_cndmask_b32 v251, v47, v45, s[82:83]
    v_mov_b32_dpp v244, v244 row_ror:8 row_mask:0xf bank_mask:0xf
    v_mfma_f32_16x16x32_bf16 a[44:47], v[184:187], v[124:127], a[44:47]
    v_mov_b32_dpp v245, v245 row_ror:8 row_mask:0xf bank_mask:0xf
    v_mov_b32_dpp v246, v246 row_ror:8 row_mask:0xf bank_mask:0xf
    ds_read_b128 v[184:187], v5 offset:40960
    s_waitcnt lgkmcnt(8)
    v_mfma_f32_16x16x32_bf16 a[48:51], v[188:191], v[112:115], a[48:51]
    v_mov_b32_dpp v247, v247 row_ror:8 row_mask:0xf bank_mask:0xf
    v_mov_b32_dpp v248, v248 row_ror:8 row_mask:0xf bank_mask:0xf
    v_mfma_f32_16x16x32_bf16 a[52:55], v[188:191], v[116:119], a[52:55]
    v_mov_b32_dpp v249, v249 row_ror:8 row_mask:0xf bank_mask:0xf
    v_mov_b32_dpp v250, v250 row_ror:8 row_mask:0xf bank_mask:0xf
    v_mfma_f32_16x16x32_bf16 a[56:59], v[188:191], v[120:123], a[56:59]
    v_mov_b32_dpp v251, v251 row_ror:8 row_mask:0xf bank_mask:0xf
    v_cndmask_b32 v32, v32, v244, s[82:83]
    v_mfma_f32_16x16x32_bf16 a[60:63], v[188:191], v[124:127], a[60:63]
    v_cndmask_b32 v34, v244, v34, s[82:83]
    v_cndmask_b32 v33, v33, v245, s[82:83]
    ds_read_b128 v[188:191], v5 offset:55296
    s_waitcnt lgkmcnt(8)
    v_mfma_f32_16x16x32_bf16 a[64:67], v[192:195], v[112:115], a[64:67]
    v_cndmask_b32 v35, v245, v35, s[82:83]
    v_cndmask_b32 v36, v36, v246, s[82:83]
    v_mfma_f32_16x16x32_bf16 a[68:71], v[192:195], v[116:119], a[68:71]
    v_cndmask_b32 v38, v246, v38, s[82:83]
    v_cndmask_b32 v37, v37, v247, s[82:83]
    v_mfma_f32_16x16x32_bf16 a[72:75], v[192:195], v[120:123], a[72:75]
    v_cndmask_b32 v39, v247, v39, s[82:83]
    v_cndmask_b32 v40, v40, v248, s[82:83]
    v_mfma_f32_16x16x32_bf16 a[76:79], v[192:195], v[124:127], a[76:79]
    v_cndmask_b32 v42, v248, v42, s[82:83]
    v_cndmask_b32 v41, v41, v249, s[82:83]
    ds_read_b128 v[192:195], v6 offset:4096
    s_waitcnt lgkmcnt(8)
    v_mfma_f32_16x16x32_bf16 a[80:83], v[196:199], v[112:115], a[80:83]
    v_cndmask_b32 v43, v249, v43, s[82:83]
    v_cndmask_b32 v44, v44, v250, s[82:83]
    v_mfma_f32_16x16x32_bf16 a[84:87], v[196:199], v[116:119], a[84:87]
    v_cndmask_b32 v46, v250, v46, s[82:83]
    v_cndmask_b32 v45, v45, v251, s[82:83]
    v_mfma_f32_16x16x32_bf16 a[88:91], v[196:199], v[120:123], a[88:91]
    v_cndmask_b32 v47, v251, v47, s[82:83]
    v_perm_b32 v96, v36, v32, s34
    v_mfma_f32_16x16x32_bf16 a[92:95], v[196:199], v[124:127], a[92:95]
    v_perm_b32 v97, v44, v40, s34
    v_perm_b32 v98, v38, v34, s34
    ds_read_b128 v[196:199], v6 offset:18432
    s_waitcnt lgkmcnt(8)
    v_mfma_f32_16x16x32_bf16 a[96:99], v[200:203], v[112:115], a[96:99]
    v_perm_b32 v99, v46, v42, s34
    v_perm_b32 v100, v36, v32, s35
    v_mfma_f32_16x16x32_bf16 a[100:103], v[200:203], v[116:119], a[100:103]
    v_perm_b32 v101, v44, v40, s35
    v_perm_b32 v102, v38, v34, s35
    v_mfma_f32_16x16x32_bf16 a[104:107], v[200:203], v[120:123], a[104:107]
    v_perm_b32 v103, v46, v42, s35
    v_perm_b32 v104, v37, v33, s34
    v_mfma_f32_16x16x32_bf16 a[108:111], v[200:203], v[124:127], a[108:111]
    v_perm_b32 v105, v45, v41, s34
    v_perm_b32 v106, v39, v35, s34
    ds_read_b128 v[200:203], v6 offset:32768
    s_waitcnt lgkmcnt(8)
    v_mfma_f32_16x16x32_bf16 a[112:115], v[204:207], v[112:115], a[112:115]
    v_perm_b32 v107, v47, v43, s34
    v_perm_b32 v108, v37, v33, s35
    v_mfma_f32_16x16x32_bf16 a[116:119], v[204:207], v[116:119], a[116:119]
    v_perm_b32 v109, v45, v41, s35
    v_perm_b32 v110, v39, v35, s35
    v_mfma_f32_16x16x32_bf16 a[120:123], v[204:207], v[120:123], a[120:123]
    v_perm_b32 v111, v47, v43, s35
    v_mfma_f32_16x16x32_bf16 a[124:127], v[204:207], v[124:127], a[124:127]
    ds_read_b128 v[204:207], v6 offset:47104
    s_waitcnt lgkmcnt(8)
    v_mfma_f32_16x16x32_bf16 a[128:131], v[208:211], v[112:115], a[128:131]
    v_mfma_f32_16x16x32_bf16 a[132:135], v[208:211], v[116:119], a[132:135]
    v_mfma_f32_16x16x32_bf16 a[136:139], v[208:211], v[120:123], a[136:139]
    v_mfma_f32_16x16x32_bf16 a[140:143], v[208:211], v[124:127], a[140:143]
    ds_read_b128 v[208:211], v6 offset:61440
    s_waitcnt lgkmcnt(8)
    v_mfma_f32_16x16x32_bf16 a[0:3], v[176:179], v[96:99], a[0:3]
    buffer_load_dwordx4 a[192:195], v8, s[16:19], s48 offen nt
    v_mfma_f32_16x16x32_bf16 a[4:7], v[176:179], v[100:103], a[4:7]
    v_mfma_f32_16x16x32_bf16 a[8:11], v[176:179], v[104:107], a[8:11]
    buffer_load_dwordx4 a[196:199], v8, s[16:19], s48 offen offset:64 nt
    v_mfma_f32_16x16x32_bf16 a[12:15], v[176:179], v[108:111], a[12:15]
    ds_read_b128 v[176:179], v5 offset:13312
    s_waitcnt lgkmcnt(8)
    v_mfma_f32_16x16x32_bf16 a[16:19], v[180:183], v[96:99], a[16:19]
    v_mfma_f32_16x16x32_bf16 a[20:23], v[180:183], v[100:103], a[20:23]
    v_mfma_f32_16x16x32_bf16 a[24:27], v[180:183], v[104:107], a[24:27]
    s_waitcnt vmcnt(6)
    v_cndmask_b32 v244, v50, v48, s[82:83]
    v_mfma_f32_16x16x32_bf16 a[28:31], v[180:183], v[108:111], a[28:31]
    v_cndmask_b32 v245, v51, v49, s[82:83]
    v_cndmask_b32 v246, v54, v52, s[82:83]
    ds_read_b128 v[180:183], v5 offset:27648
    s_waitcnt lgkmcnt(8)
    v_mfma_f32_16x16x32_bf16 a[32:35], v[184:187], v[96:99], a[32:35]
    v_cndmask_b32 v247, v55, v53, s[82:83]
    v_cndmask_b32 v248, v58, v56, s[82:83]
    v_mfma_f32_16x16x32_bf16 a[36:39], v[184:187], v[100:103], a[36:39]
    v_cndmask_b32 v249, v59, v57, s[82:83]
    v_cndmask_b32 v250, v62, v60, s[82:83]
    v_mfma_f32_16x16x32_bf16 a[40:43], v[184:187], v[104:107], a[40:43]
    v_cndmask_b32 v251, v63, v61, s[82:83]
    v_mov_b32_dpp v244, v244 row_ror:8 row_mask:0xf bank_mask:0xf
    v_mfma_f32_16x16x32_bf16 a[44:47], v[184:187], v[108:111], a[44:47]
    v_mov_b32_dpp v245, v245 row_ror:8 row_mask:0xf bank_mask:0xf
    v_mov_b32_dpp v246, v246 row_ror:8 row_mask:0xf bank_mask:0xf
    ds_read_b128 v[184:187], v5 offset:41984
    s_waitcnt lgkmcnt(8)
    v_mfma_f32_16x16x32_bf16 a[48:51], v[188:191], v[96:99], a[48:51]
    v_mov_b32_dpp v247, v247 row_ror:8 row_mask:0xf bank_mask:0xf
    v_mov_b32_dpp v248, v248 row_ror:8 row_mask:0xf bank_mask:0xf
    v_mfma_f32_16x16x32_bf16 a[52:55], v[188:191], v[100:103], a[52:55]
    v_mov_b32_dpp v249, v249 row_ror:8 row_mask:0xf bank_mask:0xf
    v_mov_b32_dpp v250, v250 row_ror:8 row_mask:0xf bank_mask:0xf
    v_mfma_f32_16x16x32_bf16 a[56:59], v[188:191], v[104:107], a[56:59]
    v_mov_b32_dpp v251, v251 row_ror:8 row_mask:0xf bank_mask:0xf
    v_cndmask_b32 v48, v48, v244, s[82:83]
    v_mfma_f32_16x16x32_bf16 a[60:63], v[188:191], v[108:111], a[60:63]
    v_cndmask_b32 v50, v244, v50, s[82:83]
    v_cndmask_b32 v49, v49, v245, s[82:83]
    ds_read_b128 v[188:191], v5 offset:56320
    s_waitcnt lgkmcnt(8)
    v_mfma_f32_16x16x32_bf16 a[64:67], v[192:195], v[96:99], a[64:67]
    v_cndmask_b32 v51, v245, v51, s[82:83]
    v_cndmask_b32 v52, v52, v246, s[82:83]
    v_mfma_f32_16x16x32_bf16 a[68:71], v[192:195], v[100:103], a[68:71]
    v_cndmask_b32 v54, v246, v54, s[82:83]
    v_cndmask_b32 v53, v53, v247, s[82:83]
    v_mfma_f32_16x16x32_bf16 a[72:75], v[192:195], v[104:107], a[72:75]
    v_cndmask_b32 v55, v247, v55, s[82:83]
    v_cndmask_b32 v56, v56, v248, s[82:83]
    v_mfma_f32_16x16x32_bf16 a[76:79], v[192:195], v[108:111], a[76:79]
    v_cndmask_b32 v58, v248, v58, s[82:83]
    v_cndmask_b32 v57, v57, v249, s[82:83]
    ds_read_b128 v[192:195], v6 offset:5120
    s_waitcnt lgkmcnt(8)
    v_mfma_f32_16x16x32_bf16 a[80:83], v[196:199], v[96:99], a[80:83]
    v_cndmask_b32 v59, v249, v59, s[82:83]
    v_cndmask_b32 v60, v60, v250, s[82:83]
    v_mfma_f32_16x16x32_bf16 a[84:87], v[196:199], v[100:103], a[84:87]
    v_cndmask_b32 v62, v250, v62, s[82:83]
    v_cndmask_b32 v61, v61, v251, s[82:83]
    v_mfma_f32_16x16x32_bf16 a[88:91], v[196:199], v[104:107], a[88:91]
    v_cndmask_b32 v63, v251, v63, s[82:83]
    v_perm_b32 v112, v52, v48, s34
    v_mfma_f32_16x16x32_bf16 a[92:95], v[196:199], v[108:111], a[92:95]
    v_perm_b32 v113, v60, v56, s34
    v_perm_b32 v114, v54, v50, s34
    ds_read_b128 v[196:199], v6 offset:19456
    s_waitcnt lgkmcnt(8)
    v_mfma_f32_16x16x32_bf16 a[96:99], v[200:203], v[96:99], a[96:99]
    v_perm_b32 v115, v62, v58, s34
    v_perm_b32 v116, v52, v48, s35
    v_mfma_f32_16x16x32_bf16 a[100:103], v[200:203], v[100:103], a[100:103]
    v_perm_b32 v117, v60, v56, s35
    v_perm_b32 v118, v54, v50, s35
    v_mfma_f32_16x16x32_bf16 a[104:107], v[200:203], v[104:107], a[104:107]
    v_perm_b32 v119, v62, v58, s35
    v_perm_b32 v120, v53, v49, s34
    v_mfma_f32_16x16x32_bf16 a[108:111], v[200:203], v[108:111], a[108:111]
    v_perm_b32 v121, v61, v57, s34
    v_perm_b32 v122, v55, v51, s34
    ds_read_b128 v[200:203], v6 offset:33792
    s_waitcnt lgkmcnt(8)
    v_mfma_f32_16x16x32_bf16 a[112:115], v[204:207], v[96:99], a[112:115]
    v_perm_b32 v123, v63, v59, s34
    v_perm_b32 v124, v53, v49, s35
    v_mfma_f32_16x16x32_bf16 a[116:119], v[204:207], v[100:103], a[116:119]
    v_perm_b32 v125, v61, v57, s35
    v_perm_b32 v126, v55, v51, s35
    v_mfma_f32_16x16x32_bf16 a[120:123], v[204:207], v[104:107], a[120:123]
    v_perm_b32 v127, v63, v59, s35
    v_mfma_f32_16x16x32_bf16 a[124:127], v[204:207], v[108:111], a[124:127]
    ds_read_b128 v[204:207], v6 offset:48128
    s_waitcnt lgkmcnt(8)
    v_mfma_f32_16x16x32_bf16 a[128:131], v[208:211], v[96:99], a[128:131]
    v_mfma_f32_16x16x32_bf16 a[132:135], v[208:211], v[100:103], a[132:135]
    v_mfma_f32_16x16x32_bf16 a[136:139], v[208:211], v[104:107], a[136:139]
    v_mfma_f32_16x16x32_bf16 a[140:143], v[208:211], v[108:111], a[140:143]
    ds_read_b128 v[208:211], v6 offset:62464
    s_waitcnt lgkmcnt(8)
    v_mfma_f32_16x16x32_bf16 a[0:3], v[176:179], v[112:115], a[0:3]
    buffer_load_dwordx4 a[200:203], v8, s[16:19], s49 offen nt
    v_mfma_f32_16x16x32_bf16 a[4:7], v[176:179], v[116:119], a[4:7]
    v_mfma_f32_16x16x32_bf16 a[8:11], v[176:179], v[120:123], a[8:11]
    buffer_load_dwordx4 a[204:207], v8, s[16:19], s49 offen offset:64 nt
    v_mfma_f32_16x16x32_bf16 a[12:15], v[176:179], v[124:127], a[12:15]
    s_waitcnt lgkmcnt(7)
    v_mfma_f32_16x16x32_bf16 a[16:19], v[180:183], v[112:115], a[16:19]
    v_mfma_f32_16x16x32_bf16 a[20:23], v[180:183], v[116:119], a[20:23]
    v_mfma_f32_16x16x32_bf16 a[24:27], v[180:183], v[120:123], a[24:27]
    v_mfma_f32_16x16x32_bf16 a[28:31], v[180:183], v[124:127], a[28:31]
    s_waitcnt lgkmcnt(6)
    v_mfma_f32_16x16x32_bf16 a[32:35], v[184:187], v[112:115], a[32:35]
    v_mfma_f32_16x16x32_bf16 a[36:39], v[184:187], v[116:119], a[36:39]
    v_mfma_f32_16x16x32_bf16 a[40:43], v[184:187], v[120:123], a[40:43]
    v_mfma_f32_16x16x32_bf16 a[44:47], v[184:187], v[124:127], a[44:47]
    s_waitcnt lgkmcnt(5)
    v_mfma_f32_16x16x32_bf16 a[48:51], v[188:191], v[112:115], a[48:51]
    v_mfma_f32_16x16x32_bf16 a[52:55], v[188:191], v[116:119], a[52:55]
    v_mfma_f32_16x16x32_bf16 a[56:59], v[188:191], v[120:123], a[56:59]
    v_mfma_f32_16x16x32_bf16 a[60:63], v[188:191], v[124:127], a[60:63]
    s_waitcnt lgkmcnt(4)
    v_mfma_f32_16x16x32_bf16 a[64:67], v[192:195], v[112:115], a[64:67]
    v_mfma_f32_16x16x32_bf16 a[68:71], v[192:195], v[116:119], a[68:71]
    v_mfma_f32_16x16x32_bf16 a[72:75], v[192:195], v[120:123], a[72:75]
    v_mfma_f32_16x16x32_bf16 a[76:79], v[192:195], v[124:127], a[76:79]
    s_waitcnt lgkmcnt(3)
    v_mfma_f32_16x16x32_bf16 a[80:83], v[196:199], v[112:115], a[80:83]
    v_mfma_f32_16x16x32_bf16 a[84:87], v[196:199], v[116:119], a[84:87]
    v_mfma_f32_16x16x32_bf16 a[88:91], v[196:199], v[120:123], a[88:91]
    v_mfma_f32_16x16x32_bf16 a[92:95], v[196:199], v[124:127], a[92:95]
    s_waitcnt lgkmcnt(2)
    v_mfma_f32_16x16x32_bf16 a[96:99], v[200:203], v[112:115], a[96:99]
    v_mfma_f32_16x16x32_bf16 a[100:103], v[200:203], v[116:119], a[100:103]
    v_mfma_f32_16x16x32_bf16 a[104:107], v[200:203], v[120:123], a[104:107]
    v_mfma_f32_16x16x32_bf16 a[108:111], v[200:203], v[124:127], a[108:111]
    s_waitcnt lgkmcnt(1)
    v_mfma_f32_16x16x32_bf16 a[112:115], v[204:207], v[112:115], a[112:115]
    v_mfma_f32_16x16x32_bf16 a[116:119], v[204:207], v[116:119], a[116:119]
    v_mfma_f32_16x16x32_bf16 a[120:123], v[204:207], v[120:123], a[120:123]
    v_mfma_f32_16x16x32_bf16 a[124:127], v[204:207], v[124:127], a[124:127]
    s_waitcnt lgkmcnt(0)
    v_mfma_f32_16x16x32_bf16 a[128:131], v[208:211], v[112:115], a[128:131]
    v_mfma_f32_16x16x32_bf16 a[132:135], v[208:211], v[116:119], a[132:135]
    v_mfma_f32_16x16x32_bf16 a[136:139], v[208:211], v[120:123], a[136:139]
    v_mfma_f32_16x16x32_bf16 a[140:143], v[208:211], v[124:127], a[140:143]
    buffer_load_dwordx4 a[208:211], v8, s[16:19], s50 offen nt
    buffer_load_dwordx4 a[212:215], v8, s[16:19], s50 offen offset:64 nt
    buffer_load_dwordx4 a[216:219], v8, s[16:19], s51 offen nt
    buffer_load_dwordx4 a[220:223], v8, s[16:19], s51 offen offset:64 nt
    buffer_load_dwordx4 a[224:227], v8, s[16:19], s48 offen offset:128 nt
    buffer_load_dwordx4 a[228:231], v8, s[16:19], s48 offen offset:192 nt
    buffer_load_dwordx4 a[232:235], v8, s[16:19], s49 offen offset:128 nt
    buffer_load_dwordx4 a[236:239], v8, s[16:19], s49 offen offset:192 nt
    buffer_load_dwordx4 a[240:243], v8, s[16:19], s50 offen offset:128 nt
    buffer_load_dwordx4 a[244:247], v8, s[16:19], s50 offen offset:192 nt
    buffer_load_dwordx4 a[248:251], v8, s[16:19], s51 offen offset:128 nt
    buffer_load_dwordx4 a[252:255], v8, s[16:19], s51 offen offset:192 nt
    s_barrier
    v_and_b32 v28, 1, v27
    v_lshlrev_b32 v28, 3, v28
    v_and_b32 v29, 7, v2
    v_add_u32 v28, v28, v29
    v_lshrrev_b32 v29, 1, v27
    v_lshlrev_b32 v29, 8, v29
    v_lshrrev_b32 v30, 3, v2
    v_lshl_add_u32 v29, v30, 3, v29
    v_lshl_add_u32 v30, v3, 2, 0
    v_xor_b32 v31, v28, v30
    v_lshl_add_u32 v10, v31, 4, v29
    v_lshl_add_u32 v10, v30, 9, v10
    v_add_u32 v14, 32768, v10
    v_lshl_add_u32 v30, v3, 2, 1
    v_xor_b32 v31, v28, v30
    v_lshl_add_u32 v11, v31, 4, v29
    v_lshl_add_u32 v11, v30, 9, v11
    v_add_u32 v15, 32768, v11
    v_lshl_add_u32 v30, v3, 2, 2
    v_xor_b32 v31, v28, v30
    v_lshl_add_u32 v12, v31, 4, v29
    v_lshl_add_u32 v12, v30, 9, v12
    v_add_u32 v16, 32768, v12
    v_lshl_add_u32 v30, v3, 2, 3
    v_xor_b32 v31, v28, v30
    v_lshl_add_u32 v13, v31, 4, v29
    v_lshl_add_u32 v13, v30, 9, v13
    v_add_u32 v17, 32768, v13
    v_accvgpr_read_b32 v244, a0
    v_accvgpr_read_b32 v245, a4
    v_accvgpr_read_b32 v246, a8
    v_accvgpr_read_b32 v247, a12
    v_cvt_pk_bf16_f32 v248, v244, v245
    v_cvt_pk_bf16_f32 v249, v246, v247
    ds_write_b64 v10, v[248:249]
    v_accvgpr_read_b32 v250, a1
    v_accvgpr_read_b32 v251, a5
    v_accvgpr_read_b32 v252, a9
    v_accvgpr_read_b32 v253, a13
    v_cvt_pk_bf16_f32 v254, v250, v251
    v_cvt_pk_bf16_f32 v255, v252, v253
    ds_write_b64 v11, v[254:255]
    v_accvgpr_read_b32 v244, a2
    v_accvgpr_read_b32 v245, a6
    v_accvgpr_read_b32 v246, a10
    v_accvgpr_read_b32 v247, a14
    v_cvt_pk_bf16_f32 v248, v244, v245
    v_cvt_pk_bf16_f32 v249, v246, v247
    ds_write_b64 v12, v[248:249]
    v_accvgpr_read_b32 v250, a3
    v_accvgpr_read_b32 v251, a7
    v_accvgpr_read_b32 v252, a11
    v_accvgpr_read_b32 v253, a15
    v_cvt_pk_bf16_f32 v254, v250, v251
    v_cvt_pk_bf16_f32 v255, v252, v253
    ds_write_b64 v13, v[254:255]
    v_accvgpr_read_b32 v244, a16
    v_accvgpr_read_b32 v245, a20
    v_accvgpr_read_b32 v246, a24
    v_accvgpr_read_b32 v247, a28
    v_cvt_pk_bf16_f32 v248, v244, v245
    v_cvt_pk_bf16_f32 v249, v246, v247
    ds_write_b64 v10, v[248:249] offset:8192
    v_accvgpr_read_b32 v250, a17
    v_accvgpr_read_b32 v251, a21
    v_accvgpr_read_b32 v252, a25
    v_accvgpr_read_b32 v253, a29
    v_cvt_pk_bf16_f32 v254, v250, v251
    v_cvt_pk_bf16_f32 v255, v252, v253
    ds_write_b64 v11, v[254:255] offset:8192
    v_accvgpr_read_b32 v244, a18
    v_accvgpr_read_b32 v245, a22
    v_accvgpr_read_b32 v246, a26
    v_accvgpr_read_b32 v247, a30
    v_cvt_pk_bf16_f32 v248, v244, v245
    v_cvt_pk_bf16_f32 v249, v246, v247
    ds_write_b64 v12, v[248:249] offset:8192
    v_accvgpr_read_b32 v250, a19
    v_accvgpr_read_b32 v251, a23
    v_accvgpr_read_b32 v252, a27
    v_accvgpr_read_b32 v253, a31
    v_cvt_pk_bf16_f32 v254, v250, v251
    v_cvt_pk_bf16_f32 v255, v252, v253
    ds_write_b64 v13, v[254:255] offset:8192
    v_accvgpr_read_b32 v244, a32
    v_accvgpr_read_b32 v245, a36
    v_accvgpr_read_b32 v246, a40
    v_accvgpr_read_b32 v247, a44
    v_cvt_pk_bf16_f32 v248, v244, v245
    v_cvt_pk_bf16_f32 v249, v246, v247
    ds_write_b64 v10, v[248:249] offset:16384
    v_accvgpr_read_b32 v250, a33
    v_accvgpr_read_b32 v251, a37
    v_accvgpr_read_b32 v252, a41
    v_accvgpr_read_b32 v253, a45
    v_cvt_pk_bf16_f32 v254, v250, v251
    v_cvt_pk_bf16_f32 v255, v252, v253
    ds_write_b64 v11, v[254:255] offset:16384
    v_accvgpr_read_b32 v244, a34
    v_accvgpr_read_b32 v245, a38
    v_accvgpr_read_b32 v246, a42
    v_accvgpr_read_b32 v247, a46
    v_cvt_pk_bf16_f32 v248, v244, v245
    v_cvt_pk_bf16_f32 v249, v246, v247
    ds_write_b64 v12, v[248:249] offset:16384
    v_accvgpr_read_b32 v250, a35
    v_accvgpr_read_b32 v251, a39
    v_accvgpr_read_b32 v252, a43
    v_accvgpr_read_b32 v253, a47
    v_cvt_pk_bf16_f32 v254, v250, v251
    v_cvt_pk_bf16_f32 v255, v252, v253
    ds_write_b64 v13, v[254:255] offset:16384
    v_accvgpr_read_b32 v244, a48
    v_accvgpr_read_b32 v245, a52
    v_accvgpr_read_b32 v246, a56
    v_accvgpr_read_b32 v247, a60
    v_cvt_pk_bf16_f32 v248, v244, v245
    v_cvt_pk_bf16_f32 v249, v246, v247
    ds_write_b64 v10, v[248:249] offset:24576
    v_accvgpr_read_b32 v250, a49
    v_accvgpr_read_b32 v251, a53
    v_accvgpr_read_b32 v252, a57
    v_accvgpr_read_b32 v253, a61
    v_cvt_pk_bf16_f32 v254, v250, v251
    v_cvt_pk_bf16_f32 v255, v252, v253
    ds_write_b64 v11, v[254:255] offset:24576
    v_accvgpr_read_b32 v244, a50
    v_accvgpr_read_b32 v245, a54
    v_accvgpr_read_b32 v246, a58
    v_accvgpr_read_b32 v247, a62
    v_cvt_pk_bf16_f32 v248, v244, v245
    v_cvt_pk_bf16_f32 v249, v246, v247
    ds_write_b64 v12, v[248:249] offset:24576
    v_accvgpr_read_b32 v250, a51
    v_accvgpr_read_b32 v251, a55
    v_accvgpr_read_b32 v252, a59
    v_accvgpr_read_b32 v253, a63
    v_cvt_pk_bf16_f32 v254, v250, v251
    v_cvt_pk_bf16_f32 v255, v252, v253
    ds_write_b64 v13, v[254:255] offset:24576
    v_accvgpr_read_b32 v244, a64
    v_accvgpr_read_b32 v245, a68
    v_accvgpr_read_b32 v246, a72
    v_accvgpr_read_b32 v247, a76
    v_cvt_pk_bf16_f32 v248, v244, v245
    v_cvt_pk_bf16_f32 v249, v246, v247
    ds_write_b64 v14, v[248:249]
    v_accvgpr_read_b32 v250, a65
    v_accvgpr_read_b32 v251, a69
    v_accvgpr_read_b32 v252, a73
    v_accvgpr_read_b32 v253, a77
    v_cvt_pk_bf16_f32 v254, v250, v251
    v_cvt_pk_bf16_f32 v255, v252, v253
    ds_write_b64 v15, v[254:255]
    v_accvgpr_read_b32 v244, a66
    v_accvgpr_read_b32 v245, a70
    v_accvgpr_read_b32 v246, a74
    v_accvgpr_read_b32 v247, a78
    v_cvt_pk_bf16_f32 v248, v244, v245
    v_cvt_pk_bf16_f32 v249, v246, v247
    ds_write_b64 v16, v[248:249]
    v_accvgpr_read_b32 v250, a67
    v_accvgpr_read_b32 v251, a71
    v_accvgpr_read_b32 v252, a75
    v_accvgpr_read_b32 v253, a79
    v_cvt_pk_bf16_f32 v254, v250, v251
    v_cvt_pk_bf16_f32 v255, v252, v253
    ds_write_b64 v17, v[254:255]
    v_accvgpr_read_b32 v244, a80
    v_accvgpr_read_b32 v245, a84
    v_accvgpr_read_b32 v246, a88
    v_accvgpr_read_b32 v247, a92
    v_cvt_pk_bf16_f32 v248, v244, v245
    v_cvt_pk_bf16_f32 v249, v246, v247
    ds_write_b64 v14, v[248:249] offset:8192
    v_accvgpr_read_b32 v250, a81
    v_accvgpr_read_b32 v251, a85
    v_accvgpr_read_b32 v252, a89
    v_accvgpr_read_b32 v253, a93
    v_cvt_pk_bf16_f32 v254, v250, v251
    v_cvt_pk_bf16_f32 v255, v252, v253
    ds_write_b64 v15, v[254:255] offset:8192
    v_accvgpr_read_b32 v244, a82
    v_accvgpr_read_b32 v245, a86
    v_accvgpr_read_b32 v246, a90
    v_accvgpr_read_b32 v247, a94
    v_cvt_pk_bf16_f32 v248, v244, v245
    v_cvt_pk_bf16_f32 v249, v246, v247
    ds_write_b64 v16, v[248:249] offset:8192
    v_accvgpr_read_b32 v250, a83
    v_accvgpr_read_b32 v251, a87
    v_accvgpr_read_b32 v252, a91
    v_accvgpr_read_b32 v253, a95
    v_cvt_pk_bf16_f32 v254, v250, v251
    v_cvt_pk_bf16_f32 v255, v252, v253
    ds_write_b64 v17, v[254:255] offset:8192
    v_accvgpr_read_b32 v244, a96
    v_accvgpr_read_b32 v245, a100
    v_accvgpr_read_b32 v246, a104
    v_accvgpr_read_b32 v247, a108
    v_cvt_pk_bf16_f32 v248, v244, v245
    v_cvt_pk_bf16_f32 v249, v246, v247
    ds_write_b64 v14, v[248:249] offset:16384
    v_accvgpr_read_b32 v250, a97
    v_accvgpr_read_b32 v251, a101
    v_accvgpr_read_b32 v252, a105
    v_accvgpr_read_b32 v253, a109
    v_cvt_pk_bf16_f32 v254, v250, v251
    v_cvt_pk_bf16_f32 v255, v252, v253
    ds_write_b64 v15, v[254:255] offset:16384
    v_accvgpr_read_b32 v244, a98
    v_accvgpr_read_b32 v245, a102
    v_accvgpr_read_b32 v246, a106
    v_accvgpr_read_b32 v247, a110
    v_cvt_pk_bf16_f32 v248, v244, v245
    v_cvt_pk_bf16_f32 v249, v246, v247
    ds_write_b64 v16, v[248:249] offset:16384
    v_accvgpr_read_b32 v250, a99
    v_accvgpr_read_b32 v251, a103
    v_accvgpr_read_b32 v252, a107
    v_accvgpr_read_b32 v253, a111
    v_cvt_pk_bf16_f32 v254, v250, v251
    v_cvt_pk_bf16_f32 v255, v252, v253
    ds_write_b64 v17, v[254:255] offset:16384
    v_accvgpr_read_b32 v244, a112
    v_accvgpr_read_b32 v245, a116
    v_accvgpr_read_b32 v246, a120
    v_accvgpr_read_b32 v247, a124
    v_cvt_pk_bf16_f32 v248, v244, v245
    v_cvt_pk_bf16_f32 v249, v246, v247
    ds_write_b64 v14, v[248:249] offset:24576
    v_accvgpr_read_b32 v250, a113
    v_accvgpr_read_b32 v251, a117
    v_accvgpr_read_b32 v252, a121
    v_accvgpr_read_b32 v253, a125
    v_cvt_pk_bf16_f32 v254, v250, v251
    v_cvt_pk_bf16_f32 v255, v252, v253
    ds_write_b64 v15, v[254:255] offset:24576
    v_accvgpr_read_b32 v244, a114
    v_accvgpr_read_b32 v245, a118
    v_accvgpr_read_b32 v246, a122
    v_accvgpr_read_b32 v247, a126
    v_cvt_pk_bf16_f32 v248, v244, v245
    v_cvt_pk_bf16_f32 v249, v246, v247
    ds_write_b64 v16, v[248:249] offset:24576
    v_accvgpr_read_b32 v250, a115
    v_accvgpr_read_b32 v251, a119
    v_accvgpr_read_b32 v252, a123
    v_accvgpr_read_b32 v253, a127
    v_cvt_pk_bf16_f32 v254, v250, v251
    v_cvt_pk_bf16_f32 v255, v252, v253
    ds_write_b64 v17, v[254:255] offset:24576
    v_accvgpr_read_b32 v244, a128
    v_accvgpr_read_b32 v245, a132
    v_accvgpr_read_b32 v246, a136
    v_accvgpr_read_b32 v247, a140
    v_cvt_pk_bf16_f32 v248, v244, v245
    v_cvt_pk_bf16_f32 v249, v246, v247
    ds_write_b64 v14, v[248:249] offset:32768
    v_accvgpr_read_b32 v250, a129
    v_accvgpr_read_b32 v251, a133
    v_accvgpr_read_b32 v252, a137
    v_accvgpr_read_b32 v253, a141
    v_cvt_pk_bf16_f32 v254, v250, v251
    v_cvt_pk_bf16_f32 v255, v252, v253
    ds_write_b64 v15, v[254:255] offset:32768
    v_accvgpr_read_b32 v244, a130
    v_accvgpr_read_b32 v245, a134
    v_accvgpr_read_b32 v246, a138
    v_accvgpr_read_b32 v247, a142
    v_cvt_pk_bf16_f32 v248, v244, v245
    v_cvt_pk_bf16_f32 v249, v246, v247
    ds_write_b64 v16, v[248:249] offset:32768
    v_accvgpr_read_b32 v250, a131
    v_accvgpr_read_b32 v251, a135
    v_accvgpr_read_b32 v252, a139
    v_accvgpr_read_b32 v253, a143
    v_cvt_pk_bf16_f32 v254, v250, v251
    v_cvt_pk_bf16_f32 v255, v252, v253
    ds_write_b64 v17, v[254:255] offset:32768
    s_waitcnt lgkmcnt(0)
    s_barrier
    v_lshl_add_u32 v5, v27, 12, v5
    v_add_u32 v5, 73728, v5
    v_xor_b32 v19, 0, v18
    v_add_u32 v20, 65536, v19
    ds_write_b128 v0, v[128:131]
    ds_read_b128 v[128:131], v5
    ds_write_b128 v0, v[136:139] offset:1024
    ds_read_b128 v[136:139], v5 offset:1024
    ds_write_b128 v0, v[144:147] offset:2048
    ds_read_b128 v[144:147], v5 offset:2048
    ds_write_b128 v0, v[152:155] offset:3072
    ds_read_b128 v[152:155], v5 offset:3072
    ds_read_b128 v[176:179], v19
    ds_read_b128 v[180:183], v19 offset:8192
    ds_read_b128 v[184:187], v19 offset:16384
    ds_read_b128 v[188:191], v19 offset:24576
    ds_read_b128 v[192:195], v19 offset:32768
    ds_read_b128 v[196:199], v19 offset:40960
    ds_read_b128 v[200:203], v19 offset:49152
    ds_read_b128 v[204:207], v19 offset:57344
    ds_read_b128 v[208:211], v20
    v_mul_u32_u24 v28, 28, v27
    v_add_u32 v28, v28, v1
    v_cmp_le_u32 vcc, 56, v28
    s_nop 1
    v_cndmask_b32 v29, 0, 1, vcc
    v_mul_u32_u24 v30, 56, v29
    v_sub_u32 v28, v28, v30
    v_mul_u32_u24 v30, 7168, v29
    v_lshl_add_u32 v96, v28, 4, v30
    s_mul_i32 s92, s2, 14336
    s_add_u32 s93, s92, 3584
    v_lshrrev_b32 v30, 3, v28
    v_lshlrev_b32 v97, 12, v30
    v_and_b32 v30, 7, v28
    v_lshl_add_u32 v97, v30, 5, v97
    v_lshl_add_u32 v97, v29, 8, v97
    s_lshr_b32 s94, s2, 1
    s_mul_i32 s94, s94, 28672
    s_and_b32 s95, s2, 1
    s_lshl_b32 s95, s95, 9
    s_add_u32 s94, s94, s95
    v_xor_b32 v19, 64, v18
    v_add_u32 v20, 65536, v19
    s_waitcnt lgkmcnt(8)
    v_mfma_f32_16x16x32_bf16 a[0:3], v[128:131], v[176:179], 0
    v_mfma_f32_16x16x32_bf16 a[4:7], v[136:139], v[176:179], 0
    v_mfma_f32_16x16x32_bf16 a[8:11], v[144:147], v[176:179], 0
    s_mov_b64 exec, 0xfffffff
    buffer_load_dwordx4 v[32:35], v96, s[88:91], s92 offen
    s_mov_b64 exec, -1
    v_mfma_f32_16x16x32_bf16 a[12:15], v[152:155], v[176:179], 0
    ds_read_b128 v[176:179], v19
    s_waitcnt lgkmcnt(8)
    v_mfma_f32_16x16x32_bf16 a[16:19], v[128:131], v[180:183], 0
    s_mov_b64 exec, 0xfffffff
    buffer_load_dwordx4 v[36:39], v96, s[88:91], s92 offen offset:896
    s_mov_b64 exec, -1
    v_mfma_f32_16x16x32_bf16 a[20:23], v[136:139], v[180:183], 0
    v_mfma_f32_16x16x32_bf16 a[24:27], v[144:147], v[180:183], 0
    s_mov_b64 exec, 0xfffffff
    buffer_load_dwordx4 v[40:43], v96, s[88:91], s92 offen offset:1792
    s_mov_b64 exec, -1
    v_mfma_f32_16x16x32_bf16 a[28:31], v[152:155], v[180:183], 0
    ds_read_b128 v[180:183], v19 offset:8192
    s_waitcnt lgkmcnt(8)
    v_mfma_f32_16x16x32_bf16 a[32:35], v[128:131], v[184:187], 0
    s_mov_b64 exec, 0xfffffff
    buffer_load_dwordx4 v[44:47], v96, s[88:91], s92 offen offset:2688
    s_mov_b64 exec, -1
    v_mfma_f32_16x16x32_bf16 a[36:39], v[136:139], v[184:187], 0
    v_mfma_f32_16x16x32_bf16 a[40:43], v[144:147], v[184:187], 0
    s_mov_b64 exec, 0xfffffff
    buffer_load_dwordx4 v[48:51], v96, s[88:91], s93 offen
    s_mov_b64 exec, -1
    v_mfma_f32_16x16x32_bf16 a[44:47], v[152:155], v[184:187], 0
    ds_read_b128 v[184:187], v19 offset:16384
    s_waitcnt lgkmcnt(8)
    v_mfma_f32_16x16x32_bf16 a[48:51], v[128:131], v[188:191], 0
    v_mfma_f32_16x16x32_bf16 a[52:55], v[136:139], v[188:191], 0
    s_mov_b64 exec, 0xfffffff
    buffer_load_dwordx4 v[52:55], v96, s[88:91], s93 offen offset:896
    s_mov_b64 exec, -1
    v_mfma_f32_16x16x32_bf16 a[56:59], v[144:147], v[188:191], 0
    v_mfma_f32_16x16x32_bf16 a[60:63], v[152:155], v[188:191], 0
    s_mov_b64 exec, 0xfffffff
    buffer_load_dwordx4 v[56:59], v96, s[88:91], s93 offen offset:1792
    s_mov_b64 exec, -1
    ds_read_b128 v[188:191], v19 offset:24576
    s_waitcnt lgkmcnt(8)
    v_mfma_f32_16x16x32_bf16 a[64:67], v[128:131], v[192:195], 0
    v_mfma_f32_16x16x32_bf16 a[68:71], v[136:139], v[192:195], 0
    s_mov_b64 exec, 0xfffffff
    buffer_load_dwordx4 v[60:63], v96, s[88:91], s93 offen offset:2688
    s_mov_b64 exec, -1
    v_mfma_f32_16x16x32_bf16 a[72:75], v[144:147], v[192:195], 0
    v_mfma_f32_16x16x32_bf16 a[76:79], v[152:155], v[192:195], 0
    ds_read_b128 v[192:195], v19 offset:32768
    ds_write_b128 v0, v[132:135]
    ds_read_b128 v[132:135], v5
    s_waitcnt lgkmcnt(10)
    v_mfma_f32_16x16x32_bf16 a[80:83], v[128:131], v[196:199], 0
    v_mfma_f32_16x16x32_bf16 a[84:87], v[136:139], v[196:199], 0
    v_mfma_f32_16x16x32_bf16 a[88:91], v[144:147], v[196:199], 0
    v_mfma_f32_16x16x32_bf16 a[92:95], v[152:155], v[196:199], 0
    ds_read_b128 v[196:199], v19 offset:40960
    ds_write_b128 v0, v[140:143] offset:1024
    ds_read_b128 v[140:143], v5 offset:1024
    s_waitcnt lgkmcnt(12)
    v_mfma_f32_16x16x32_bf16 a[96:99], v[128:131], v[200:203], 0
    v_mfma_f32_16x16x32_bf16 a[100:103], v[136:139], v[200:203], 0
    v_mfma_f32_16x16x32_bf16 a[104:107], v[144:147], v[200:203], 0
    v_mfma_f32_16x16x32_bf16 a[108:111], v[152:155], v[200:203], 0
    ds_read_b128 v[200:203], v19 offset:49152
    ds_write_b128 v0, v[148:151] offset:2048
    ds_read_b128 v[148:151], v5 offset:2048
    s_waitcnt lgkmcnt(14)
    v_mfma_f32_16x16x32_bf16 a[112:115], v[128:131], v[204:207], 0
    v_mfma_f32_16x16x32_bf16 a[116:119], v[136:139], v[204:207], 0
    v_mfma_f32_16x16x32_bf16 a[120:123], v[144:147], v[204:207], 0
    v_mfma_f32_16x16x32_bf16 a[124:127], v[152:155], v[204:207], 0
    ds_read_b128 v[204:207], v19 offset:57344
    ds_write_b128 v0, v[156:159] offset:3072
    ds_read_b128 v[156:159], v5 offset:3072
    s_waitcnt lgkmcnt(15)
    v_mfma_f32_16x16x32_bf16 a[128:131], v[128:131], v[208:211], 0
    v_mfma_f32_16x16x32_bf16 a[132:135], v[136:139], v[208:211], 0
    v_mfma_f32_16x16x32_bf16 a[136:139], v[144:147], v[208:211], 0
    v_mfma_f32_16x16x32_bf16 a[140:143], v[152:155], v[208:211], 0
    ds_read_b128 v[208:211], v20
    v_xor_b32 v19, 128, v18
    v_add_u32 v20, 65536, v19
    s_waitcnt lgkmcnt(10)
    v_mfma_f32_16x16x32_bf16 a[0:3], v[132:135], v[176:179], a[0:3]
    s_waitcnt lgkmcnt(7)
    v_mfma_f32_16x16x32_bf16 a[4:7], v[140:143], v[176:179], a[4:7]
    s_waitcnt lgkmcnt(4)
    v_mfma_f32_16x16x32_bf16 a[8:11], v[148:151], v[176:179], a[8:11]
    s_waitcnt lgkmcnt(1)
    v_mfma_f32_16x16x32_bf16 a[12:15], v[156:159], v[176:179], a[12:15]
    ds_read_b128 v[176:179], v19
    v_mfma_f32_16x16x32_bf16 a[16:19], v[132:135], v[180:183], a[16:19]
    v_mfma_f32_16x16x32_bf16 a[20:23], v[140:143], v[180:183], a[20:23]
    v_mfma_f32_16x16x32_bf16 a[24:27], v[148:151], v[180:183], a[24:27]
    v_mfma_f32_16x16x32_bf16 a[28:31], v[156:159], v[180:183], a[28:31]
    ds_read_b128 v[180:183], v19 offset:8192
    v_mfma_f32_16x16x32_bf16 a[32:35], v[132:135], v[184:187], a[32:35]
    v_mfma_f32_16x16x32_bf16 a[36:39], v[140:143], v[184:187], a[36:39]
    v_mfma_f32_16x16x32_bf16 a[40:43], v[148:151], v[184:187], a[40:43]
    v_mfma_f32_16x16x32_bf16 a[44:47], v[156:159], v[184:187], a[44:47]
    ds_read_b128 v[184:187], v19 offset:16384
    v_mfma_f32_16x16x32_bf16 a[48:51], v[132:135], v[188:191], a[48:51]
    v_mfma_f32_16x16x32_bf16 a[52:55], v[140:143], v[188:191], a[52:55]
    v_mfma_f32_16x16x32_bf16 a[56:59], v[148:151], v[188:191], a[56:59]
    v_mfma_f32_16x16x32_bf16 a[60:63], v[156:159], v[188:191], a[60:63]
    ds_read_b128 v[188:191], v19 offset:24576
    v_mfma_f32_16x16x32_bf16 a[64:67], v[132:135], v[192:195], a[64:67]
    v_mfma_f32_16x16x32_bf16 a[68:71], v[140:143], v[192:195], a[68:71]
    v_mfma_f32_16x16x32_bf16 a[72:75], v[148:151], v[192:195], a[72:75]
    v_mfma_f32_16x16x32_bf16 a[76:79], v[156:159], v[192:195], a[76:79]
    ds_read_b128 v[192:195], v19 offset:32768
    ds_write_b128 v0, v[160:163]
    ds_read_b128 v[160:163], v5
    v_mfma_f32_16x16x32_bf16 a[80:83], v[132:135], v[196:199], a[80:83]
    v_mfma_f32_16x16x32_bf16 a[84:87], v[140:143], v[196:199], a[84:87]
    v_mfma_f32_16x16x32_bf16 a[88:91], v[148:151], v[196:199], a[88:91]
    v_mfma_f32_16x16x32_bf16 a[92:95], v[156:159], v[196:199], a[92:95]
    ds_read_b128 v[196:199], v19 offset:40960
    ds_write_b128 v0, v[168:171] offset:1024
    ds_read_b128 v[168:171], v5 offset:1024
    v_mfma_f32_16x16x32_bf16 a[96:99], v[132:135], v[200:203], a[96:99]
    v_mfma_f32_16x16x32_bf16 a[100:103], v[140:143], v[200:203], a[100:103]
    v_mfma_f32_16x16x32_bf16 a[104:107], v[148:151], v[200:203], a[104:107]
    v_mfma_f32_16x16x32_bf16 a[108:111], v[156:159], v[200:203], a[108:111]
    ds_read_b128 v[200:203], v19 offset:49152
    ds_write_b128 v0, v[212:215] offset:2048
    ds_read_b128 v[212:215], v5 offset:2048
    v_mfma_f32_16x16x32_bf16 a[112:115], v[132:135], v[204:207], a[112:115]
    v_mfma_f32_16x16x32_bf16 a[116:119], v[140:143], v[204:207], a[116:119]
    v_mfma_f32_16x16x32_bf16 a[120:123], v[148:151], v[204:207], a[120:123]
    v_mfma_f32_16x16x32_bf16 a[124:127], v[156:159], v[204:207], a[124:127]
    ds_read_b128 v[204:207], v19 offset:57344
    ds_write_b128 v0, v[220:223] offset:3072
    ds_read_b128 v[220:223], v5 offset:3072
    s_waitcnt lgkmcnt(15)
    v_mfma_f32_16x16x32_bf16 a[128:131], v[132:135], v[208:211], a[128:131]
    v_mfma_f32_16x16x32_bf16 a[132:135], v[140:143], v[208:211], a[132:135]
    v_mfma_f32_16x16x32_bf16 a[136:139], v[148:151], v[208:211], a[136:139]
    v_mfma_f32_16x16x32_bf16 a[140:143], v[156:159], v[208:211], a[140:143]
    ds_read_b128 v[208:211], v20
    v_xor_b32 v19, 192, v18
    v_add_u32 v20, 65536, v19
    s_waitcnt lgkmcnt(10)
    v_mfma_f32_16x16x32_bf16 a[0:3], v[160:163], v[176:179], a[0:3]
    s_waitcnt lgkmcnt(7)
    v_mfma_f32_16x16x32_bf16 a[4:7], v[168:171], v[176:179], a[4:7]
    s_waitcnt lgkmcnt(4)
    v_mfma_f32_16x16x32_bf16 a[8:11], v[212:215], v[176:179], a[8:11]
    s_waitcnt lgkmcnt(1)
    v_mfma_f32_16x16x32_bf16 a[12:15], v[220:223], v[176:179], a[12:15]
    ds_read_b128 v[176:179], v19
    v_mfma_f32_16x16x32_bf16 a[16:19], v[160:163], v[180:183], a[16:19]
    v_mfma_f32_16x16x32_bf16 a[20:23], v[168:171], v[180:183], a[20:23]
    v_mfma_f32_16x16x32_bf16 a[24:27], v[212:215], v[180:183], a[24:27]
    v_mfma_f32_16x16x32_bf16 a[28:31], v[220:223], v[180:183], a[28:31]
    ds_read_b128 v[180:183], v19 offset:8192
    v_mfma_f32_16x16x32_bf16 a[32:35], v[160:163], v[184:187], a[32:35]
    v_mfma_f32_16x16x32_bf16 a[36:39], v[168:171], v[184:187], a[36:39]
    v_mfma_f32_16x16x32_bf16 a[40:43], v[212:215], v[184:187], a[40:43]
    v_mfma_f32_16x16x32_bf16 a[44:47], v[220:223], v[184:187], a[44:47]
    ds_read_b128 v[184:187], v19 offset:16384
    v_mfma_f32_16x16x32_bf16 a[48:51], v[160:163], v[188:191], a[48:51]
    v_mfma_f32_16x16x32_bf16 a[52:55], v[168:171], v[188:191], a[52:55]
    v_mfma_f32_16x16x32_bf16 a[56:59], v[212:215], v[188:191], a[56:59]
    v_mfma_f32_16x16x32_bf16 a[60:63], v[220:223], v[188:191], a[60:63]
    ds_read_b128 v[188:191], v19 offset:24576
    v_mfma_f32_16x16x32_bf16 a[64:67], v[160:163], v[192:195], a[64:67]
    v_mfma_f32_16x16x32_bf16 a[68:71], v[168:171], v[192:195], a[68:71]
    v_mfma_f32_16x16x32_bf16 a[72:75], v[212:215], v[192:195], a[72:75]
    v_mfma_f32_16x16x32_bf16 a[76:79], v[220:223], v[192:195], a[76:79]
    ds_read_b128 v[192:195], v19 offset:32768
    ds_write_b128 v0, v[164:167]
    ds_read_b128 v[164:167], v5
    v_mfma_f32_16x16x32_bf16 a[80:83], v[160:163], v[196:199], a[80:83]
    v_mfma_f32_16x16x32_bf16 a[84:87], v[168:171], v[196:199], a[84:87]
    v_mfma_f32_16x16x32_bf16 a[88:91], v[212:215], v[196:199], a[88:91]
    v_mfma_f32_16x16x32_bf16 a[92:95], v[220:223], v[196:199], a[92:95]
    ds_read_b128 v[196:199], v19 offset:40960
    ds_write_b128 v0, v[172:175] offset:1024
    ds_read_b128 v[172:175], v5 offset:1024
    v_mfma_f32_16x16x32_bf16 a[96:99], v[160:163], v[200:203], a[96:99]
    v_mfma_f32_16x16x32_bf16 a[100:103], v[168:171], v[200:203], a[100:103]
    v_mfma_f32_16x16x32_bf16 a[104:107], v[212:215], v[200:203], a[104:107]
    v_mfma_f32_16x16x32_bf16 a[108:111], v[220:223], v[200:203], a[108:111]
    ds_read_b128 v[200:203], v19 offset:49152
    ds_write_b128 v0, v[216:219] offset:2048
    ds_read_b128 v[216:219], v5 offset:2048
    v_mfma_f32_16x16x32_bf16 a[112:115], v[160:163], v[204:207], a[112:115]
    v_mfma_f32_16x16x32_bf16 a[116:119], v[168:171], v[204:207], a[116:119]
    v_mfma_f32_16x16x32_bf16 a[120:123], v[212:215], v[204:207], a[120:123]
    v_mfma_f32_16x16x32_bf16 a[124:127], v[220:223], v[204:207], a[124:127]
    ds_read_b128 v[204:207], v19 offset:57344
    ds_write_b128 v0, v[224:227] offset:3072
    ds_read_b128 v[224:227], v5 offset:3072
    s_waitcnt lgkmcnt(15)
    v_mfma_f32_16x16x32_bf16 a[128:131], v[160:163], v[208:211], a[128:131]
    v_mfma_f32_16x16x32_bf16 a[132:135], v[168:171], v[208:211], a[132:135]
    v_mfma_f32_16x16x32_bf16 a[136:139], v[212:215], v[208:211], a[136:139]
    v_mfma_f32_16x16x32_bf16 a[140:143], v[220:223], v[208:211], a[140:143]
    ds_read_b128 v[208:211], v20
    v_xor_b32 v19, 0, v18
    v_add_u32 v20, 65536, v19
    s_waitcnt lgkmcnt(10)
    v_mfma_f32_16x16x32_bf16 a[0:3], v[164:167], v[176:179], a[0:3]
    buffer_load_dwordx4 v[212:215], v8, s[16:19], s48 offen offset:256 nt
    buffer_load_dwordx4 v[220:223], v8, s[16:19], s48 offen offset:320 nt
    s_waitcnt lgkmcnt(7)
    v_mfma_f32_16x16x32_bf16 a[4:7], v[172:175], v[176:179], a[4:7]
    s_waitcnt lgkmcnt(4)
    v_mfma_f32_16x16x32_bf16 a[8:11], v[216:219], v[176:179], a[8:11]
    s_waitcnt lgkmcnt(1)
    v_mfma_f32_16x16x32_bf16 a[12:15], v[224:227], v[176:179], a[12:15]
    ds_read_b128 v[176:179], v19 offset:256
    v_mfma_f32_16x16x32_bf16 a[16:19], v[164:167], v[180:183], a[16:19]
    v_mfma_f32_16x16x32_bf16 a[20:23], v[172:175], v[180:183], a[20:23]
    v_mfma_f32_16x16x32_bf16 a[24:27], v[216:219], v[180:183], a[24:27]
    v_mfma_f32_16x16x32_bf16 a[28:31], v[224:227], v[180:183], a[28:31]
    ds_read_b128 v[180:183], v19 offset:8448
    v_mfma_f32_16x16x32_bf16 a[32:35], v[164:167], v[184:187], a[32:35]
    v_mfma_f32_16x16x32_bf16 a[36:39], v[172:175], v[184:187], a[36:39]
    v_mfma_f32_16x16x32_bf16 a[40:43], v[216:219], v[184:187], a[40:43]
    v_mfma_f32_16x16x32_bf16 a[44:47], v[224:227], v[184:187], a[44:47]
    ds_read_b128 v[184:187], v19 offset:16640
    v_mfma_f32_16x16x32_bf16 a[48:51], v[164:167], v[188:191], a[48:51]
    v_mfma_f32_16x16x32_bf16 a[52:55], v[172:175], v[188:191], a[52:55]
    v_mfma_f32_16x16x32_bf16 a[56:59], v[216:219], v[188:191], a[56:59]
    v_mfma_f32_16x16x32_bf16 a[60:63], v[224:227], v[188:191], a[60:63]
    ds_read_b128 v[188:191], v19 offset:24832
    v_mfma_f32_16x16x32_bf16 a[64:67], v[164:167], v[192:195], a[64:67]
    v_mfma_f32_16x16x32_bf16 a[68:71], v[172:175], v[192:195], a[68:71]
    v_mfma_f32_16x16x32_bf16 a[72:75], v[216:219], v[192:195], a[72:75]
    v_mfma_f32_16x16x32_bf16 a[76:79], v[224:227], v[192:195], a[76:79]
    ds_read_b128 v[192:195], v19 offset:33024
    ds_write_b128 v0, v[228:231]
    ds_read_b128 v[228:231], v5
    v_mfma_f32_16x16x32_bf16 a[80:83], v[164:167], v[196:199], a[80:83]
    v_mfma_f32_16x16x32_bf16 a[84:87], v[172:175], v[196:199], a[84:87]
    v_mfma_f32_16x16x32_bf16 a[88:91], v[216:219], v[196:199], a[88:91]
    v_mfma_f32_16x16x32_bf16 a[92:95], v[224:227], v[196:199], a[92:95]
    ds_read_b128 v[196:199], v19 offset:41216
    ds_write_b128 v0, v[236:239] offset:1024
    ds_read_b128 v[236:239], v5 offset:1024
    v_mfma_f32_16x16x32_bf16 a[96:99], v[164:167], v[200:203], a[96:99]
    v_mfma_f32_16x16x32_bf16 a[100:103], v[172:175], v[200:203], a[100:103]
    v_mfma_f32_16x16x32_bf16 a[104:107], v[216:219], v[200:203], a[104:107]
    v_mfma_f32_16x16x32_bf16 a[108:111], v[224:227], v[200:203], a[108:111]
    ds_read_b128 v[200:203], v19 offset:49408
    ds_write_b128 v0, a[144:147] offset:2048
    ds_read_b128 a[144:147], v5 offset:2048
    v_mfma_f32_16x16x32_bf16 a[112:115], v[164:167], v[204:207], a[112:115]
    v_mfma_f32_16x16x32_bf16 a[116:119], v[172:175], v[204:207], a[116:119]
    v_mfma_f32_16x16x32_bf16 a[120:123], v[216:219], v[204:207], a[120:123]
    v_mfma_f32_16x16x32_bf16 a[124:127], v[224:227], v[204:207], a[124:127]
    ds_read_b128 v[204:207], v19 offset:57600
    ds_write_b128 v0, a[152:155] offset:3072
    ds_read_b128 a[152:155], v5 offset:3072
    s_waitcnt lgkmcnt(15)
    v_mfma_f32_16x16x32_bf16 a[128:131], v[164:167], v[208:211], a[128:131]
    v_mfma_f32_16x16x32_bf16 a[132:135], v[172:175], v[208:211], a[132:135]
    v_mfma_f32_16x16x32_bf16 a[136:139], v[216:219], v[208:211], a[136:139]
    v_mfma_f32_16x16x32_bf16 a[140:143], v[224:227], v[208:211], a[140:143]
    ds_read_b128 v[208:211], v20 offset:256
    v_xor_b32 v19, 64, v18
    v_add_u32 v20, 65536, v19
    s_waitcnt lgkmcnt(10)
    v_mfma_f32_16x16x32_bf16 a[0:3], v[228:231], v[176:179], a[0:3]
    buffer_load_dwordx4 v[216:219], v8, s[16:19], s49 offen offset:256 nt
    buffer_load_dwordx4 v[224:227], v8, s[16:19], s49 offen offset:320 nt
    s_waitcnt lgkmcnt(7)
    v_mfma_f32_16x16x32_bf16 a[4:7], v[236:239], v[176:179], a[4:7]
    s_waitcnt lgkmcnt(4)
    v_mfma_f32_16x16x32_bf16 a[8:11], a[144:147], v[176:179], a[8:11]
    s_waitcnt lgkmcnt(1)
    v_mfma_f32_16x16x32_bf16 a[12:15], a[152:155], v[176:179], a[12:15]
    ds_read_b128 v[176:179], v19 offset:256
    v_mfma_f32_16x16x32_bf16 a[16:19], v[228:231], v[180:183], a[16:19]
    v_mfma_f32_16x16x32_bf16 a[20:23], v[236:239], v[180:183], a[20:23]
    v_mfma_f32_16x16x32_bf16 a[24:27], a[144:147], v[180:183], a[24:27]
    v_mfma_f32_16x16x32_bf16 a[28:31], a[152:155], v[180:183], a[28:31]
    ds_read_b128 v[180:183], v19 offset:8448
    v_mfma_f32_16x16x32_bf16 a[32:35], v[228:231], v[184:187], a[32:35]
    v_mfma_f32_16x16x32_bf16 a[36:39], v[236:239], v[184:187], a[36:39]
    v_mfma_f32_16x16x32_bf16 a[40:43], a[144:147], v[184:187], a[40:43]
    v_mfma_f32_16x16x32_bf16 a[44:47], a[152:155], v[184:187], a[44:47]
    ds_read_b128 v[184:187], v19 offset:16640
    v_mfma_f32_16x16x32_bf16 a[48:51], v[228:231], v[188:191], a[48:51]
    v_mfma_f32_16x16x32_bf16 a[52:55], v[236:239], v[188:191], a[52:55]
    v_mfma_f32_16x16x32_bf16 a[56:59], a[144:147], v[188:191], a[56:59]
    v_mfma_f32_16x16x32_bf16 a[60:63], a[152:155], v[188:191], a[60:63]
    ds_read_b128 v[188:191], v19 offset:24832
    v_mfma_f32_16x16x32_bf16 a[64:67], v[228:231], v[192:195], a[64:67]
    v_mfma_f32_16x16x32_bf16 a[68:71], v[236:239], v[192:195], a[68:71]
    v_mfma_f32_16x16x32_bf16 a[72:75], a[144:147], v[192:195], a[72:75]
    v_mfma_f32_16x16x32_bf16 a[76:79], a[152:155], v[192:195], a[76:79]
    ds_read_b128 v[192:195], v19 offset:33024
    ds_write_b128 v0, v[232:235]
    ds_read_b128 v[232:235], v5
    v_mfma_f32_16x16x32_bf16 a[80:83], v[228:231], v[196:199], a[80:83]
    v_mfma_f32_16x16x32_bf16 a[84:87], v[236:239], v[196:199], a[84:87]
    v_mfma_f32_16x16x32_bf16 a[88:91], a[144:147], v[196:199], a[88:91]
    v_mfma_f32_16x16x32_bf16 a[92:95], a[152:155], v[196:199], a[92:95]
    ds_read_b128 v[196:199], v19 offset:41216
    ds_write_b128 v0, v[240:243] offset:1024
    ds_read_b128 v[240:243], v5 offset:1024
    v_mfma_f32_16x16x32_bf16 a[96:99], v[228:231], v[200:203], a[96:99]
    v_mfma_f32_16x16x32_bf16 a[100:103], v[236:239], v[200:203], a[100:103]
    v_mfma_f32_16x16x32_bf16 a[104:107], a[144:147], v[200:203], a[104:107]
    v_mfma_f32_16x16x32_bf16 a[108:111], a[152:155], v[200:203], a[108:111]
    ds_read_b128 v[200:203], v19 offset:49408
    ds_write_b128 v0, a[148:151] offset:2048
    ds_read_b128 a[148:151], v5 offset:2048
    v_mfma_f32_16x16x32_bf16 a[112:115], v[228:231], v[204:207], a[112:115]
    v_mfma_f32_16x16x32_bf16 a[116:119], v[236:239], v[204:207], a[116:119]
    v_mfma_f32_16x16x32_bf16 a[120:123], a[144:147], v[204:207], a[120:123]
    v_mfma_f32_16x16x32_bf16 a[124:127], a[152:155], v[204:207], a[124:127]
    ds_read_b128 v[204:207], v19 offset:57600
    ds_write_b128 v0, a[156:159] offset:3072
    ds_read_b128 a[156:159], v5 offset:3072
    s_waitcnt lgkmcnt(15)
    v_mfma_f32_16x16x32_bf16 a[128:131], v[228:231], v[208:211], a[128:131]
    v_mfma_f32_16x16x32_bf16 a[132:135], v[236:239], v[208:211], a[132:135]
    v_mfma_f32_16x16x32_bf16 a[136:139], a[144:147], v[208:211], a[136:139]
    v_mfma_f32_16x16x32_bf16 a[140:143], a[152:155], v[208:211], a[140:143]
    ds_read_b128 v[208:211], v20 offset:256
    v_xor_b32 v19, 128, v18
    v_add_u32 v20, 65536, v19
    s_waitcnt lgkmcnt(10)
    v_mfma_f32_16x16x32_bf16 a[0:3], v[232:235], v[176:179], a[0:3]
    buffer_load_dwordx4 v[228:231], v8, s[16:19], s50 offen offset:256 nt
    buffer_load_dwordx4 v[236:239], v8, s[16:19], s50 offen offset:320 nt
    buffer_load_dwordx4 a[144:147], v8, s[16:19], s51 offen offset:256 nt
    s_waitcnt vmcnt(7)
    s_waitcnt lgkmcnt(7)
    v_mfma_f32_16x16x32_bf16 a[4:7], v[240:243], v[176:179], a[4:7]
    v_perm_b32 v64, v36, v32, s34
    s_waitcnt lgkmcnt(4)
    v_mfma_f32_16x16x32_bf16 a[8:11], a[148:151], v[176:179], a[8:11]
    v_perm_b32 v65, v44, v40, s34
    s_waitcnt lgkmcnt(1)
    v_mfma_f32_16x16x32_bf16 a[12:15], a[156:159], v[176:179], a[12:15]
    v_perm_b32 v66, v52, v48, s34
    ds_read_b128 v[176:179], v19 offset:256
    v_mfma_f32_16x16x32_bf16 a[16:19], v[232:235], v[180:183], a[16:19]
    v_perm_b32 v67, v60, v56, s34
    v_mfma_f32_16x16x32_bf16 a[20:23], v[240:243], v[180:183], a[20:23]
    v_perm_b32 v68, v36, v32, s35
    v_mfma_f32_16x16x32_bf16 a[24:27], a[148:151], v[180:183], a[24:27]
    v_perm_b32 v69, v44, v40, s35
    v_mfma_f32_16x16x32_bf16 a[28:31], a[156:159], v[180:183], a[28:31]
    v_perm_b32 v70, v52, v48, s35
    ds_read_b128 v[180:183], v19 offset:8448
    v_mfma_f32_16x16x32_bf16 a[32:35], v[232:235], v[184:187], a[32:35]
    v_perm_b32 v71, v60, v56, s35
    v_mfma_f32_16x16x32_bf16 a[36:39], v[240:243], v[184:187], a[36:39]
    v_perm_b32 v72, v37, v33, s34
    v_mfma_f32_16x16x32_bf16 a[40:43], a[148:151], v[184:187], a[40:43]
    v_perm_b32 v73, v45, v41, s34
    v_mfma_f32_16x16x32_bf16 a[44:47], a[156:159], v[184:187], a[44:47]
    buffer_load_dwordx4 a[152:155], v8, s[16:19], s51 offen offset:320 nt
    v_perm_b32 v74, v53, v49, s34
    ds_read_b128 v[184:187], v19 offset:16640
    v_mfma_f32_16x16x32_bf16 a[48:51], v[232:235], v[188:191], a[48:51]
    v_perm_b32 v75, v61, v57, s34
    v_mfma_f32_16x16x32_bf16 a[52:55], v[240:243], v[188:191], a[52:55]
    v_perm_b32 v76, v37, v33, s35
    v_mfma_f32_16x16x32_bf16 a[56:59], a[148:151], v[188:191], a[56:59]
    v_perm_b32 v77, v45, v41, s35
    v_mfma_f32_16x16x32_bf16 a[60:63], a[156:159], v[188:191], a[60:63]
    v_perm_b32 v78, v53, v49, s35
    ds_read_b128 v[188:191], v19 offset:24832
    v_mfma_f32_16x16x32_bf16 a[64:67], v[232:235], v[192:195], a[64:67]
    v_perm_b32 v79, v61, v57, s35
    v_mfma_f32_16x16x32_bf16 a[68:71], v[240:243], v[192:195], a[68:71]
    v_perm_b32 v80, v38, v34, s34
    v_mfma_f32_16x16x32_bf16 a[72:75], a[148:151], v[192:195], a[72:75]
    v_perm_b32 v81, v46, v42, s34
    v_mfma_f32_16x16x32_bf16 a[76:79], a[156:159], v[192:195], a[76:79]
    v_perm_b32 v82, v54, v50, s34
    ds_read_b128 v[192:195], v19 offset:33024
    ds_write_b128 v0, a[160:163]
    ds_read_b128 a[160:163], v5
    v_mfma_f32_16x16x32_bf16 a[80:83], v[232:235], v[196:199], a[80:83]
    v_perm_b32 v83, v62, v58, s34
    v_mfma_f32_16x16x32_bf16 a[84:87], v[240:243], v[196:199], a[84:87]
    v_perm_b32 v84, v38, v34, s35
    v_mfma_f32_16x16x32_bf16 a[88:91], a[148:151], v[196:199], a[88:91]
    v_perm_b32 v85, v46, v42, s35
    v_mfma_f32_16x16x32_bf16 a[92:95], a[156:159], v[196:199], a[92:95]
    v_perm_b32 v86, v54, v50, s35
    ds_read_b128 v[196:199], v19 offset:41216
    ds_write_b128 v0, a[168:171] offset:1024
    ds_read_b128 a[168:171], v5 offset:1024
    v_mfma_f32_16x16x32_bf16 a[96:99], v[232:235], v[200:203], a[96:99]
    v_perm_b32 v87, v62, v58, s35
    v_mfma_f32_16x16x32_bf16 a[100:103], v[240:243], v[200:203], a[100:103]
    v_perm_b32 v88, v39, v35, s34
    v_mfma_f32_16x16x32_bf16 a[104:107], a[148:151], v[200:203], a[104:107]
    v_perm_b32 v89, v47, v43, s34
    v_mfma_f32_16x16x32_bf16 a[108:111], a[156:159], v[200:203], a[108:111]
    v_perm_b32 v90, v55, v51, s34
    ds_read_b128 v[200:203], v19 offset:49408
    ds_write_b128 v0, a[176:179] offset:2048
    ds_read_b128 a[176:179], v5 offset:2048
    v_mfma_f32_16x16x32_bf16 a[112:115], v[232:235], v[204:207], a[112:115]
    v_perm_b32 v91, v63, v59, s34
    v_mfma_f32_16x16x32_bf16 a[116:119], v[240:243], v[204:207], a[116:119]
    v_perm_b32 v92, v39, v35, s35
    v_mfma_f32_16x16x32_bf16 a[120:123], a[148:151], v[204:207], a[120:123]
    v_perm_b32 v93, v47, v43, s35
    v_mfma_f32_16x16x32_bf16 a[124:127], a[156:159], v[204:207], a[124:127]
    v_perm_b32 v94, v55, v51, s35
    ds_read_b128 v[204:207], v19 offset:57600
    ds_write_b128 v0, a[184:187] offset:3072
    ds_read_b128 a[184:187], v5 offset:3072
    s_waitcnt lgkmcnt(15)
    v_mfma_f32_16x16x32_bf16 a[128:131], v[232:235], v[208:211], a[128:131]
    v_perm_b32 v95, v63, v59, s35
    v_mfma_f32_16x16x32_bf16 a[132:135], v[240:243], v[208:211], a[132:135]
    v_mfma_f32_16x16x32_bf16 a[136:139], a[148:151], v[208:211], a[136:139]
    v_mfma_f32_16x16x32_bf16 a[140:143], a[156:159], v[208:211], a[140:143]
    ds_read_b128 v[208:211], v20 offset:256
    v_xor_b32 v19, 192, v18
    v_add_u32 v20, 65536, v19
    s_waitcnt lgkmcnt(10)
    v_mfma_f32_16x16x32_bf16 a[0:3], a[160:163], v[176:179], a[0:3]
    s_mov_b64 exec, 0xfffffff
    buffer_store_dwordx4 v[64:67], v97, s[84:87], s94 offen
    s_mov_b64 exec, -1
    s_mov_b64 exec, 0xfffffff
    buffer_store_dwordx4 v[68:71], v97, s[84:87], s94 offen offset:1024
    s_mov_b64 exec, -1
    s_mov_b64 exec, 0xfffffff
    buffer_store_dwordx4 v[72:75], v97, s[84:87], s94 offen offset:2048
    s_mov_b64 exec, -1
    s_mov_b64 exec, 0xfffffff
    buffer_store_dwordx4 v[76:79], v97, s[84:87], s94 offen offset:3072
    s_mov_b64 exec, -1
    s_mov_b64 exec, 0xfffffff
    buffer_store_dwordx4 v[80:83], v97, s[84:87], s94 offen offset:16
    s_mov_b64 exec, -1
    s_mov_b64 exec, 0xfffffff
    buffer_store_dwordx4 v[84:87], v97, s[84:87], s94 offen offset:1040
    s_mov_b64 exec, -1
    s_mov_b64 exec, 0xfffffff
    buffer_store_dwordx4 v[88:91], v97, s[84:87], s94 offen offset:2064
    s_mov_b64 exec, -1
    s_mov_b64 exec, 0xfffffff
    buffer_store_dwordx4 v[92:95], v97, s[84:87], s94 offen offset:3088
    s_mov_b64 exec, -1
    s_waitcnt lgkmcnt(7)
    v_mfma_f32_16x16x32_bf16 a[4:7], a[168:171], v[176:179], a[4:7]
    s_waitcnt lgkmcnt(4)
    v_mfma_f32_16x16x32_bf16 a[8:11], a[176:179], v[176:179], a[8:11]
    s_waitcnt lgkmcnt(1)
    v_mfma_f32_16x16x32_bf16 a[12:15], a[184:187], v[176:179], a[12:15]
    ds_read_b128 v[176:179], v19 offset:256
    v_mfma_f32_16x16x32_bf16 a[16:19], a[160:163], v[180:183], a[16:19]
    v_mfma_f32_16x16x32_bf16 a[20:23], a[168:171], v[180:183], a[20:23]
    v_mfma_f32_16x16x32_bf16 a[24:27], a[176:179], v[180:183], a[24:27]
    v_mfma_f32_16x16x32_bf16 a[28:31], a[184:187], v[180:183], a[28:31]
    ds_read_b128 v[180:183], v19 offset:8448
    v_mfma_f32_16x16x32_bf16 a[32:35], a[160:163], v[184:187], a[32:35]
    v_mfma_f32_16x16x32_bf16 a[36:39], a[168:171], v[184:187], a[36:39]
    v_mfma_f32_16x16x32_bf16 a[40:43], a[176:179], v[184:187], a[40:43]
    v_mfma_f32_16x16x32_bf16 a[44:47], a[184:187], v[184:187], a[44:47]
    ds_read_b128 v[184:187], v19 offset:16640
    v_mfma_f32_16x16x32_bf16 a[48:51], a[160:163], v[188:191], a[48:51]
    v_mfma_f32_16x16x32_bf16 a[52:55], a[168:171], v[188:191], a[52:55]
    v_mfma_f32_16x16x32_bf16 a[56:59], a[176:179], v[188:191], a[56:59]
    buffer_load_dwordx4 v[232:235], v8, s[16:19], s48 offen offset:384 nt
    v_mfma_f32_16x16x32_bf16 a[60:63], a[184:187], v[188:191], a[60:63]
    ds_read_b128 v[188:191], v19 offset:24832
    v_mfma_f32_16x16x32_bf16 a[64:67], a[160:163], v[192:195], a[64:67]
    v_mfma_f32_16x16x32_bf16 a[68:71], a[168:171], v[192:195], a[68:71]
    v_mfma_f32_16x16x32_bf16 a[72:75], a[176:179], v[192:195], a[72:75]
    v_mfma_f32_16x16x32_bf16 a[76:79], a[184:187], v[192:195], a[76:79]
    ds_read_b128 v[192:195], v19 offset:33024
    ds_write_b128 v0, a[164:167]
    ds_read_b128 a[164:167], v5
    v_mfma_f32_16x16x32_bf16 a[80:83], a[160:163], v[196:199], a[80:83]
    v_mfma_f32_16x16x32_bf16 a[84:87], a[168:171], v[196:199], a[84:87]
    v_mfma_f32_16x16x32_bf16 a[88:91], a[176:179], v[196:199], a[88:91]
    v_mfma_f32_16x16x32_bf16 a[92:95], a[184:187], v[196:199], a[92:95]
    ds_read_b128 v[196:199], v19 offset:41216
    ds_write_b128 v0, a[172:175] offset:1024
    ds_read_b128 a[172:175], v5 offset:1024
    v_mfma_f32_16x16x32_bf16 a[96:99], a[160:163], v[200:203], a[96:99]
    v_mfma_f32_16x16x32_bf16 a[100:103], a[168:171], v[200:203], a[100:103]
    v_mfma_f32_16x16x32_bf16 a[104:107], a[176:179], v[200:203], a[104:107]
    v_mfma_f32_16x16x32_bf16 a[108:111], a[184:187], v[200:203], a[108:111]
    ds_read_b128 v[200:203], v19 offset:49408
    ds_write_b128 v0, a[180:183] offset:2048
    ds_read_b128 a[180:183], v5 offset:2048
    v_mfma_f32_16x16x32_bf16 a[112:115], a[160:163], v[204:207], a[112:115]
    v_mfma_f32_16x16x32_bf16 a[116:119], a[168:171], v[204:207], a[116:119]
    v_mfma_f32_16x16x32_bf16 a[120:123], a[176:179], v[204:207], a[120:123]
    v_mfma_f32_16x16x32_bf16 a[124:127], a[184:187], v[204:207], a[124:127]
    ds_read_b128 v[204:207], v19 offset:57600
    ds_write_b128 v0, a[188:191] offset:3072
    ds_read_b128 a[188:191], v5 offset:3072
    s_waitcnt lgkmcnt(15)
    v_mfma_f32_16x16x32_bf16 a[128:131], a[160:163], v[208:211], a[128:131]
    v_mfma_f32_16x16x32_bf16 a[132:135], a[168:171], v[208:211], a[132:135]
    v_mfma_f32_16x16x32_bf16 a[136:139], a[176:179], v[208:211], a[136:139]
    v_mfma_f32_16x16x32_bf16 a[140:143], a[184:187], v[208:211], a[140:143]
    ds_read_b128 v[208:211], v20 offset:256
    v_xor_b32 v19, 0, v18
    v_add_u32 v20, 65536, v19
    s_waitcnt lgkmcnt(10)
    v_mfma_f32_16x16x32_bf16 a[0:3], a[164:167], v[176:179], a[0:3]
    buffer_load_dwordx4 v[240:243], v8, s[16:19], s48 offen offset:448 nt
    s_waitcnt lgkmcnt(7)
    v_mfma_f32_16x16x32_bf16 a[4:7], a[172:175], v[176:179], a[4:7]
    s_waitcnt lgkmcnt(4)
    v_mfma_f32_16x16x32_bf16 a[8:11], a[180:183], v[176:179], a[8:11]
    s_waitcnt lgkmcnt(1)
    v_mfma_f32_16x16x32_bf16 a[12:15], a[188:191], v[176:179], a[12:15]
    ds_read_b128 v[176:179], v19
    v_mfma_f32_16x16x32_bf16 a[16:19], a[164:167], v[180:183], a[16:19]
    v_mfma_f32_16x16x32_bf16 a[20:23], a[172:175], v[180:183], a[20:23]
    v_mfma_f32_16x16x32_bf16 a[24:27], a[180:183], v[180:183], a[24:27]
    v_mfma_f32_16x16x32_bf16 a[28:31], a[188:191], v[180:183], a[28:31]
    ds_read_b128 v[180:183], v19 offset:8192
    v_mfma_f32_16x16x32_bf16 a[32:35], a[164:167], v[184:187], a[32:35]
    v_mfma_f32_16x16x32_bf16 a[36:39], a[172:175], v[184:187], a[36:39]
    v_mfma_f32_16x16x32_bf16 a[40:43], a[180:183], v[184:187], a[40:43]
    v_mfma_f32_16x16x32_bf16 a[44:47], a[188:191], v[184:187], a[44:47]
    ds_read_b128 v[184:187], v19 offset:16384
    v_mfma_f32_16x16x32_bf16 a[48:51], a[164:167], v[188:191], a[48:51]
    v_mfma_f32_16x16x32_bf16 a[52:55], a[172:175], v[188:191], a[52:55]
    v_mfma_f32_16x16x32_bf16 a[56:59], a[180:183], v[188:191], a[56:59]
    v_mfma_f32_16x16x32_bf16 a[60:63], a[188:191], v[188:191], a[60:63]
    ds_read_b128 v[188:191], v19 offset:24576
    v_mfma_f32_16x16x32_bf16 a[64:67], a[164:167], v[192:195], a[64:67]
    v_mfma_f32_16x16x32_bf16 a[68:71], a[172:175], v[192:195], a[68:71]
    v_mfma_f32_16x16x32_bf16 a[72:75], a[180:183], v[192:195], a[72:75]
    v_mfma_f32_16x16x32_bf16 a[76:79], a[188:191], v[192:195], a[76:79]
    ds_read_b128 v[192:195], v19 offset:32768
    ds_write_b128 v0, a[192:195]
    ds_read_b128 a[192:195], v5
    v_mfma_f32_16x16x32_bf16 a[80:83], a[164:167], v[196:199], a[80:83]
    v_mfma_f32_16x16x32_bf16 a[84:87], a[172:175], v[196:199], a[84:87]
    buffer_load_dwordx4 a[148:151], v8, s[16:19], s49 offen offset:384 nt
    v_mfma_f32_16x16x32_bf16 a[88:91], a[180:183], v[196:199], a[88:91]
    v_mfma_f32_16x16x32_bf16 a[92:95], a[188:191], v[196:199], a[92:95]
    ds_read_b128 v[196:199], v19 offset:40960
    ds_write_b128 v0, a[200:203] offset:1024
    ds_read_b128 a[200:203], v5 offset:1024
    v_mfma_f32_16x16x32_bf16 a[96:99], a[164:167], v[200:203], a[96:99]
    v_mfma_f32_16x16x32_bf16 a[100:103], a[172:175], v[200:203], a[100:103]
    v_mfma_f32_16x16x32_bf16 a[104:107], a[180:183], v[200:203], a[104:107]
    v_mfma_f32_16x16x32_bf16 a[108:111], a[188:191], v[200:203], a[108:111]
    ds_read_b128 v[200:203], v19 offset:49152
    ds_write_b128 v0, a[208:211] offset:2048
    ds_read_b128 a[208:211], v5 offset:2048
    v_mfma_f32_16x16x32_bf16 a[112:115], a[164:167], v[204:207], a[112:115]
    v_mfma_f32_16x16x32_bf16 a[116:119], a[172:175], v[204:207], a[116:119]
    v_mfma_f32_16x16x32_bf16 a[120:123], a[180:183], v[204:207], a[120:123]
    v_mfma_f32_16x16x32_bf16 a[124:127], a[188:191], v[204:207], a[124:127]
    ds_read_b128 v[204:207], v19 offset:57344
    ds_write_b128 v0, a[216:219] offset:3072
    ds_read_b128 a[216:219], v5 offset:3072
    s_waitcnt lgkmcnt(15)
    v_mfma_f32_16x16x32_bf16 a[128:131], a[164:167], v[208:211], a[128:131]
    v_mfma_f32_16x16x32_bf16 a[132:135], a[172:175], v[208:211], a[132:135]
    v_mfma_f32_16x16x32_bf16 a[136:139], a[180:183], v[208:211], a[136:139]
    v_mfma_f32_16x16x32_bf16 a[140:143], a[188:191], v[208:211], a[140:143]
    ds_read_b128 v[208:211], v20
    v_xor_b32 v19, 64, v18
    v_add_u32 v20, 65536, v19
    s_waitcnt lgkmcnt(10)
    v_mfma_f32_16x16x32_bf16 v[32:35], a[192:195], v[176:179], 0
    v_accvgpr_read_b32 v10, a0
    s_waitcnt lgkmcnt(7)
    v_mfma_f32_16x16x32_bf16 v[36:39], a[200:203], v[176:179], 0
    v_accvgpr_read_b32 v11, a1
    s_waitcnt lgkmcnt(4)
    v_mfma_f32_16x16x32_bf16 v[40:43], a[208:211], v[176:179], 0
    v_accvgpr_read_b32 v12, a2
    s_waitcnt lgkmcnt(1)
    v_mfma_f32_16x16x32_bf16 v[44:47], a[216:219], v[176:179], 0
    v_accvgpr_read_b32 v13, a3
    ds_read_b128 v[176:179], v19
    v_mfma_f32_16x16x32_bf16 v[48:51], a[192:195], v[180:183], 0
    v_accvgpr_read_b32 v14, a4
    v_mfma_f32_16x16x32_bf16 v[52:55], a[200:203], v[180:183], 0
    v_accvgpr_read_b32 v15, a5
    v_mfma_f32_16x16x32_bf16 v[56:59], a[208:211], v[180:183], 0
    v_accvgpr_read_b32 v16, a6
    v_mfma_f32_16x16x32_bf16 v[60:63], a[216:219], v[180:183], 0
    buffer_load_dwordx4 a[156:159], v8, s[16:19], s49 offen offset:448 nt
    v_accvgpr_read_b32 v17, a7
    ds_read_b128 v[180:183], v19 offset:8192
    v_mfma_f32_16x16x32_bf16 v[64:67], a[192:195], v[184:187], 0
    v_max3_f32 v244, v10, v11, v12
    v_mfma_f32_16x16x32_bf16 v[68:71], a[200:203], v[184:187], 0
    v_max3_f32 v244, v13, v14, v244
    v_mfma_f32_16x16x32_bf16 v[72:75], a[208:211], v[184:187], 0
    v_max3_f32 v244, v15, v16, v244
    v_mfma_f32_16x16x32_bf16 v[76:79], a[216:219], v[184:187], 0
    v_max_f32 v244, v17, v244
    ds_read_b128 v[184:187], v19 offset:16384
    v_mfma_f32_16x16x32_bf16 v[80:83], a[192:195], v[188:191], 0
    v_accvgpr_read_b32 v10, a8
    v_mfma_f32_16x16x32_bf16 v[84:87], a[200:203], v[188:191], 0
    v_accvgpr_read_b32 v11, a9
    v_mfma_f32_16x16x32_bf16 v[88:91], a[208:211], v[188:191], 0
    v_accvgpr_read_b32 v12, a10
    v_mfma_f32_16x16x32_bf16 v[92:95], a[216:219], v[188:191], 0
    v_accvgpr_read_b32 v13, a11
    ds_read_b128 v[188:191], v19 offset:24576
    v_mfma_f32_16x16x32_bf16 v[96:99], a[192:195], v[192:195], 0
    v_accvgpr_read_b32 v14, a12
    v_mfma_f32_16x16x32_bf16 v[100:103], a[200:203], v[192:195], 0
    v_accvgpr_read_b32 v15, a13
    v_mfma_f32_16x16x32_bf16 v[104:107], a[208:211], v[192:195], 0
    v_accvgpr_read_b32 v16, a14
    v_mfma_f32_16x16x32_bf16 v[108:111], a[216:219], v[192:195], 0
    v_accvgpr_read_b32 v17, a15
    ds_read_b128 v[192:195], v19 offset:32768
    ds_write_b128 v0, a[196:199]
    ds_read_b128 a[196:199], v5
    v_mfma_f32_16x16x32_bf16 v[112:115], a[192:195], v[196:199], 0
    v_max3_f32 v244, v10, v11, v244
    v_mfma_f32_16x16x32_bf16 v[116:119], a[200:203], v[196:199], 0
    v_max_f32 v244, v12, v244
    v_mfma_f32_16x16x32_bf16 v[120:123], a[208:211], v[196:199], 0
    v_max3_f32 v244, v13, v14, v244
    v_mfma_f32_16x16x32_bf16 v[124:127], a[216:219], v[196:199], 0
    v_max3_f32 v244, v15, v16, v244
    ds_read_b128 v[196:199], v19 offset:40960
    ds_write_b128 v0, a[204:207] offset:1024
    ds_read_b128 a[204:207], v5 offset:1024
    v_mfma_f32_16x16x32_bf16 v[128:131], a[192:195], v[200:203], 0
    v_max_f32 v244, v17, v244
    v_mfma_f32_16x16x32_bf16 v[132:135], a[200:203], v[200:203], 0
    v_accvgpr_read_b32 v10, a16
    v_mfma_f32_16x16x32_bf16 v[136:139], a[208:211], v[200:203], 0
    v_accvgpr_read_b32 v11, a17
    v_mfma_f32_16x16x32_bf16 v[140:143], a[216:219], v[200:203], 0
    v_accvgpr_read_b32 v12, a18
    ds_read_b128 v[200:203], v19 offset:49152
    ds_write_b128 v0, a[212:215] offset:2048
    ds_read_b128 a[212:215], v5 offset:2048
    v_mfma_f32_16x16x32_bf16 v[144:147], a[192:195], v[204:207], 0
    v_accvgpr_read_b32 v13, a19
    v_mfma_f32_16x16x32_bf16 v[148:151], a[200:203], v[204:207], 0
    buffer_load_dwordx4 a[160:163], v8, s[16:19], s50 offen offset:384 nt
    v_accvgpr_read_b32 v14, a20
    v_mfma_f32_16x16x32_bf16 v[152:155], a[208:211], v[204:207], 0
    v_accvgpr_read_b32 v15, a21
    v_mfma_f32_16x16x32_bf16 v[156:159], a[216:219], v[204:207], 0
    v_accvgpr_read_b32 v16, a22
    ds_read_b128 v[204:207], v19 offset:57344
    ds_write_b128 v0, a[220:223] offset:3072
    ds_read_b128 a[220:223], v5 offset:3072
    s_waitcnt lgkmcnt(15)
    v_mfma_f32_16x16x32_bf16 v[160:163], a[192:195], v[208:211], 0
    v_accvgpr_read_b32 v17, a23
    v_mfma_f32_16x16x32_bf16 v[164:167], a[200:203], v[208:211], 0
    v_max3_f32 v245, v10, v11, v12
    v_mfma_f32_16x16x32_bf16 v[168:171], a[208:211], v[208:211], 0
    v_max3_f32 v245, v13, v14, v245
    v_mfma_f32_16x16x32_bf16 v[172:175], a[216:219], v[208:211], 0
    v_max3_f32 v245, v15, v16, v245
    ds_read_b128 v[208:211], v20
    v_xor_b32 v19, 128, v18
    v_add_u32 v20, 65536, v19
    s_waitcnt lgkmcnt(10)
    v_mfma_f32_16x16x32_bf16 v[32:35], a[196:199], v[176:179], v[32:35]
    v_max_f32 v245, v17, v245
    s_waitcnt lgkmcnt(7)
    v_mfma_f32_16x16x32_bf16 v[36:39], a[204:207], v[176:179], v[36:39]
    v_accvgpr_read_b32 v10, a24
    s_waitcnt lgkmcnt(4)
    v_mfma_f32_16x16x32_bf16 v[40:43], a[212:215], v[176:179], v[40:43]
    v_accvgpr_read_b32 v11, a25
    s_waitcnt lgkmcnt(1)
    v_mfma_f32_16x16x32_bf16 v[44:47], a[220:223], v[176:179], v[44:47]
    v_accvgpr_read_b32 v12, a26
    ds_read_b128 v[176:179], v19
    v_mfma_f32_16x16x32_bf16 v[48:51], a[196:199], v[180:183], v[48:51]
    v_accvgpr_read_b32 v13, a27
    v_mfma_f32_16x16x32_bf16 v[52:55], a[204:207], v[180:183], v[52:55]
    v_accvgpr_read_b32 v14, a28
    v_mfma_f32_16x16x32_bf16 v[56:59], a[212:215], v[180:183], v[56:59]
    v_accvgpr_read_b32 v15, a29
    v_mfma_f32_16x16x32_bf16 v[60:63], a[220:223], v[180:183], v[60:63]
    v_accvgpr_read_b32 v16, a30
    ds_read_b128 v[180:183], v19 offset:8192
    v_mfma_f32_16x16x32_bf16 v[64:67], a[196:199], v[184:187], v[64:67]
    v_accvgpr_read_b32 v17, a31
    v_mfma_f32_16x16x32_bf16 v[68:71], a[204:207], v[184:187], v[68:71]
    v_max3_f32 v245, v10, v11, v245
    v_mfma_f32_16x16x32_bf16 v[72:75], a[212:215], v[184:187], v[72:75]
    v_max_f32 v245, v12, v245
    v_mfma_f32_16x16x32_bf16 v[76:79], a[220:223], v[184:187], v[76:79]
    v_max3_f32 v245, v13, v14, v245
    ds_read_b128 v[184:187], v19 offset:16384
    v_mfma_f32_16x16x32_bf16 v[80:83], a[196:199], v[188:191], v[80:83]
    v_max3_f32 v245, v15, v16, v245
    v_mfma_f32_16x16x32_bf16 v[84:87], a[204:207], v[188:191], v[84:87]
    v_max_f32 v245, v17, v245
    v_mfma_f32_16x16x32_bf16 v[88:91], a[212:215], v[188:191], v[88:91]
    v_accvgpr_read_b32 v10, a32
    v_mfma_f32_16x16x32_bf16 v[92:95], a[220:223], v[188:191], v[92:95]
    buffer_load_dwordx4 a[168:171], v8, s[16:19], s50 offen offset:448 nt
    v_accvgpr_read_b32 v11, a33
    ds_read_b128 v[188:191], v19 offset:24576
    v_mfma_f32_16x16x32_bf16 v[96:99], a[196:199], v[192:195], v[96:99]
    v_accvgpr_read_b32 v12, a34
    v_mfma_f32_16x16x32_bf16 v[100:103], a[204:207], v[192:195], v[100:103]
    v_accvgpr_read_b32 v13, a35
    v_mfma_f32_16x16x32_bf16 v[104:107], a[212:215], v[192:195], v[104:107]
    v_accvgpr_read_b32 v14, a36
    v_mfma_f32_16x16x32_bf16 v[108:111], a[220:223], v[192:195], v[108:111]
    v_accvgpr_read_b32 v15, a37
    ds_read_b128 v[192:195], v19 offset:32768
    ds_write_b128 v0, a[224:227]
    ds_read_b128 a[224:227], v5
    v_mfma_f32_16x16x32_bf16 v[112:115], a[196:199], v[196:199], v[112:115]
    v_accvgpr_read_b32 v16, a38
    v_mfma_f32_16x16x32_bf16 v[116:119], a[204:207], v[196:199], v[116:119]
    v_accvgpr_read_b32 v17, a39
    v_mfma_f32_16x16x32_bf16 v[120:123], a[212:215], v[196:199], v[120:123]
    v_max3_f32 v246, v10, v11, v12
    v_mfma_f32_16x16x32_bf16 v[124:127], a[220:223], v[196:199], v[124:127]
    v_max3_f32 v246, v13, v14, v246
    ds_read_b128 v[196:199], v19 offset:40960
    ds_write_b128 v0, a[232:235] offset:1024
    ds_read_b128 a[232:235], v5 offset:1024
    v_mfma_f32_16x16x32_bf16 v[128:131], a[196:199], v[200:203], v[128:131]
    v_max3_f32 v246, v15, v16, v246
    v_mfma_f32_16x16x32_bf16 v[132:135], a[204:207], v[200:203], v[132:135]
    v_max_f32 v246, v17, v246
    v_mfma_f32_16x16x32_bf16 v[136:139], a[212:215], v[200:203], v[136:139]
    v_accvgpr_read_b32 v10, a40
    v_mfma_f32_16x16x32_bf16 v[140:143], a[220:223], v[200:203], v[140:143]
    v_accvgpr_read_b32 v11, a41
    ds_read_b128 v[200:203], v19 offset:49152
    ds_write_b128 v0, a[240:243] offset:2048
    ds_read_b128 a[240:243], v5 offset:2048
    v_mfma_f32_16x16x32_bf16 v[144:147], a[196:199], v[204:207], v[144:147]
    v_accvgpr_read_b32 v12, a42
    v_mfma_f32_16x16x32_bf16 v[148:151], a[204:207], v[204:207], v[148:151]
    v_accvgpr_read_b32 v13, a43
    v_mfma_f32_16x16x32_bf16 v[152:155], a[212:215], v[204:207], v[152:155]
    v_accvgpr_read_b32 v14, a44
    v_mfma_f32_16x16x32_bf16 v[156:159], a[220:223], v[204:207], v[156:159]
    v_accvgpr_read_b32 v15, a45
    ds_read_b128 v[204:207], v19 offset:57344
    ds_write_b128 v0, a[248:251] offset:3072
    ds_read_b128 a[248:251], v5 offset:3072
    s_waitcnt lgkmcnt(15)
    v_mfma_f32_16x16x32_bf16 v[160:163], a[196:199], v[208:211], v[160:163]
    v_accvgpr_read_b32 v16, a46
    v_mfma_f32_16x16x32_bf16 v[164:167], a[204:207], v[208:211], v[164:167]
    v_accvgpr_read_b32 v17, a47
    v_mfma_f32_16x16x32_bf16 v[168:171], a[212:215], v[208:211], v[168:171]
    v_max3_f32 v246, v10, v11, v246
    v_mfma_f32_16x16x32_bf16 v[172:175], a[220:223], v[208:211], v[172:175]
    v_max_f32 v246, v12, v246
    ds_read_b128 v[208:211], v20
    v_xor_b32 v19, 192, v18
    v_add_u32 v20, 65536, v19
    s_waitcnt lgkmcnt(10)
    v_mfma_f32_16x16x32_bf16 v[32:35], a[224:227], v[176:179], v[32:35]
    buffer_load_dwordx4 a[176:179], v8, s[16:19], s51 offen offset:384 nt
    v_max3_f32 v246, v13, v14, v246
    s_waitcnt lgkmcnt(7)
    v_mfma_f32_16x16x32_bf16 v[36:39], a[232:235], v[176:179], v[36:39]
    v_max3_f32 v246, v15, v16, v246
    s_waitcnt lgkmcnt(4)
    v_mfma_f32_16x16x32_bf16 v[40:43], a[240:243], v[176:179], v[40:43]
    v_max_f32 v246, v17, v246
    s_waitcnt lgkmcnt(1)
    v_mfma_f32_16x16x32_bf16 v[44:47], a[248:251], v[176:179], v[44:47]
    v_accvgpr_read_b32 v10, a48
    ds_read_b128 v[176:179], v19
    v_mfma_f32_16x16x32_bf16 v[48:51], a[224:227], v[180:183], v[48:51]
    v_accvgpr_read_b32 v11, a49
    v_mfma_f32_16x16x32_bf16 v[52:55], a[232:235], v[180:183], v[52:55]
    v_accvgpr_read_b32 v12, a50
    v_mfma_f32_16x16x32_bf16 v[56:59], a[240:243], v[180:183], v[56:59]
    v_accvgpr_read_b32 v13, a51
    v_mfma_f32_16x16x32_bf16 v[60:63], a[248:251], v[180:183], v[60:63]
    v_accvgpr_read_b32 v14, a52
    ds_read_b128 v[180:183], v19 offset:8192
    v_mfma_f32_16x16x32_bf16 v[64:67], a[224:227], v[184:187], v[64:67]
    v_accvgpr_read_b32 v15, a53
    v_mfma_f32_16x16x32_bf16 v[68:71], a[232:235], v[184:187], v[68:71]
    v_accvgpr_read_b32 v16, a54
    v_mfma_f32_16x16x32_bf16 v[72:75], a[240:243], v[184:187], v[72:75]
    v_accvgpr_read_b32 v17, a55
    v_mfma_f32_16x16x32_bf16 v[76:79], a[248:251], v[184:187], v[76:79]
    v_max3_f32 v247, v10, v11, v12
    ds_read_b128 v[184:187], v19 offset:16384
    v_mfma_f32_16x16x32_bf16 v[80:83], a[224:227], v[188:191], v[80:83]
    v_max3_f32 v247, v13, v14, v247
    v_mfma_f32_16x16x32_bf16 v[84:87], a[232:235], v[188:191], v[84:87]
    v_max3_f32 v247, v15, v16, v247
    v_mfma_f32_16x16x32_bf16 v[88:91], a[240:243], v[188:191], v[88:91]
    v_max_f32 v247, v17, v247
    v_mfma_f32_16x16x32_bf16 v[92:95], a[248:251], v[188:191], v[92:95]
    v_accvgpr_read_b32 v10, a56
    ds_read_b128 v[188:191], v19 offset:24576
    v_mfma_f32_16x16x32_bf16 v[96:99], a[224:227], v[192:195], v[96:99]
    v_accvgpr_read_b32 v11, a57
    v_mfma_f32_16x16x32_bf16 v[100:103], a[232:235], v[192:195], v[100:103]
    v_accvgpr_read_b32 v12, a58
    v_mfma_f32_16x16x32_bf16 v[104:107], a[240:243], v[192:195], v[104:107]
    v_accvgpr_read_b32 v13, a59
    v_mfma_f32_16x16x32_bf16 v[108:111], a[248:251], v[192:195], v[108:111]
    v_accvgpr_read_b32 v14, a60
    ds_read_b128 v[192:195], v19 offset:32768
    ds_write_b128 v0, a[228:231]
    ds_read_b128 a[228:231], v5
    v_mfma_f32_16x16x32_bf16 v[112:115], a[224:227], v[196:199], v[112:115]
    v_accvgpr_read_b32 v15, a61
    v_mfma_f32_16x16x32_bf16 v[116:119], a[232:235], v[196:199], v[116:119]
    v_accvgpr_read_b32 v16, a62
    v_mfma_f32_16x16x32_bf16 v[120:123], a[240:243], v[196:199], v[120:123]
    buffer_load_dwordx4 a[184:187], v8, s[16:19], s51 offen offset:448 nt
    v_accvgpr_read_b32 v17, a63
    v_mfma_f32_16x16x32_bf16 v[124:127], a[248:251], v[196:199], v[124:127]
    v_max3_f32 v247, v10, v11, v247
    ds_read_b128 v[196:199], v19 offset:40960
    ds_write_b128 v0, a[236:239] offset:1024
    ds_read_b128 a[236:239], v5 offset:1024
    v_mfma_f32_16x16x32_bf16 v[128:131], a[224:227], v[200:203], v[128:131]
    v_max_f32 v247, v12, v247
    v_mfma_f32_16x16x32_bf16 v[132:135], a[232:235], v[200:203], v[132:135]
    v_max3_f32 v247, v13, v14, v247
    v_mfma_f32_16x16x32_bf16 v[136:139], a[240:243], v[200:203], v[136:139]
    v_max3_f32 v247, v15, v16, v247
    v_mfma_f32_16x16x32_bf16 v[140:143], a[248:251], v[200:203], v[140:143]
    v_max_f32 v247, v17, v247
    ds_read_b128 v[200:203], v19 offset:49152
    ds_write_b128 v0, a[244:247] offset:2048
    ds_read_b128 a[244:247], v5 offset:2048
    v_mfma_f32_16x16x32_bf16 v[144:147], a[224:227], v[204:207], v[144:147]
    v_accvgpr_read_b32 v10, a64
    v_mfma_f32_16x16x32_bf16 v[148:151], a[232:235], v[204:207], v[148:151]
    v_accvgpr_read_b32 v11, a65
    v_mfma_f32_16x16x32_bf16 v[152:155], a[240:243], v[204:207], v[152:155]
    v_accvgpr_read_b32 v12, a66
    v_mfma_f32_16x16x32_bf16 v[156:159], a[248:251], v[204:207], v[156:159]
    v_accvgpr_read_b32 v13, a67
    ds_read_b128 v[204:207], v19 offset:57344
    ds_write_b128 v0, a[252:255] offset:3072
    ds_read_b128 a[252:255], v5 offset:3072
    s_waitcnt lgkmcnt(15)
    v_mfma_f32_16x16x32_bf16 v[160:163], a[224:227], v[208:211], v[160:163]
    v_accvgpr_read_b32 v14, a68
    v_mfma_f32_16x16x32_bf16 v[164:167], a[232:235], v[208:211], v[164:167]
    s_add_u32 s47, s31, 0
    buffer_load_dwordx2 a[164:165], v9, s[20:23], s47 offen nt
    v_accvgpr_read_b32 v15, a69
    v_mfma_f32_16x16x32_bf16 v[168:171], a[240:243], v[208:211], v[168:171]
    v_accvgpr_read_b32 v16, a70
    v_mfma_f32_16x16x32_bf16 v[172:175], a[248:251], v[208:211], v[172:175]
    v_accvgpr_read_b32 v17, a71
    ds_read_b128 v[208:211], v20
    v_xor_b32 v19, 0, v18
    v_add_u32 v20, 65536, v19
    s_waitcnt lgkmcnt(10)
    v_mfma_f32_16x16x32_bf16 v[32:35], a[228:231], v[176:179], v[32:35]
    v_max3_f32 v248, v10, v11, v12
    s_waitcnt lgkmcnt(7)
    v_mfma_f32_16x16x32_bf16 v[36:39], a[236:239], v[176:179], v[36:39]
    v_max3_f32 v248, v13, v14, v248
    s_waitcnt lgkmcnt(4)
    v_mfma_f32_16x16x32_bf16 v[40:43], a[244:247], v[176:179], v[40:43]
    v_max3_f32 v248, v15, v16, v248
    s_waitcnt lgkmcnt(1)
    v_mfma_f32_16x16x32_bf16 v[44:47], a[252:255], v[176:179], v[44:47]
    v_max_f32 v248, v17, v248
    ds_read_b128 v[176:179], v19 offset:256
    v_mfma_f32_16x16x32_bf16 v[48:51], a[228:231], v[180:183], v[48:51]
    v_accvgpr_read_b32 v10, a72
    v_mfma_f32_16x16x32_bf16 v[52:55], a[236:239], v[180:183], v[52:55]
    v_accvgpr_read_b32 v11, a73
    v_mfma_f32_16x16x32_bf16 v[56:59], a[244:247], v[180:183], v[56:59]
    v_accvgpr_read_b32 v12, a74
    v_mfma_f32_16x16x32_bf16 v[60:63], a[252:255], v[180:183], v[60:63]
    v_accvgpr_read_b32 v13, a75
    ds_read_b128 v[180:183], v19 offset:8448
    v_mfma_f32_16x16x32_bf16 v[64:67], a[228:231], v[184:187], v[64:67]
    s_add_u32 s58, s31, 0
    buffer_load_dwordx2 a[166:167], v9, s[20:23], s58 offen offset:512 nt
    v_accvgpr_read_b32 v14, a76
    v_mfma_f32_16x16x32_bf16 v[68:71], a[236:239], v[184:187], v[68:71]
    v_accvgpr_read_b32 v15, a77
    v_mfma_f32_16x16x32_bf16 v[72:75], a[244:247], v[184:187], v[72:75]
    v_accvgpr_read_b32 v16, a78
    v_mfma_f32_16x16x32_bf16 v[76:79], a[252:255], v[184:187], v[76:79]
    v_accvgpr_read_b32 v17, a79
    ds_read_b128 v[184:187], v19 offset:16640
    v_mfma_f32_16x16x32_bf16 v[80:83], a[228:231], v[188:191], v[80:83]
    v_max3_f32 v248, v10, v11, v248
    v_mfma_f32_16x16x32_bf16 v[84:87], a[236:239], v[188:191], v[84:87]
    v_max_f32 v248, v12, v248
    v_mfma_f32_16x16x32_bf16 v[88:91], a[244:247], v[188:191], v[88:91]
    v_max3_f32 v248, v13, v14, v248
    v_mfma_f32_16x16x32_bf16 v[92:95], a[252:255], v[188:191], v[92:95]
    v_max3_f32 v248, v15, v16, v248
    ds_read_b128 v[188:191], v19 offset:24832
    v_mfma_f32_16x16x32_bf16 v[96:99], a[228:231], v[192:195], v[96:99]
    v_max_f32 v248, v17, v248
    v_mfma_f32_16x16x32_bf16 v[100:103], a[236:239], v[192:195], v[100:103]
    v_accvgpr_read_b32 v10, a80
    v_mfma_f32_16x16x32_bf16 v[104:107], a[244:247], v[192:195], v[104:107]
    v_accvgpr_read_b32 v11, a81
    v_mfma_f32_16x16x32_bf16 v[108:111], a[252:255], v[192:195], v[108:111]
    s_add_u32 s59, s31, 0
    buffer_load_dwordx2 a[172:173], v9, s[20:23], s59 offen offset:1024 nt
    v_accvgpr_read_b32 v12, a82
    ds_read_b128 v[192:195], v19 offset:33024
    s_waitcnt vmcnt(26)
    ds_write_b128 v0, v[212:215]
    ds_read_b128 v[212:215], v5
    v_mfma_f32_16x16x32_bf16 v[112:115], a[228:231], v[196:199], v[112:115]
    v_accvgpr_read_b32 v13, a83
    v_mfma_f32_16x16x32_bf16 v[116:119], a[236:239], v[196:199], v[116:119]
    v_accvgpr_read_b32 v14, a84
    v_mfma_f32_16x16x32_bf16 v[120:123], a[244:247], v[196:199], v[120:123]
    v_accvgpr_read_b32 v15, a85
    v_mfma_f32_16x16x32_bf16 v[124:127], a[252:255], v[196:199], v[124:127]
    v_accvgpr_read_b32 v16, a86
    ds_read_b128 v[196:199], v19 offset:41216
    s_waitcnt vmcnt(24)
    ds_write_b128 v0, v[216:219] offset:1024
    ds_read_b128 v[216:219], v5 offset:1024
    v_mfma_f32_16x16x32_bf16 v[128:131], a[228:231], v[200:203], v[128:131]
    v_accvgpr_read_b32 v17, a87
    v_mfma_f32_16x16x32_bf16 v[132:135], a[236:239], v[200:203], v[132:135]
    v_max3_f32 v249, v10, v11, v12
    v_mfma_f32_16x16x32_bf16 v[136:139], a[244:247], v[200:203], v[136:139]
    v_max3_f32 v249, v13, v14, v249
    v_mfma_f32_16x16x32_bf16 v[140:143], a[252:255], v[200:203], v[140:143]
    v_max3_f32 v249, v15, v16, v249
    ds_read_b128 v[200:203], v19 offset:49408
    s_waitcnt vmcnt(22)
    ds_write_b128 v0, v[228:231] offset:2048
    ds_read_b128 v[228:231], v5 offset:2048
    v_mfma_f32_16x16x32_bf16 v[144:147], a[228:231], v[204:207], v[144:147]
    v_max_f32 v249, v17, v249
    v_mfma_f32_16x16x32_bf16 v[148:151], a[236:239], v[204:207], v[148:151]
    v_accvgpr_read_b32 v10, a88
    v_mfma_f32_16x16x32_bf16 v[152:155], a[244:247], v[204:207], v[152:155]
    s_add_u32 s46, s31, 0
    buffer_load_dwordx2 a[174:175], v9, s[20:23], s46 offen offset:1536 nt
    v_accvgpr_read_b32 v11, a89
    v_mfma_f32_16x16x32_bf16 v[156:159], a[252:255], v[204:207], v[156:159]
    v_accvgpr_read_b32 v12, a90
    ds_read_b128 v[204:207], v19 offset:57600
    s_waitcnt vmcnt(21)
    ds_write_b128 v0, a[144:147] offset:3072
    ds_read_b128 a[144:147], v5 offset:3072
    s_waitcnt lgkmcnt(15)
    v_mfma_f32_16x16x32_bf16 v[160:163], a[228:231], v[208:211], v[160:163]
    v_accvgpr_read_b32 v13, a91
    v_mfma_f32_16x16x32_bf16 v[164:167], a[236:239], v[208:211], v[164:167]
    v_accvgpr_read_b32 v14, a92
    v_mfma_f32_16x16x32_bf16 v[168:171], a[244:247], v[208:211], v[168:171]
    v_accvgpr_read_b32 v15, a93
    v_mfma_f32_16x16x32_bf16 v[172:175], a[252:255], v[208:211], v[172:175]
    v_accvgpr_read_b32 v16, a94
    ds_read_b128 v[208:211], v20 offset:256
    v_xor_b32 v19, 64, v18
    v_add_u32 v20, 65536, v19
    s_waitcnt lgkmcnt(10)
    v_mfma_f32_16x16x32_bf16 v[32:35], v[212:215], v[176:179], v[32:35]
    v_accvgpr_read_b32 v17, a95
    s_waitcnt lgkmcnt(7)
    v_mfma_f32_16x16x32_bf16 v[36:39], v[216:219], v[176:179], v[36:39]
    v_max3_f32 v249, v10, v11, v249
    s_waitcnt lgkmcnt(4)
    v_mfma_f32_16x16x32_bf16 v[40:43], v[228:231], v[176:179], v[40:43]
    v_max_f32 v249, v12, v249
    s_waitcnt lgkmcnt(1)
    v_mfma_f32_16x16x32_bf16 v[44:47], a[144:147], v[176:179], v[44:47]
    v_max3_f32 v249, v13, v14, v249
    ds_read_b128 v[176:179], v19 offset:256
    v_mfma_f32_16x16x32_bf16 v[48:51], v[212:215], v[180:183], v[48:51]
    s_add_u32 s47, s31, 0
    buffer_load_dwordx2 a[180:181], v9, s[20:23], s47 offen offset:2048 nt
    v_max3_f32 v249, v15, v16, v249
    v_mfma_f32_16x16x32_bf16 v[52:55], v[216:219], v[180:183], v[52:55]
    v_max_f32 v249, v17, v249
    v_mfma_f32_16x16x32_bf16 v[56:59], v[228:231], v[180:183], v[56:59]
    v_accvgpr_read_b32 v10, a96
    v_mfma_f32_16x16x32_bf16 v[60:63], a[144:147], v[180:183], v[60:63]
    v_accvgpr_read_b32 v11, a97
    ds_read_b128 v[180:183], v19 offset:8448
    v_mfma_f32_16x16x32_bf16 v[64:67], v[212:215], v[184:187], v[64:67]
    v_accvgpr_read_b32 v12, a98
    v_mfma_f32_16x16x32_bf16 v[68:71], v[216:219], v[184:187], v[68:71]
    v_accvgpr_read_b32 v13, a99
    v_mfma_f32_16x16x32_bf16 v[72:75], v[228:231], v[184:187], v[72:75]
    v_accvgpr_read_b32 v14, a100
    v_mfma_f32_16x16x32_bf16 v[76:79], a[144:147], v[184:187], v[76:79]
    v_accvgpr_read_b32 v15, a101
    ds_read_b128 v[184:187], v19 offset:16640
    v_mfma_f32_16x16x32_bf16 v[80:83], v[212:215], v[188:191], v[80:83]
    v_accvgpr_read_b32 v16, a102
    v_mfma_f32_16x16x32_bf16 v[84:87], v[216:219], v[188:191], v[84:87]
    v_accvgpr_read_b32 v17, a103
    v_mfma_f32_16x16x32_bf16 v[88:91], v[228:231], v[188:191], v[88:91]
    v_max3_f32 v250, v10, v11, v12
    v_mfma_f32_16x16x32_bf16 v[92:95], a[144:147], v[188:191], v[92:95]
    s_add_u32 s58, s31, 0
    buffer_load_dwordx2 a[182:183], v9, s[20:23], s58 offen offset:2560 nt
    v_max3_f32 v250, v13, v14, v250
    ds_read_b128 v[188:191], v19 offset:24832
    v_mfma_f32_16x16x32_bf16 v[96:99], v[212:215], v[192:195], v[96:99]
    v_max3_f32 v250, v15, v16, v250
    v_mfma_f32_16x16x32_bf16 v[100:103], v[216:219], v[192:195], v[100:103]
    v_max_f32 v250, v17, v250
    v_mfma_f32_16x16x32_bf16 v[104:107], v[228:231], v[192:195], v[104:107]
    v_accvgpr_read_b32 v10, a104
    v_mfma_f32_16x16x32_bf16 v[108:111], a[144:147], v[192:195], v[108:111]
    v_accvgpr_read_b32 v11, a105
    ds_read_b128 v[192:195], v19 offset:33024
    ds_write_b128 v0, v[220:223]
    ds_read_b128 v[220:223], v5
    v_mfma_f32_16x16x32_bf16 v[112:115], v[212:215], v[196:199], v[112:115]
    v_accvgpr_read_b32 v12, a106
    v_mfma_f32_16x16x32_bf16 v[116:119], v[216:219], v[196:199], v[116:119]
    v_accvgpr_read_b32 v13, a107
    v_mfma_f32_16x16x32_bf16 v[120:123], v[228:231], v[196:199], v[120:123]
    v_accvgpr_read_b32 v14, a108
    v_mfma_f32_16x16x32_bf16 v[124:127], a[144:147], v[196:199], v[124:127]
    v_accvgpr_read_b32 v15, a109
    ds_read_b128 v[196:199], v19 offset:41216
    ds_write_b128 v0, v[224:227] offset:1024
    ds_read_b128 v[224:227], v5 offset:1024
    v_mfma_f32_16x16x32_bf16 v[128:131], v[212:215], v[200:203], v[128:131]
    v_accvgpr_read_b32 v16, a110
    v_mfma_f32_16x16x32_bf16 v[132:135], v[216:219], v[200:203], v[132:135]
    v_accvgpr_read_b32 v17, a111
    v_mfma_f32_16x16x32_bf16 v[136:139], v[228:231], v[200:203], v[136:139]
    s_add_u32 s59, s31, 0
    buffer_load_dwordx2 a[188:189], v9, s[20:23], s59 offen offset:3072 nt
    v_max3_f32 v250, v10, v11, v250
    v_mfma_f32_16x16x32_bf16 v[140:143], a[144:147], v[200:203], v[140:143]
    v_max_f32 v250, v12, v250
    ds_read_b128 v[200:203], v19 offset:49408
    ds_write_b128 v0, v[236:239] offset:2048
    ds_read_b128 v[236:239], v5 offset:2048
    v_mfma_f32_16x16x32_bf16 v[144:147], v[212:215], v[204:207], v[144:147]
    v_max3_f32 v250, v13, v14, v250
    v_mfma_f32_16x16x32_bf16 v[148:151], v[216:219], v[204:207], v[148:151]
    v_max3_f32 v250, v15, v16, v250
    v_mfma_f32_16x16x32_bf16 v[152:155], v[228:231], v[204:207], v[152:155]
    v_max_f32 v250, v17, v250
    v_mfma_f32_16x16x32_bf16 v[156:159], a[144:147], v[204:207], v[156:159]
    v_accvgpr_read_b32 v10, a112
    ds_read_b128 v[204:207], v19 offset:57600
    s_waitcnt vmcnt(23)
    ds_write_b128 v0, a[152:155] offset:3072
    ds_read_b128 a[152:155], v5 offset:3072
    s_waitcnt lgkmcnt(15)
    v_mfma_f32_16x16x32_bf16 v[160:163], v[212:215], v[208:211], v[160:163]
    v_accvgpr_read_b32 v11, a113
    v_mfma_f32_16x16x32_bf16 v[164:167], v[216:219], v[208:211], v[164:167]
    v_accvgpr_read_b32 v12, a114
    v_mfma_f32_16x16x32_bf16 v[168:171], v[228:231], v[208:211], v[168:171]
    v_accvgpr_read_b32 v13, a115
    v_mfma_f32_16x16x32_bf16 v[172:175], a[144:147], v[208:211], v[172:175]
    v_accvgpr_read_b32 v14, a116
    ds_read_b128 v[208:211], v20 offset:256
    v_xor_b32 v19, 128, v18
    v_add_u32 v20, 65536, v19
    s_waitcnt lgkmcnt(10)
    v_mfma_f32_16x16x32_bf16 v[32:35], v[220:223], v[176:179], v[32:35]
    v_accvgpr_read_b32 v15, a117
    s_waitcnt lgkmcnt(7)
    v_mfma_f32_16x16x32_bf16 v[36:39], v[224:227], v[176:179], v[36:39]
    s_add_u32 s46, s31, 0
    buffer_load_dwordx2 a[190:191], v9, s[20:23], s46 offen offset:3584 nt
    v_accvgpr_read_b32 v16, a118
    s_waitcnt lgkmcnt(4)
    v_mfma_f32_16x16x32_bf16 v[40:43], v[236:239], v[176:179], v[40:43]
    v_accvgpr_read_b32 v17, a119
    s_waitcnt lgkmcnt(1)
    v_mfma_f32_16x16x32_bf16 v[44:47], a[152:155], v[176:179], v[44:47]
    v_max3_f32 v251, v10, v11, v12
    ds_read_b128 v[176:179], v19 offset:256
    v_mfma_f32_16x16x32_bf16 v[48:51], v[220:223], v[180:183], v[48:51]
    v_max3_f32 v251, v13, v14, v251
    v_mfma_f32_16x16x32_bf16 v[52:55], v[224:227], v[180:183], v[52:55]
    v_max3_f32 v251, v15, v16, v251
    v_mfma_f32_16x16x32_bf16 v[56:59], v[236:239], v[180:183], v[56:59]
    v_max_f32 v251, v17, v251
    v_mfma_f32_16x16x32_bf16 v[60:63], a[152:155], v[180:183], v[60:63]
    v_accvgpr_read_b32 v10, a120
    ds_read_b128 v[180:183], v19 offset:8448
    v_mfma_f32_16x16x32_bf16 v[64:67], v[220:223], v[184:187], v[64:67]
    v_accvgpr_read_b32 v11, a121
    v_mfma_f32_16x16x32_bf16 v[68:71], v[224:227], v[184:187], v[68:71]
    v_accvgpr_read_b32 v12, a122
    v_mfma_f32_16x16x32_bf16 v[72:75], v[236:239], v[184:187], v[72:75]
    v_accvgpr_read_b32 v13, a123
    v_mfma_f32_16x16x32_bf16 v[76:79], a[152:155], v[184:187], v[76:79]
    v_accvgpr_read_b32 v14, a124
    ds_read_b128 v[184:187], v19 offset:16640
    v_mfma_f32_16x16x32_bf16 v[80:83], v[220:223], v[188:191], v[80:83]
    s_add_u32 s47, s31, 16384
    buffer_load_dwordx2 a[192:193], v9, s[20:23], s47 offen nt
    v_accvgpr_read_b32 v15, a125
    v_mfma_f32_16x16x32_bf16 v[84:87], v[224:227], v[188:191], v[84:87]
    v_accvgpr_read_b32 v16, a126
    v_mfma_f32_16x16x32_bf16 v[88:91], v[236:239], v[188:191], v[88:91]
    v_accvgpr_read_b32 v17, a127
    v_mfma_f32_16x16x32_bf16 v[92:95], a[152:155], v[188:191], v[92:95]
    v_max3_f32 v251, v10, v11, v251
    ds_read_b128 v[188:191], v19 offset:24832
    v_mfma_f32_16x16x32_bf16 v[96:99], v[220:223], v[192:195], v[96:99]
    v_max_f32 v251, v12, v251
    v_mfma_f32_16x16x32_bf16 v[100:103], v[224:227], v[192:195], v[100:103]
    v_max3_f32 v251, v13, v14, v251
    v_mfma_f32_16x16x32_bf16 v[104:107], v[236:239], v[192:195], v[104:107]
    v_max3_f32 v251, v15, v16, v251
    v_mfma_f32_16x16x32_bf16 v[108:111], a[152:155], v[192:195], v[108:111]
    v_max_f32 v251, v17, v251
    ds_read_b128 v[192:195], v19 offset:33024
    s_waitcnt vmcnt(16)
    ds_write_b128 v0, v[232:235]
    ds_read_b128 v[232:235], v5
    v_mfma_f32_16x16x32_bf16 v[112:115], v[220:223], v[196:199], v[112:115]
    v_accvgpr_read_b32 v10, a128
    v_mfma_f32_16x16x32_bf16 v[116:119], v[224:227], v[196:199], v[116:119]
    v_accvgpr_read_b32 v11, a129
    v_mfma_f32_16x16x32_bf16 v[120:123], v[236:239], v[196:199], v[120:123]
    v_accvgpr_read_b32 v12, a130
    v_mfma_f32_16x16x32_bf16 v[124:127], a[152:155], v[196:199], v[124:127]
    s_add_u32 s58, s31, 16384
    buffer_load_dwordx2 a[194:195], v9, s[20:23], s58 offen offset:512 nt
    v_accvgpr_read_b32 v13, a131
    ds_read_b128 v[196:199], v19 offset:41216
    s_waitcnt vmcnt(15)
    ds_write_b128 v0, a[148:151] offset:1024
    ds_read_b128 a[148:151], v5 offset:1024
    v_mfma_f32_16x16x32_bf16 v[128:131], v[220:223], v[200:203], v[128:131]
    v_accvgpr_read_b32 v14, a132
    v_mfma_f32_16x16x32_bf16 v[132:135], v[224:227], v[200:203], v[132:135]
    v_accvgpr_read_b32 v15, a133
    v_mfma_f32_16x16x32_bf16 v[136:139], v[236:239], v[200:203], v[136:139]
    v_accvgpr_read_b32 v16, a134
    v_mfma_f32_16x16x32_bf16 v[140:143], a[152:155], v[200:203], v[140:143]
    v_accvgpr_read_b32 v17, a135
    ds_read_b128 v[200:203], v19 offset:49408
    s_waitcnt vmcnt(13)
    ds_write_b128 v0, a[160:163] offset:2048
    ds_read_b128 a[160:163], v5 offset:2048
    v_mfma_f32_16x16x32_bf16 v[144:147], v[220:223], v[204:207], v[144:147]
    v_max3_f32 v252, v10, v11, v12
    v_mfma_f32_16x16x32_bf16 v[148:151], v[224:227], v[204:207], v[148:151]
    v_max3_f32 v252, v13, v14, v252
    v_mfma_f32_16x16x32_bf16 v[152:155], v[236:239], v[204:207], v[152:155]
    v_max3_f32 v252, v15, v16, v252
    v_mfma_f32_16x16x32_bf16 v[156:159], a[152:155], v[204:207], v[156:159]
    v_max_f32 v252, v17, v252
    ds_read_b128 v[204:207], v19 offset:57600
    s_waitcnt vmcnt(11)
    ds_write_b128 v0, a[176:179] offset:3072
    ds_read_b128 a[176:179], v5 offset:3072
    s_waitcnt lgkmcnt(15)
    v_mfma_f32_16x16x32_bf16 v[160:163], v[220:223], v[208:211], v[160:163]
    v_accvgpr_read_b32 v10, a136
    v_mfma_f32_16x16x32_bf16 v[164:167], v[224:227], v[208:211], v[164:167]
    v_accvgpr_read_b32 v11, a137
    v_mfma_f32_16x16x32_bf16 v[168:171], v[236:239], v[208:211], v[168:171]
    s_add_u32 s59, s31, 16384
    buffer_load_dwordx2 a[200:201], v9, s[20:23], s59 offen offset:1024 nt
    v_accvgpr_read_b32 v12, a138
    v_mfma_f32_16x16x32_bf16 v[172:175], a[152:155], v[208:211], v[172:175]
    v_accvgpr_read_b32 v13, a139
    ds_read_b128 v[208:211], v20 offset:256
    v_xor_b32 v19, 192, v18
    v_add_u32 v20, 65536, v19
    s_waitcnt lgkmcnt(10)
    v_mfma_f32_16x16x32_bf16 v[32:35], v[232:235], v[176:179], v[32:35]
    v_accvgpr_read_b32 v14, a140
    s_waitcnt lgkmcnt(7)
    v_mfma_f32_16x16x32_bf16 v[36:39], a[148:151], v[176:179], v[36:39]
    v_accvgpr_read_b32 v15, a141
    s_waitcnt lgkmcnt(4)
    v_mfma_f32_16x16x32_bf16 v[40:43], a[160:163], v[176:179], v[40:43]
    v_accvgpr_read_b32 v16, a142
    s_waitcnt lgkmcnt(1)
    v_mfma_f32_16x16x32_bf16 v[44:47], a[176:179], v[176:179], v[44:47]
    v_accvgpr_read_b32 v17, a143
    ds_read_b128 v[176:179], v19 offset:256
    v_mfma_f32_16x16x32_bf16 v[48:51], v[232:235], v[180:183], v[48:51]
    v_max3_f32 v252, v10, v11, v252
    v_mfma_f32_16x16x32_bf16 v[52:55], a[148:151], v[180:183], v[52:55]
    v_max_f32 v252, v12, v252
    v_mfma_f32_16x16x32_bf16 v[56:59], a[160:163], v[180:183], v[56:59]
    v_max3_f32 v252, v13, v14, v252
    v_mfma_f32_16x16x32_bf16 v[60:63], a[176:179], v[180:183], v[60:63]
    v_max3_f32 v252, v15, v16, v252
    ds_read_b128 v[180:183], v19 offset:8448
    v_mfma_f32_16x16x32_bf16 v[64:67], v[232:235], v[184:187], v[64:67]
    v_max_f32 v252, v17, v252
    v_mfma_f32_16x16x32_bf16 v[68:71], a[148:151], v[184:187], v[68:71]
    s_add_u32 s46, s31, 16384
    buffer_load_dwordx2 a[202:203], v9, s[20:23], s46 offen offset:1536 nt
    v_mfma_f32_16x16x32_bf16 v[72:75], a[160:163], v[184:187], v[72:75]
    v_mfma_f32_16x16x32_bf16 v[76:79], a[176:179], v[184:187], v[76:79]
    ds_read_b128 v[184:187], v19 offset:16640
    v_mfma_f32_16x16x32_bf16 v[80:83], v[232:235], v[188:191], v[80:83]
    v_mfma_f32_16x16x32_bf16 v[84:87], a[148:151], v[188:191], v[84:87]
    v_mfma_f32_16x16x32_bf16 v[88:91], a[160:163], v[188:191], v[88:91]
    v_mfma_f32_16x16x32_bf16 v[92:95], a[176:179], v[188:191], v[92:95]
    ds_read_b128 v[188:191], v19 offset:24832
    v_mfma_f32_16x16x32_bf16 v[96:99], v[232:235], v[192:195], v[96:99]
    v_mfma_f32_16x16x32_bf16 v[100:103], a[148:151], v[192:195], v[100:103]
    v_mfma_f32_16x16x32_bf16 v[104:107], a[160:163], v[192:195], v[104:107]
    v_mfma_f32_16x16x32_bf16 v[108:111], a[176:179], v[192:195], v[108:111]
    s_add_u32 s47, s31, 16384
    buffer_load_dwordx2 a[208:209], v9, s[20:23], s47 offen offset:2048 nt
    ds_read_b128 v[192:195], v19 offset:33024
    ds_write_b128 v0, v[240:243]
    ds_read_b128 v[240:243], v5
    v_mfma_f32_16x16x32_bf16 v[112:115], v[232:235], v[196:199], v[112:115]
    v_mfma_f32_16x16x32_bf16 v[116:119], a[148:151], v[196:199], v[116:119]
    v_mfma_f32_16x16x32_bf16 v[120:123], a[160:163], v[196:199], v[120:123]
    v_mfma_f32_16x16x32_bf16 v[124:127], a[176:179], v[196:199], v[124:127]
    ds_read_b128 v[196:199], v19 offset:41216
    ds_write_b128 v0, a[156:159] offset:1024
    ds_read_b128 a[156:159], v5 offset:1024
    v_mfma_f32_16x16x32_bf16 v[128:131], v[232:235], v[200:203], v[128:131]
    v_mfma_f32_16x16x32_bf16 v[132:135], a[148:151], v[200:203], v[132:135]
    v_mfma_f32_16x16x32_bf16 v[136:139], a[160:163], v[200:203], v[136:139]
    v_mfma_f32_16x16x32_bf16 v[140:143], a[176:179], v[200:203], v[140:143]
    ds_read_b128 v[200:203], v19 offset:49408
    ds_write_b128 v0, a[168:171] offset:2048
    ds_read_b128 a[168:171], v5 offset:2048
    v_mfma_f32_16x16x32_bf16 v[144:147], v[232:235], v[204:207], v[144:147]
    v_mfma_f32_16x16x32_bf16 v[148:151], a[148:151], v[204:207], v[148:151]
    v_mfma_f32_16x16x32_bf16 v[152:155], a[160:163], v[204:207], v[152:155]
    s_add_u32 s58, s31, 16384
    buffer_load_dwordx2 a[210:211], v9, s[20:23], s58 offen offset:2560 nt
    v_mfma_f32_16x16x32_bf16 v[156:159], a[176:179], v[204:207], v[156:159]
    ds_read_b128 v[204:207], v19 offset:57600
    s_waitcnt vmcnt(14)
    ds_write_b128 v0, a[184:187] offset:3072
    ds_read_b128 a[184:187], v5 offset:3072
    s_waitcnt lgkmcnt(15)
    v_mfma_f32_16x16x32_bf16 v[160:163], v[232:235], v[208:211], v[160:163]
    v_mfma_f32_16x16x32_bf16 v[164:167], a[148:151], v[208:211], v[164:167]
    v_mfma_f32_16x16x32_bf16 v[168:171], a[160:163], v[208:211], v[168:171]
    v_mfma_f32_16x16x32_bf16 v[172:175], a[176:179], v[208:211], v[172:175]
    ds_read_b128 v[208:211], v20 offset:256
    s_waitcnt lgkmcnt(10)
    v_mfma_f32_16x16x32_bf16 v[32:35], v[240:243], v[176:179], v[32:35]
    s_waitcnt lgkmcnt(7)
    v_mfma_f32_16x16x32_bf16 v[36:39], a[156:159], v[176:179], v[36:39]
    s_waitcnt lgkmcnt(4)
    v_mfma_f32_16x16x32_bf16 v[40:43], a[168:171], v[176:179], v[40:43]
    s_waitcnt lgkmcnt(1)
    v_mfma_f32_16x16x32_bf16 v[44:47], a[184:187], v[176:179], v[44:47]
    v_mfma_f32_16x16x32_bf16 v[48:51], v[240:243], v[180:183], v[48:51]
    v_mfma_f32_16x16x32_bf16 v[52:55], a[156:159], v[180:183], v[52:55]
    s_add_u32 s59, s31, 16384
    buffer_load_dwordx2 a[216:217], v9, s[20:23], s59 offen offset:3072 nt
    v_mfma_f32_16x16x32_bf16 v[56:59], a[168:171], v[180:183], v[56:59]
    v_mfma_f32_16x16x32_bf16 v[60:63], a[184:187], v[180:183], v[60:63]
    v_mfma_f32_16x16x32_bf16 v[64:67], v[240:243], v[184:187], v[64:67]
    v_mfma_f32_16x16x32_bf16 v[68:71], a[156:159], v[184:187], v[68:71]
    v_mfma_f32_16x16x32_bf16 v[72:75], a[168:171], v[184:187], v[72:75]
    v_mfma_f32_16x16x32_bf16 v[76:79], a[184:187], v[184:187], v[76:79]
    v_mfma_f32_16x16x32_bf16 v[80:83], v[240:243], v[188:191], v[80:83]
    v_mfma_f32_16x16x32_bf16 v[84:87], a[156:159], v[188:191], v[84:87]
    v_mfma_f32_16x16x32_bf16 v[88:91], a[168:171], v[188:191], v[88:91]
    v_mfma_f32_16x16x32_bf16 v[92:95], a[184:187], v[188:191], v[92:95]
    v_mfma_f32_16x16x32_bf16 v[96:99], v[240:243], v[192:195], v[96:99]
    s_add_u32 s46, s31, 16384
    buffer_load_dwordx2 a[218:219], v9, s[20:23], s46 offen offset:3584 nt
    v_mfma_f32_16x16x32_bf16 v[100:103], a[156:159], v[192:195], v[100:103]
    v_mfma_f32_16x16x32_bf16 v[104:107], a[168:171], v[192:195], v[104:107]
    v_mfma_f32_16x16x32_bf16 v[108:111], a[184:187], v[192:195], v[108:111]
    v_mfma_f32_16x16x32_bf16 v[112:115], v[240:243], v[196:199], v[112:115]
    v_mfma_f32_16x16x32_bf16 v[116:119], a[156:159], v[196:199], v[116:119]
    v_mfma_f32_16x16x32_bf16 v[120:123], a[168:171], v[196:199], v[120:123]
    v_mfma_f32_16x16x32_bf16 v[124:127], a[184:187], v[196:199], v[124:127]
    v_mfma_f32_16x16x32_bf16 v[128:131], v[240:243], v[200:203], v[128:131]
    v_mfma_f32_16x16x32_bf16 v[132:135], a[156:159], v[200:203], v[132:135]
    v_mfma_f32_16x16x32_bf16 v[136:139], a[168:171], v[200:203], v[136:139]
    v_mfma_f32_16x16x32_bf16 v[140:143], a[184:187], v[200:203], v[140:143]
    s_add_u32 s47, s31, 32768
    buffer_load_dwordx2 a[196:197], v9, s[20:23], s47 offen nt
    v_mfma_f32_16x16x32_bf16 v[144:147], v[240:243], v[204:207], v[144:147]
    v_mfma_f32_16x16x32_bf16 v[148:151], a[156:159], v[204:207], v[148:151]
    v_mfma_f32_16x16x32_bf16 v[152:155], a[168:171], v[204:207], v[152:155]
    v_mfma_f32_16x16x32_bf16 v[156:159], a[184:187], v[204:207], v[156:159]
    s_waitcnt lgkmcnt(0)
    v_mfma_f32_16x16x32_bf16 v[160:163], v[240:243], v[208:211], v[160:163]
    v_mfma_f32_16x16x32_bf16 v[164:167], a[156:159], v[208:211], v[164:167]
    v_mfma_f32_16x16x32_bf16 v[168:171], a[168:171], v[208:211], v[168:171]
    v_mfma_f32_16x16x32_bf16 v[172:175], a[184:187], v[208:211], v[172:175]
    s_mov_b32 s80, s33
    s_mov_b32 s81, s33
    v_lshlrev_b32 v28, 4, v2
    v_lshl_add_u32 v28, v27, 2, v28
    v_add_u32 v28, 147456, v28
    v_lshlrev_b32 v29, 4, v2
    v_add_u32 v29, 147456, v29
    v_max3_f32 v212, v32, v33, v244
    v_max3_f32 v213, v34, v35, v36
    v_max3_f32 v212, v37, v38, v212
    v_max3_f32 v213, v39, v40, v213
    v_max3_f32 v212, v41, v42, v212
    v_max3_f32 v213, v43, v44, v213
    v_max3_f32 v212, v45, v46, v212
    v_max3_f32 v212, v47, v213, v212
    v_max3_f32 v214, v48, v49, v245
    v_max3_f32 v215, v50, v51, v52
    v_max3_f32 v214, v53, v54, v214
    v_max3_f32 v215, v55, v56, v215
    v_max3_f32 v214, v57, v58, v214
    v_max3_f32 v215, v59, v60, v215
    v_max3_f32 v214, v61, v62, v214
    v_max3_f32 v214, v63, v215, v214
    v_max3_f32 v216, v64, v65, v246
    v_max3_f32 v217, v66, v67, v68
    v_max3_f32 v216, v69, v70, v216
    v_max3_f32 v217, v71, v72, v217
    v_max3_f32 v216, v73, v74, v216
    v_max3_f32 v217, v75, v76, v217
    v_max3_f32 v216, v77, v78, v216
    v_max3_f32 v216, v79, v217, v216
    v_max3_f32 v218, v80, v81, v247
    v_max3_f32 v219, v82, v83, v84
    v_max3_f32 v218, v85, v86, v218
    v_max3_f32 v219, v87, v88, v219
    v_max3_f32 v218, v89, v90, v218
    v_max3_f32 v219, v91, v92, v219
    v_max3_f32 v218, v93, v94, v218
    v_max3_f32 v218, v95, v219, v218
    v_max3_f32 v220, v96, v97, v248
    v_max3_f32 v221, v98, v99, v100
    v_max3_f32 v220, v101, v102, v220
    v_max3_f32 v221, v103, v104, v221
    v_max3_f32 v220, v105, v106, v220
    v_max3_f32 v221, v107, v108, v221
    v_max3_f32 v220, v109, v110, v220
    v_max3_f32 v220, v111, v221, v220
    v_max3_f32 v222, v112, v113, v249
    v_max3_f32 v223, v114, v115, v116
    v_max3_f32 v222, v117, v118, v222
    v_max3_f32 v223, v119, v120, v223
    v_max3_f32 v222, v121, v122, v222
    v_max3_f32 v223, v123, v124, v223
    v_max3_f32 v222, v125, v126, v222
    v_max3_f32 v222, v127, v223, v222
    v_max3_f32 v224, v128, v129, v250
    v_max3_f32 v225, v130, v131, v132
    v_max3_f32 v224, v133, v134, v224
    v_max3_f32 v225, v135, v136, v225
    v_max3_f32 v224, v137, v138, v224
    v_max3_f32 v225, v139, v140, v225
    v_max3_f32 v224, v141, v142, v224
    v_max3_f32 v224, v143, v225, v224
    v_max3_f32 v226, v144, v145, v251
    v_max3_f32 v227, v146, v147, v148
    v_max3_f32 v226, v149, v150, v226
    v_max3_f32 v227, v151, v152, v227
    v_max3_f32 v226, v153, v154, v226
    v_max3_f32 v227, v155, v156, v227
    v_max3_f32 v226, v157, v158, v226
    v_max3_f32 v226, v159, v227, v226
    v_max3_f32 v228, v160, v161, v252
    v_max3_f32 v229, v162, v163, v164
    v_max3_f32 v228, v165, v166, v228
    v_max3_f32 v229, v167, v168, v229
    v_max3_f32 v228, v169, v170, v228
    v_max3_f32 v229, v171, v172, v229
    v_max3_f32 v228, v173, v174, v228
    v_max3_f32 v228, v175, v229, v228
    v_mov_b32 v213, v212
    v_mov_b32 v215, v214
    v_mov_b32 v217, v216
    v_mov_b32 v219, v218
    v_mov_b32 v221, v220
    v_mov_b32 v223, v222
    v_mov_b32 v225, v224
    v_mov_b32 v227, v226
    v_mov_b32 v229, v228
    v_permlane32_swap_b32 v213, v212
    v_permlane32_swap_b32 v215, v214
    v_permlane32_swap_b32 v217, v216
    v_permlane32_swap_b32 v219, v218
    v_permlane32_swap_b32 v221, v220
    v_permlane32_swap_b32 v223, v222
    v_permlane32_swap_b32 v225, v224
    v_permlane32_swap_b32 v227, v226
    v_permlane32_swap_b32 v229, v228
    v_max_f32 v212, v213, v212
    v_max_f32 v214, v215, v214
    v_max_f32 v216, v217, v216
    v_max_f32 v218, v219, v218
    v_max_f32 v220, v221, v220
    v_max_f32 v222, v223, v222
    v_max_f32 v224, v225, v224
    v_max_f32 v226, v227, v226
    v_max_f32 v228, v229, v228
    v_mov_b32 v213, v212
    v_mov_b32 v215, v214
    v_mov_b32 v217, v216
    v_mov_b32 v219, v218
    v_mov_b32 v221, v220
    v_mov_b32 v223, v222
    v_mov_b32 v225, v224
    v_mov_b32 v227, v226
    v_mov_b32 v229, v228
    v_permlane16_swap_b32 v213, v212
    v_permlane16_swap_b32 v215, v214
    v_permlane16_swap_b32 v217, v216
    v_permlane16_swap_b32 v219, v218
    v_permlane16_swap_b32 v221, v220
    v_permlane16_swap_b32 v223, v222
    v_permlane16_swap_b32 v225, v224
    v_permlane16_swap_b32 v227, v226
    v_permlane16_swap_b32 v229, v228
    v_max_f32 v212, v213, v212
    ds_write_b32 v28, v212
    s_add_u32 s58, s31, 32768
    buffer_load_dwordx2 a[198:199], v9, s[20:23], s58 offen offset:512 nt
    v_max_f32 v214, v215, v214
    ds_write_b32 v28, v214 offset:256
    s_add_u32 s59, s31, 32768
    buffer_load_dwordx2 a[204:205], v9, s[20:23], s59 offen offset:1024 nt
    v_max_f32 v216, v217, v216
    ds_write_b32 v28, v216 offset:512
    s_add_u32 s46, s31, 32768
    buffer_load_dwordx2 a[206:207], v9, s[20:23], s46 offen offset:1536 nt
    v_max_f32 v218, v219, v218
    ds_write_b32 v28, v218 offset:768
    s_add_u32 s47, s31, 32768
    buffer_load_dwordx2 a[212:213], v9, s[20:23], s47 offen offset:2048 nt
    v_max_f32 v220, v221, v220
    ds_write_b32 v28, v220 offset:1024
    s_add_u32 s58, s31, 32768
    buffer_load_dwordx2 a[214:215], v9, s[20:23], s58 offen offset:2560 nt
    v_max_f32 v222, v223, v222
    ds_write_b32 v28, v222 offset:1280
    s_add_u32 s59, s31, 32768
    buffer_load_dwordx2 a[220:221], v9, s[20:23], s59 offen offset:3072 nt
    v_max_f32 v224, v225, v224
    ds_write_b32 v28, v224 offset:1536
    s_add_u32 s46, s31, 32768
    buffer_load_dwordx2 a[222:223], v9, s[20:23], s46 offen offset:3584 nt
    v_max_f32 v226, v227, v226
    ds_write_b32 v28, v226 offset:1792
    s_add_u32 s47, s31, 49152
    buffer_load_dwordx2 a[224:225], v9, s[20:23], s47 offen nt
    v_max_f32 v228, v229, v228
    ds_write_b32 v28, v228 offset:2048
    s_add_u32 s58, s31, 49152
    buffer_load_dwordx2 a[226:227], v9, s[20:23], s58 offen offset:512 nt
    s_waitcnt lgkmcnt(0)
    s_barrier
    ds_read_b128 v[176:179], v29
    ds_read_b128 v[180:183], v29 offset:256
    ds_read_b128 v[184:187], v29 offset:512
    ds_read_b128 v[188:191], v29 offset:768
    ds_read_b128 v[192:195], v29 offset:1024
    ds_read_b128 v[196:199], v29 offset:1280
    ds_read_b128 v[200:203], v29 offset:1536
    ds_read_b128 v[204:207], v29 offset:1792
    ds_read_b128 v[208:211], v29 offset:2048
    v_mov_b32 v231, s33
    s_waitcnt lgkmcnt(8)
    v_max3_f32 v212, v176, v177, v178
    v_max_f32 v212, v179, v212
    s_waitcnt lgkmcnt(7)
    v_max3_f32 v214, v180, v181, v182
    v_max_f32 v214, v183, v214
    s_waitcnt lgkmcnt(6)
    v_max3_f32 v216, v184, v185, v186
    v_max_f32 v216, v187, v216
    s_waitcnt lgkmcnt(5)
    v_max3_f32 v218, v188, v189, v190
    v_max_f32 v218, v191, v218
    s_waitcnt lgkmcnt(4)
    v_max3_f32 v220, v192, v193, v194
    v_max_f32 v220, v195, v220
    s_waitcnt lgkmcnt(3)
    v_max3_f32 v222, v196, v197, v198
    v_max_f32 v222, v199, v222
    s_waitcnt lgkmcnt(2)
    v_max3_f32 v224, v200, v201, v202
    v_max_f32 v224, v203, v224
    s_waitcnt lgkmcnt(1)
    v_max3_f32 v226, v204, v205, v206
    v_max_f32 v226, v207, v226
    s_waitcnt lgkmcnt(0)
    v_max3_f32 v228, v208, v209, v210
    v_max_f32 v228, v211, v228
    v_mul_f32 v212, v231, v212
    v_mul_f32 v214, v231, v214
    v_mul_f32 v216, v231, v216
    v_mul_f32 v218, v231, v218
    v_mul_f32 v220, v231, v220
    v_mul_f32 v222, v231, v222
    v_mul_f32 v224, v231, v224
    v_mul_f32 v226, v231, v226
    v_mul_f32 v228, v231, v228
    v_sub_f32 v212, 0, v212
    v_sub_f32 v214, 0, v214
    v_sub_f32 v216, 0, v216
    v_sub_f32 v218, 0, v218
    v_sub_f32 v220, 0, v220
    v_sub_f32 v222, 0, v222
    v_sub_f32 v224, 0, v224
    v_sub_f32 v226, 0, v226
    v_sub_f32 v228, 0, v228
    v_pk_fma_f32 v[32:33], v[32:33], s[80:81], v[212:213] op_sel_hi:[1,1,0]
    v_pk_fma_f32 v[34:35], v[34:35], s[80:81], v[212:213] op_sel_hi:[1,1,0]
    v_exp_f32 v32, v32
    v_exp_f32 v33, v33
    v_exp_f32 v34, v34
    v_exp_f32 v35, v35
    v_pk_fma_f32 v[36:37], v[36:37], s[80:81], v[212:213] op_sel_hi:[1,1,0]
    v_pk_fma_f32 v[38:39], v[38:39], s[80:81], v[212:213] op_sel_hi:[1,1,0]
    v_exp_f32 v36, v36
    v_exp_f32 v37, v37
    v_exp_f32 v38, v38
    v_exp_f32 v39, v39
    v_mov_b32 v22, v21
    v_xor_b32 v240, 0, v22
    v_cvt_pk_bf16_f32 v232, v32, v33
    v_cvt_pk_bf16_f32 v233, v34, v35
    v_pk_add_f32 v[176:177], v[32:33], v[34:35]
    ds_write_b64 v240, v[232:233]
    s_add_u32 s59, s31, 49152
    buffer_load_dwordx2 a[232:233], v9, s[20:23], s59 offen offset:1024 nt
    v_pk_fma_f32 v[40:41], v[40:41], s[80:81], v[212:213] op_sel_hi:[1,1,0]
    v_pk_fma_f32 v[42:43], v[42:43], s[80:81], v[212:213] op_sel_hi:[1,1,0]
    v_exp_f32 v40, v40
    v_exp_f32 v41, v41
    v_exp_f32 v42, v42
    v_exp_f32 v43, v43
    v_xor_b32 v241, 32, v22
    v_cvt_pk_bf16_f32 v234, v36, v37
    v_cvt_pk_bf16_f32 v235, v38, v39
    v_pk_add_f32 v[176:177], v[36:37], v[176:177]
    v_pk_add_f32 v[176:177], v[38:39], v[176:177]
    ds_write_b64 v241, v[234:235]
    v_pk_fma_f32 v[44:45], v[44:45], s[80:81], v[212:213] op_sel_hi:[1,1,0]
    v_pk_fma_f32 v[46:47], v[46:47], s[80:81], v[212:213] op_sel_hi:[1,1,0]
    v_exp_f32 v44, v44
    v_exp_f32 v45, v45
    v_exp_f32 v46, v46
    v_exp_f32 v47, v47
    v_xor_b32 v242, 64, v22
    v_cvt_pk_bf16_f32 v236, v40, v41
    v_cvt_pk_bf16_f32 v237, v42, v43
    v_pk_add_f32 v[176:177], v[40:41], v[176:177]
    v_pk_add_f32 v[176:177], v[42:43], v[176:177]
    ds_write_b64 v242, v[236:237]
    s_add_u32 s46, s31, 49152
    buffer_load_dwordx2 a[234:235], v9, s[20:23], s46 offen offset:1536 nt
    v_accvgpr_read_b32 v196, a0
    v_accvgpr_read_b32 v197, a1
    v_accvgpr_read_b32 v198, a2
    v_accvgpr_read_b32 v199, a3
    v_pk_fma_f32 v[196:197], v[196:197], s[80:81], v[212:213] op_sel_hi:[1,1,0]
    v_pk_fma_f32 v[198:199], v[198:199], s[80:81], v[212:213] op_sel_hi:[1,1,0]
    v_exp_f32 v196, v196
    v_exp_f32 v197, v197
    v_exp_f32 v198, v198
    v_exp_f32 v199, v199
    v_xor_b32 v243, 96, v22
    v_cvt_pk_bf16_f32 v238, v44, v45
    v_cvt_pk_bf16_f32 v239, v46, v47
    v_pk_add_f32 v[176:177], v[44:45], v[176:177]
    v_pk_add_f32 v[176:177], v[46:47], v[176:177]
    ds_write_b64 v243, v[238:239]
    v_accvgpr_read_b32 v200, a4
    v_accvgpr_read_b32 v201, a5
    v_accvgpr_read_b32 v202, a6
    v_accvgpr_read_b32 v203, a7
    v_pk_fma_f32 v[200:201], v[200:201], s[80:81], v[212:213] op_sel_hi:[1,1,0]
    v_pk_fma_f32 v[202:203], v[202:203], s[80:81], v[212:213] op_sel_hi:[1,1,0]
    v_exp_f32 v200, v200
    v_exp_f32 v201, v201
    v_exp_f32 v202, v202
    v_exp_f32 v203, v203
    v_xor_b32 v240, 128, v22
    v_cvt_pk_bf16_f32 v232, v196, v197
    v_cvt_pk_bf16_f32 v233, v198, v199
    v_pk_add_f32 v[176:177], v[196:197], v[176:177]
    v_pk_add_f32 v[176:177], v[198:199], v[176:177]
    ds_write_b64 v240, v[232:233]
    s_add_u32 s47, s31, 49152
    buffer_load_dwordx2 a[240:241], v9, s[20:23], s47 offen offset:2048 nt
    v_accvgpr_read_b32 v204, a8
    v_accvgpr_read_b32 v205, a9
    v_accvgpr_read_b32 v206, a10
    v_accvgpr_read_b32 v207, a11
    v_pk_fma_f32 v[204:205], v[204:205], s[80:81], v[212:213] op_sel_hi:[1,1,0]
    v_pk_fma_f32 v[206:207], v[206:207], s[80:81], v[212:213] op_sel_hi:[1,1,0]
    v_exp_f32 v204, v204
    v_exp_f32 v205, v205
    v_exp_f32 v206, v206
    v_exp_f32 v207, v207
    v_xor_b32 v241, 160, v22
    v_cvt_pk_bf16_f32 v234, v200, v201
    v_cvt_pk_bf16_f32 v235, v202, v203
    v_pk_add_f32 v[176:177], v[200:201], v[176:177]
    v_pk_add_f32 v[176:177], v[202:203], v[176:177]
    ds_write_b64 v241, v[234:235]
    v_accvgpr_read_b32 v208, a12
    v_accvgpr_read_b32 v209, a13
    v_accvgpr_read_b32 v210, a14
    v_accvgpr_read_b32 v211, a15
    v_pk_fma_f32 v[208:209], v[208:209], s[80:81], v[212:213] op_sel_hi:[1,1,0]
    v_pk_fma_f32 v[210:211], v[210:211], s[80:81], v[212:213] op_sel_hi:[1,1,0]
    v_exp_f32 v208, v208
    v_exp_f32 v209, v209
    v_exp_f32 v210, v210
    v_exp_f32 v211, v211
    v_xor_b32 v242, 192, v22
    v_cvt_pk_bf16_f32 v236, v204, v205
    v_cvt_pk_bf16_f32 v237, v206, v207
    v_pk_add_f32 v[176:177], v[204:205], v[176:177]
    v_pk_add_f32 v[176:177], v[206:207], v[176:177]
    ds_write_b64 v242, v[236:237]
    s_add_u32 s58, s31, 49152
    buffer_load_dwordx2 a[242:243], v9, s[20:23], s58 offen offset:2560 nt
    v_pk_fma_f32 v[48:49], v[48:49], s[80:81], v[214:215] op_sel_hi:[1,1,0]
    v_pk_fma_f32 v[50:51], v[50:51], s[80:81], v[214:215] op_sel_hi:[1,1,0]
    v_exp_f32 v48, v48
    v_exp_f32 v49, v49
    v_exp_f32 v50, v50
    v_exp_f32 v51, v51
    v_xor_b32 v243, 224, v22
    v_cvt_pk_bf16_f32 v238, v208, v209
    v_cvt_pk_bf16_f32 v239, v210, v211
    v_pk_add_f32 v[176:177], v[208:209], v[176:177]
    v_pk_add_f32 v[176:177], v[210:211], v[176:177]
    ds_write_b64 v243, v[238:239]
    v_pk_fma_f32 v[52:53], v[52:53], s[80:81], v[214:215] op_sel_hi:[1,1,0]
    v_pk_fma_f32 v[54:55], v[54:55], s[80:81], v[214:215] op_sel_hi:[1,1,0]
    v_exp_f32 v52, v52
    v_exp_f32 v53, v53
    v_exp_f32 v54, v54
    v_exp_f32 v55, v55
    v_add_u32 v22, 16384, v21
    v_xor_b32 v240, 0, v22
    v_cvt_pk_bf16_f32 v232, v48, v49
    v_cvt_pk_bf16_f32 v233, v50, v51
    v_pk_add_f32 v[178:179], v[48:49], v[50:51]
    ds_write_b64 v240, v[232:233]
    s_add_u32 s59, s31, 49152
    buffer_load_dwordx2 a[248:249], v9, s[20:23], s59 offen offset:3072 nt
    v_pk_fma_f32 v[56:57], v[56:57], s[80:81], v[214:215] op_sel_hi:[1,1,0]
    v_pk_fma_f32 v[58:59], v[58:59], s[80:81], v[214:215] op_sel_hi:[1,1,0]
    v_exp_f32 v56, v56
    v_exp_f32 v57, v57
    v_exp_f32 v58, v58
    v_exp_f32 v59, v59
    v_xor_b32 v241, 32, v22
    v_cvt_pk_bf16_f32 v234, v52, v53
    v_cvt_pk_bf16_f32 v235, v54, v55
    v_pk_add_f32 v[178:179], v[52:53], v[178:179]
    v_pk_add_f32 v[178:179], v[54:55], v[178:179]
    ds_write_b64 v241, v[234:235]
    v_pk_fma_f32 v[60:61], v[60:61], s[80:81], v[214:215] op_sel_hi:[1,1,0]
    v_pk_fma_f32 v[62:63], v[62:63], s[80:81], v[214:215] op_sel_hi:[1,1,0]
    v_exp_f32 v60, v60
    v_exp_f32 v61, v61
    v_exp_f32 v62, v62
    v_exp_f32 v63, v63
    v_xor_b32 v242, 64, v22
    v_cvt_pk_bf16_f32 v236, v56, v57
    v_cvt_pk_bf16_f32 v237, v58, v59
    v_pk_add_f32 v[178:179], v[56:57], v[178:179]
    v_pk_add_f32 v[178:179], v[58:59], v[178:179]
    ds_write_b64 v242, v[236:237]
    s_add_u32 s46, s31, 49152
    buffer_load_dwordx2 a[250:251], v9, s[20:23], s46 offen offset:3584 nt
    v_accvgpr_read_b32 v196, a16
    v_accvgpr_read_b32 v197, a17
    v_accvgpr_read_b32 v198, a18
    v_accvgpr_read_b32 v199, a19
    v_pk_fma_f32 v[196:197], v[196:197], s[80:81], v[214:215] op_sel_hi:[1,1,0]
    v_pk_fma_f32 v[198:199], v[198:199], s[80:81], v[214:215] op_sel_hi:[1,1,0]
    v_exp_f32 v196, v196
    v_exp_f32 v197, v197
    v_exp_f32 v198, v198
    v_exp_f32 v199, v199
    v_xor_b32 v243, 96, v22
    v_cvt_pk_bf16_f32 v238, v60, v61
    v_cvt_pk_bf16_f32 v239, v62, v63
    v_pk_add_f32 v[178:179], v[60:61], v[178:179]
    v_pk_add_f32 v[178:179], v[62:63], v[178:179]
    ds_write_b64 v243, v[238:239]
    v_accvgpr_read_b32 v200, a20
    v_accvgpr_read_b32 v201, a21
    v_accvgpr_read_b32 v202, a22
    v_accvgpr_read_b32 v203, a23
    v_pk_fma_f32 v[200:201], v[200:201], s[80:81], v[214:215] op_sel_hi:[1,1,0]
    v_pk_fma_f32 v[202:203], v[202:203], s[80:81], v[214:215] op_sel_hi:[1,1,0]
    v_exp_f32 v200, v200
    v_exp_f32 v201, v201
    v_exp_f32 v202, v202
    v_exp_f32 v203, v203
    v_xor_b32 v240, 128, v22
    v_cvt_pk_bf16_f32 v232, v196, v197
    v_cvt_pk_bf16_f32 v233, v198, v199
    v_pk_add_f32 v[178:179], v[196:197], v[178:179]
    v_pk_add_f32 v[178:179], v[198:199], v[178:179]
    ds_write_b64 v240, v[232:233]
    s_add_u32 s47, s31, 65536
    buffer_load_dwordx2 a[228:229], v9, s[20:23], s47 offen nt
    v_accvgpr_read_b32 v204, a24
    v_accvgpr_read_b32 v205, a25
    v_accvgpr_read_b32 v206, a26
    v_accvgpr_read_b32 v207, a27
    v_pk_fma_f32 v[204:205], v[204:205], s[80:81], v[214:215] op_sel_hi:[1,1,0]
    v_pk_fma_f32 v[206:207], v[206:207], s[80:81], v[214:215] op_sel_hi:[1,1,0]
    v_exp_f32 v204, v204
    v_exp_f32 v205, v205
    v_exp_f32 v206, v206
    v_exp_f32 v207, v207
    v_xor_b32 v241, 160, v22
    v_cvt_pk_bf16_f32 v234, v200, v201
    v_cvt_pk_bf16_f32 v235, v202, v203
    v_pk_add_f32 v[178:179], v[200:201], v[178:179]
    v_pk_add_f32 v[178:179], v[202:203], v[178:179]
    ds_write_b64 v241, v[234:235]
    v_accvgpr_read_b32 v208, a28
    v_accvgpr_read_b32 v209, a29
    v_accvgpr_read_b32 v210, a30
    v_accvgpr_read_b32 v211, a31
    v_pk_fma_f32 v[208:209], v[208:209], s[80:81], v[214:215] op_sel_hi:[1,1,0]
    v_pk_fma_f32 v[210:211], v[210:211], s[80:81], v[214:215] op_sel_hi:[1,1,0]
    v_exp_f32 v208, v208
    v_exp_f32 v209, v209
    v_exp_f32 v210, v210
    v_exp_f32 v211, v211
    v_xor_b32 v242, 192, v22
    v_cvt_pk_bf16_f32 v236, v204, v205
    v_cvt_pk_bf16_f32 v237, v206, v207
    v_pk_add_f32 v[178:179], v[204:205], v[178:179]
    v_pk_add_f32 v[178:179], v[206:207], v[178:179]
    ds_write_b64 v242, v[236:237]
    s_add_u32 s58, s31, 65536
    buffer_load_dwordx2 a[230:231], v9, s[20:23], s58 offen offset:512 nt
    v_pk_fma_f32 v[64:65], v[64:65], s[80:81], v[216:217] op_sel_hi:[1,1,0]
    v_pk_fma_f32 v[66:67], v[66:67], s[80:81], v[216:217] op_sel_hi:[1,1,0]
    v_exp_f32 v64, v64
    v_exp_f32 v65, v65
    v_exp_f32 v66, v66
    v_exp_f32 v67, v67
    v_xor_b32 v243, 224, v22
    v_cvt_pk_bf16_f32 v238, v208, v209
    v_cvt_pk_bf16_f32 v239, v210, v211
    v_pk_add_f32 v[178:179], v[208:209], v[178:179]
    v_pk_add_f32 v[178:179], v[210:211], v[178:179]
    ds_write_b64 v243, v[238:239]
    v_pk_fma_f32 v[68:69], v[68:69], s[80:81], v[216:217] op_sel_hi:[1,1,0]
    v_pk_fma_f32 v[70:71], v[70:71], s[80:81], v[216:217] op_sel_hi:[1,1,0]
    v_exp_f32 v68, v68
    v_exp_f32 v69, v69
    v_exp_f32 v70, v70
    v_exp_f32 v71, v71
    v_add_u32 v22, 32768, v21
    v_xor_b32 v240, 0, v22
    v_cvt_pk_bf16_f32 v232, v64, v65
    v_cvt_pk_bf16_f32 v233, v66, v67
    v_pk_add_f32 v[180:181], v[64:65], v[66:67]
    ds_write_b64 v240, v[232:233]
    s_add_u32 s59, s31, 65536
    buffer_load_dwordx2 a[236:237], v9, s[20:23], s59 offen offset:1024 nt
    v_pk_fma_f32 v[72:73], v[72:73], s[80:81], v[216:217] op_sel_hi:[1,1,0]
    v_pk_fma_f32 v[74:75], v[74:75], s[80:81], v[216:217] op_sel_hi:[1,1,0]
    v_exp_f32 v72, v72
    v_exp_f32 v73, v73
    v_exp_f32 v74, v74
    v_exp_f32 v75, v75
    v_xor_b32 v241, 32, v22
    v_cvt_pk_bf16_f32 v234, v68, v69
    v_cvt_pk_bf16_f32 v235, v70, v71
    v_pk_add_f32 v[180:181], v[68:69], v[180:181]
    v_pk_add_f32 v[180:181], v[70:71], v[180:181]
    ds_write_b64 v241, v[234:235]
    v_pk_fma_f32 v[76:77], v[76:77], s[80:81], v[216:217] op_sel_hi:[1,1,0]
    v_pk_fma_f32 v[78:79], v[78:79], s[80:81], v[216:217] op_sel_hi:[1,1,0]
    v_exp_f32 v76, v76
    v_exp_f32 v77, v77
    v_exp_f32 v78, v78
    v_exp_f32 v79, v79
    v_xor_b32 v242, 64, v22
    v_cvt_pk_bf16_f32 v236, v72, v73
    v_cvt_pk_bf16_f32 v237, v74, v75
    v_pk_add_f32 v[180:181], v[72:73], v[180:181]
    v_pk_add_f32 v[180:181], v[74:75], v[180:181]
    ds_write_b64 v242, v[236:237]
    s_add_u32 s46, s31, 65536
    buffer_load_dwordx2 a[238:239], v9, s[20:23], s46 offen offset:1536 nt
    v_accvgpr_read_b32 v196, a32
    v_accvgpr_read_b32 v197, a33
    v_accvgpr_read_b32 v198, a34
    v_accvgpr_read_b32 v199, a35
    v_pk_fma_f32 v[196:197], v[196:197], s[80:81], v[216:217] op_sel_hi:[1,1,0]
    v_pk_fma_f32 v[198:199], v[198:199], s[80:81], v[216:217] op_sel_hi:[1,1,0]
    v_exp_f32 v196, v196
    v_exp_f32 v197, v197
    v_exp_f32 v198, v198
    v_exp_f32 v199, v199
    v_xor_b32 v243, 96, v22
    v_cvt_pk_bf16_f32 v238, v76, v77
    v_cvt_pk_bf16_f32 v239, v78, v79
    v_pk_add_f32 v[180:181], v[76:77], v[180:181]
    v_pk_add_f32 v[180:181], v[78:79], v[180:181]
    ds_write_b64 v243, v[238:239]
    v_accvgpr_read_b32 v200, a36
    v_accvgpr_read_b32 v201, a37
    v_accvgpr_read_b32 v202, a38
    v_accvgpr_read_b32 v203, a39
    v_pk_fma_f32 v[200:201], v[200:201], s[80:81], v[216:217] op_sel_hi:[1,1,0]
    v_pk_fma_f32 v[202:203], v[202:203], s[80:81], v[216:217] op_sel_hi:[1,1,0]
    v_exp_f32 v200, v200
    v_exp_f32 v201, v201
    v_exp_f32 v202, v202
    v_exp_f32 v203, v203
    v_xor_b32 v240, 128, v22
    v_cvt_pk_bf16_f32 v232, v196, v197
    v_cvt_pk_bf16_f32 v233, v198, v199
    v_pk_add_f32 v[180:181], v[196:197], v[180:181]
    v_pk_add_f32 v[180:181], v[198:199], v[180:181]
    ds_write_b64 v240, v[232:233]
    s_add_u32 s47, s31, 65536
    buffer_load_dwordx2 a[244:245], v9, s[20:23], s47 offen offset:2048 nt
    v_accvgpr_read_b32 v204, a40
    v_accvgpr_read_b32 v205, a41
    v_accvgpr_read_b32 v206, a42
    v_accvgpr_read_b32 v207, a43
    v_pk_fma_f32 v[204:205], v[204:205], s[80:81], v[216:217] op_sel_hi:[1,1,0]
    v_pk_fma_f32 v[206:207], v[206:207], s[80:81], v[216:217] op_sel_hi:[1,1,0]
    v_exp_f32 v204, v204
    v_exp_f32 v205, v205
    v_exp_f32 v206, v206
    v_exp_f32 v207, v207
    v_xor_b32 v241, 160, v22
    v_cvt_pk_bf16_f32 v234, v200, v201
    v_cvt_pk_bf16_f32 v235, v202, v203
    v_pk_add_f32 v[180:181], v[200:201], v[180:181]
    v_pk_add_f32 v[180:181], v[202:203], v[180:181]
    ds_write_b64 v241, v[234:235]
    v_accvgpr_read_b32 v208, a44
    v_accvgpr_read_b32 v209, a45
    v_accvgpr_read_b32 v210, a46
    v_accvgpr_read_b32 v211, a47
    v_pk_fma_f32 v[208:209], v[208:209], s[80:81], v[216:217] op_sel_hi:[1,1,0]
    v_pk_fma_f32 v[210:211], v[210:211], s[80:81], v[216:217] op_sel_hi:[1,1,0]
    v_exp_f32 v208, v208
    v_exp_f32 v209, v209
    v_exp_f32 v210, v210
    v_exp_f32 v211, v211
    v_xor_b32 v242, 192, v22
    v_cvt_pk_bf16_f32 v236, v204, v205
    v_cvt_pk_bf16_f32 v237, v206, v207
    v_pk_add_f32 v[180:181], v[204:205], v[180:181]
    v_pk_add_f32 v[180:181], v[206:207], v[180:181]
    ds_write_b64 v242, v[236:237]
    s_add_u32 s58, s31, 65536
    buffer_load_dwordx2 a[246:247], v9, s[20:23], s58 offen offset:2560 nt
    v_pk_fma_f32 v[80:81], v[80:81], s[80:81], v[218:219] op_sel_hi:[1,1,0]
    v_pk_fma_f32 v[82:83], v[82:83], s[80:81], v[218:219] op_sel_hi:[1,1,0]
    v_exp_f32 v80, v80
    v_exp_f32 v81, v81
    v_exp_f32 v82, v82
    v_exp_f32 v83, v83
    v_xor_b32 v243, 224, v22
    v_cvt_pk_bf16_f32 v238, v208, v209
    v_cvt_pk_bf16_f32 v239, v210, v211
    v_pk_add_f32 v[180:181], v[208:209], v[180:181]
    v_pk_add_f32 v[180:181], v[210:211], v[180:181]
    ds_write_b64 v243, v[238:239]
    v_pk_fma_f32 v[84:85], v[84:85], s[80:81], v[218:219] op_sel_hi:[1,1,0]
    v_pk_fma_f32 v[86:87], v[86:87], s[80:81], v[218:219] op_sel_hi:[1,1,0]
    v_exp_f32 v84, v84
    v_exp_f32 v85, v85
    v_exp_f32 v86, v86
    v_exp_f32 v87, v87
    v_add_u32 v22, 49152, v21
    v_xor_b32 v240, 0, v22
    v_cvt_pk_bf16_f32 v232, v80, v81
    v_cvt_pk_bf16_f32 v233, v82, v83
    v_pk_add_f32 v[182:183], v[80:81], v[82:83]
    ds_write_b64 v240, v[232:233]
    s_add_u32 s59, s31, 65536
    buffer_load_dwordx2 a[252:253], v9, s[20:23], s59 offen offset:3072 nt
    v_pk_fma_f32 v[88:89], v[88:89], s[80:81], v[218:219] op_sel_hi:[1,1,0]
    v_pk_fma_f32 v[90:91], v[90:91], s[80:81], v[218:219] op_sel_hi:[1,1,0]
    v_exp_f32 v88, v88
    v_exp_f32 v89, v89
    v_exp_f32 v90, v90
    v_exp_f32 v91, v91
    v_xor_b32 v241, 32, v22
    v_cvt_pk_bf16_f32 v234, v84, v85
    v_cvt_pk_bf16_f32 v235, v86, v87
    v_pk_add_f32 v[182:183], v[84:85], v[182:183]
    v_pk_add_f32 v[182:183], v[86:87], v[182:183]
    ds_write_b64 v241, v[234:235]
    v_pk_fma_f32 v[92:93], v[92:93], s[80:81], v[218:219] op_sel_hi:[1,1,0]
    v_pk_fma_f32 v[94:95], v[94:95], s[80:81], v[218:219] op_sel_hi:[1,1,0]
    v_exp_f32 v92, v92
    v_exp_f32 v93, v93
    v_exp_f32 v94, v94
    v_exp_f32 v95, v95
    v_xor_b32 v242, 64, v22
    v_cvt_pk_bf16_f32 v236, v88, v89
    v_cvt_pk_bf16_f32 v237, v90, v91
    v_pk_add_f32 v[182:183], v[88:89], v[182:183]
    v_pk_add_f32 v[182:183], v[90:91], v[182:183]
    ds_write_b64 v242, v[236:237]
    s_add_u32 s46, s31, 65536
    buffer_load_dwordx2 a[254:255], v9, s[20:23], s46 offen offset:3584 nt
    v_accvgpr_read_b32 v196, a48
    v_accvgpr_read_b32 v197, a49
    v_accvgpr_read_b32 v198, a50
    v_accvgpr_read_b32 v199, a51
    v_pk_fma_f32 v[196:197], v[196:197], s[80:81], v[218:219] op_sel_hi:[1,1,0]
    v_pk_fma_f32 v[198:199], v[198:199], s[80:81], v[218:219] op_sel_hi:[1,1,0]
    v_exp_f32 v196, v196
    v_exp_f32 v197, v197
    v_exp_f32 v198, v198
    v_exp_f32 v199, v199
    v_xor_b32 v243, 96, v22
    v_cvt_pk_bf16_f32 v238, v92, v93
    v_cvt_pk_bf16_f32 v239, v94, v95
    v_pk_add_f32 v[182:183], v[92:93], v[182:183]
    v_pk_add_f32 v[182:183], v[94:95], v[182:183]
    ds_write_b64 v243, v[238:239]
    v_accvgpr_read_b32 v200, a52
    v_accvgpr_read_b32 v201, a53
    v_accvgpr_read_b32 v202, a54
    v_accvgpr_read_b32 v203, a55
    v_pk_fma_f32 v[200:201], v[200:201], s[80:81], v[218:219] op_sel_hi:[1,1,0]
    v_pk_fma_f32 v[202:203], v[202:203], s[80:81], v[218:219] op_sel_hi:[1,1,0]
    v_exp_f32 v200, v200
    v_exp_f32 v201, v201
    v_exp_f32 v202, v202
    v_exp_f32 v203, v203
    v_xor_b32 v240, 128, v22
    v_cvt_pk_bf16_f32 v232, v196, v197
    v_cvt_pk_bf16_f32 v233, v198, v199
    v_pk_add_f32 v[182:183], v[196:197], v[182:183]
    v_pk_add_f32 v[182:183], v[198:199], v[182:183]
    ds_write_b64 v240, v[232:233]
    s_add_u32 s47, s31, 81920
    buffer_load_dwordx2 a[144:145], v9, s[20:23], s47 offen nt
    v_accvgpr_read_b32 v204, a56
    v_accvgpr_read_b32 v205, a57
    v_accvgpr_read_b32 v206, a58
    v_accvgpr_read_b32 v207, a59
    v_pk_fma_f32 v[204:205], v[204:205], s[80:81], v[218:219] op_sel_hi:[1,1,0]
    v_pk_fma_f32 v[206:207], v[206:207], s[80:81], v[218:219] op_sel_hi:[1,1,0]
    v_exp_f32 v204, v204
    v_exp_f32 v205, v205
    v_exp_f32 v206, v206
    v_exp_f32 v207, v207
    v_xor_b32 v241, 160, v22
    v_cvt_pk_bf16_f32 v234, v200, v201
    v_cvt_pk_bf16_f32 v235, v202, v203
    v_pk_add_f32 v[182:183], v[200:201], v[182:183]
    v_pk_add_f32 v[182:183], v[202:203], v[182:183]
    ds_write_b64 v241, v[234:235]
    v_accvgpr_read_b32 v208, a60
    v_accvgpr_read_b32 v209, a61
    v_accvgpr_read_b32 v210, a62
    v_accvgpr_read_b32 v211, a63
    v_pk_fma_f32 v[208:209], v[208:209], s[80:81], v[218:219] op_sel_hi:[1,1,0]
    v_pk_fma_f32 v[210:211], v[210:211], s[80:81], v[218:219] op_sel_hi:[1,1,0]
    v_exp_f32 v208, v208
    v_exp_f32 v209, v209
    v_exp_f32 v210, v210
    v_exp_f32 v211, v211
    v_xor_b32 v242, 192, v22
    v_cvt_pk_bf16_f32 v236, v204, v205
    v_cvt_pk_bf16_f32 v237, v206, v207
    v_pk_add_f32 v[182:183], v[204:205], v[182:183]
    v_pk_add_f32 v[182:183], v[206:207], v[182:183]
    ds_write_b64 v242, v[236:237]
    s_add_u32 s58, s31, 81920
    buffer_load_dwordx2 a[146:147], v9, s[20:23], s58 offen offset:512 nt
    v_pk_fma_f32 v[96:97], v[96:97], s[80:81], v[220:221] op_sel_hi:[1,1,0]
    v_pk_fma_f32 v[98:99], v[98:99], s[80:81], v[220:221] op_sel_hi:[1,1,0]
    v_exp_f32 v96, v96
    v_exp_f32 v97, v97
    v_exp_f32 v98, v98
    v_exp_f32 v99, v99
    v_xor_b32 v243, 224, v22
    v_cvt_pk_bf16_f32 v238, v208, v209
    v_cvt_pk_bf16_f32 v239, v210, v211
    v_pk_add_f32 v[182:183], v[208:209], v[182:183]
    v_pk_add_f32 v[182:183], v[210:211], v[182:183]
    ds_write_b64 v243, v[238:239]
    v_pk_fma_f32 v[100:101], v[100:101], s[80:81], v[220:221] op_sel_hi:[1,1,0]
    v_pk_fma_f32 v[102:103], v[102:103], s[80:81], v[220:221] op_sel_hi:[1,1,0]
    v_exp_f32 v100, v100
    v_exp_f32 v101, v101
    v_exp_f32 v102, v102
    v_exp_f32 v103, v103
    v_add_u32 v22, 65536, v21
    v_xor_b32 v240, 0, v22
    v_cvt_pk_bf16_f32 v232, v96, v97
    v_cvt_pk_bf16_f32 v233, v98, v99
    v_pk_add_f32 v[184:185], v[96:97], v[98:99]
    ds_write_b64 v240, v[232:233]
    s_add_u32 s59, s31, 81920
    buffer_load_dwordx2 a[152:153], v9, s[20:23], s59 offen offset:1024 nt
    v_pk_fma_f32 v[104:105], v[104:105], s[80:81], v[220:221] op_sel_hi:[1,1,0]
    v_pk_fma_f32 v[106:107], v[106:107], s[80:81], v[220:221] op_sel_hi:[1,1,0]
    v_exp_f32 v104, v104
    v_exp_f32 v105, v105
    v_exp_f32 v106, v106
    v_exp_f32 v107, v107
    v_xor_b32 v241, 32, v22
    v_cvt_pk_bf16_f32 v234, v100, v101
    v_cvt_pk_bf16_f32 v235, v102, v103
    v_pk_add_f32 v[184:185], v[100:101], v[184:185]
    v_pk_add_f32 v[184:185], v[102:103], v[184:185]
    ds_write_b64 v241, v[234:235]
    v_pk_fma_f32 v[108:109], v[108:109], s[80:81], v[220:221] op_sel_hi:[1,1,0]
    v_pk_fma_f32 v[110:111], v[110:111], s[80:81], v[220:221] op_sel_hi:[1,1,0]
    v_exp_f32 v108, v108
    v_exp_f32 v109, v109
    v_exp_f32 v110, v110
    v_exp_f32 v111, v111
    v_xor_b32 v242, 64, v22
    v_cvt_pk_bf16_f32 v236, v104, v105
    v_cvt_pk_bf16_f32 v237, v106, v107
    v_pk_add_f32 v[184:185], v[104:105], v[184:185]
    v_pk_add_f32 v[184:185], v[106:107], v[184:185]
    ds_write_b64 v242, v[236:237]
    s_add_u32 s46, s31, 81920
    buffer_load_dwordx2 a[154:155], v9, s[20:23], s46 offen offset:1536 nt
    v_accvgpr_read_b32 v196, a64
    v_accvgpr_read_b32 v197, a65
    v_accvgpr_read_b32 v198, a66
    v_accvgpr_read_b32 v199, a67
    v_pk_fma_f32 v[196:197], v[196:197], s[80:81], v[220:221] op_sel_hi:[1,1,0]
    v_pk_fma_f32 v[198:199], v[198:199], s[80:81], v[220:221] op_sel_hi:[1,1,0]
    v_exp_f32 v196, v196
    v_exp_f32 v197, v197
    v_exp_f32 v198, v198
    v_exp_f32 v199, v199
    v_xor_b32 v243, 96, v22
    v_cvt_pk_bf16_f32 v238, v108, v109
    v_cvt_pk_bf16_f32 v239, v110, v111
    v_pk_add_f32 v[184:185], v[108:109], v[184:185]
    v_pk_add_f32 v[184:185], v[110:111], v[184:185]
    ds_write_b64 v243, v[238:239]
    v_accvgpr_read_b32 v200, a68
    v_accvgpr_read_b32 v201, a69
    v_accvgpr_read_b32 v202, a70
    v_accvgpr_read_b32 v203, a71
    v_pk_fma_f32 v[200:201], v[200:201], s[80:81], v[220:221] op_sel_hi:[1,1,0]
    v_pk_fma_f32 v[202:203], v[202:203], s[80:81], v[220:221] op_sel_hi:[1,1,0]
    v_exp_f32 v200, v200
    v_exp_f32 v201, v201
    v_exp_f32 v202, v202
    v_exp_f32 v203, v203
    v_xor_b32 v240, 128, v22
    v_cvt_pk_bf16_f32 v232, v196, v197
    v_cvt_pk_bf16_f32 v233, v198, v199
    v_pk_add_f32 v[184:185], v[196:197], v[184:185]
    v_pk_add_f32 v[184:185], v[198:199], v[184:185]
    ds_write_b64 v240, v[232:233]
    s_add_u32 s47, s31, 81920
    buffer_load_dwordx2 a[148:149], v9, s[20:23], s47 offen offset:2048 nt
    v_accvgpr_read_b32 v204, a72
    v_accvgpr_read_b32 v205, a73
    v_accvgpr_read_b32 v206, a74
    v_accvgpr_read_b32 v207, a75
    v_pk_fma_f32 v[204:205], v[204:205], s[80:81], v[220:221] op_sel_hi:[1,1,0]
    v_pk_fma_f32 v[206:207], v[206:207], s[80:81], v[220:221] op_sel_hi:[1,1,0]
    v_exp_f32 v204, v204
    v_exp_f32 v205, v205
    v_exp_f32 v206, v206
    v_exp_f32 v207, v207
    v_xor_b32 v241, 160, v22
    v_cvt_pk_bf16_f32 v234, v200, v201
    v_cvt_pk_bf16_f32 v235, v202, v203
    v_pk_add_f32 v[184:185], v[200:201], v[184:185]
    v_pk_add_f32 v[184:185], v[202:203], v[184:185]
    ds_write_b64 v241, v[234:235]
    v_accvgpr_read_b32 v208, a76
    v_accvgpr_read_b32 v209, a77
    v_accvgpr_read_b32 v210, a78
    v_accvgpr_read_b32 v211, a79
    v_pk_fma_f32 v[208:209], v[208:209], s[80:81], v[220:221] op_sel_hi:[1,1,0]
    v_pk_fma_f32 v[210:211], v[210:211], s[80:81], v[220:221] op_sel_hi:[1,1,0]
    v_exp_f32 v208, v208
    v_exp_f32 v209, v209
    v_exp_f32 v210, v210
    v_exp_f32 v211, v211
    v_xor_b32 v242, 192, v22
    v_cvt_pk_bf16_f32 v236, v204, v205
    v_cvt_pk_bf16_f32 v237, v206, v207
    v_pk_add_f32 v[184:185], v[204:205], v[184:185]
    v_pk_add_f32 v[184:185], v[206:207], v[184:185]
    ds_write_b64 v242, v[236:237]
    s_add_u32 s58, s31, 81920
    buffer_load_dwordx2 a[150:151], v9, s[20:23], s58 offen offset:2560 nt
    v_pk_fma_f32 v[112:113], v[112:113], s[80:81], v[222:223] op_sel_hi:[1,1,0]
    v_pk_fma_f32 v[114:115], v[114:115], s[80:81], v[222:223] op_sel_hi:[1,1,0]
    v_exp_f32 v112, v112
    v_exp_f32 v113, v113
    v_exp_f32 v114, v114
    v_exp_f32 v115, v115
    v_xor_b32 v243, 224, v22
    v_cvt_pk_bf16_f32 v238, v208, v209
    v_cvt_pk_bf16_f32 v239, v210, v211
    v_pk_add_f32 v[184:185], v[208:209], v[184:185]
    v_pk_add_f32 v[184:185], v[210:211], v[184:185]
    ds_write_b64 v243, v[238:239]
    v_pk_fma_f32 v[116:117], v[116:117], s[80:81], v[222:223] op_sel_hi:[1,1,0]
    v_pk_fma_f32 v[118:119], v[118:119], s[80:81], v[222:223] op_sel_hi:[1,1,0]
    v_exp_f32 v116, v116
    v_exp_f32 v117, v117
    v_exp_f32 v118, v118
    v_exp_f32 v119, v119
    v_add_u32 v22, 81920, v21
    v_xor_b32 v240, 0, v22
    v_cvt_pk_bf16_f32 v232, v112, v113
    v_cvt_pk_bf16_f32 v233, v114, v115
    v_pk_add_f32 v[186:187], v[112:113], v[114:115]
    ds_write_b64 v240, v[232:233]
    s_add_u32 s59, s31, 81920
    buffer_load_dwordx2 a[160:161], v9, s[20:23], s59 offen offset:3072 nt
    v_pk_fma_f32 v[120:121], v[120:121], s[80:81], v[222:223] op_sel_hi:[1,1,0]
    v_pk_fma_f32 v[122:123], v[122:123], s[80:81], v[222:223] op_sel_hi:[1,1,0]
    v_exp_f32 v120, v120
    v_exp_f32 v121, v121
    v_exp_f32 v122, v122
    v_exp_f32 v123, v123
    v_xor_b32 v241, 32, v22
    v_cvt_pk_bf16_f32 v234, v116, v117
    v_cvt_pk_bf16_f32 v235, v118, v119
    v_pk_add_f32 v[186:187], v[116:117], v[186:187]
    v_pk_add_f32 v[186:187], v[118:119], v[186:187]
    ds_write_b64 v241, v[234:235]
    v_pk_fma_f32 v[124:125], v[124:125], s[80:81], v[222:223] op_sel_hi:[1,1,0]
    v_pk_fma_f32 v[126:127], v[126:127], s[80:81], v[222:223] op_sel_hi:[1,1,0]
    v_exp_f32 v124, v124
    v_exp_f32 v125, v125
    v_exp_f32 v126, v126
    v_exp_f32 v127, v127
    v_xor_b32 v242, 64, v22
    v_cvt_pk_bf16_f32 v236, v120, v121
    v_cvt_pk_bf16_f32 v237, v122, v123
    v_pk_add_f32 v[186:187], v[120:121], v[186:187]
    v_pk_add_f32 v[186:187], v[122:123], v[186:187]
    ds_write_b64 v242, v[236:237]
    s_add_u32 s46, s31, 81920
    buffer_load_dwordx2 a[162:163], v9, s[20:23], s46 offen offset:3584 nt
    v_accvgpr_read_b32 v196, a80
    v_accvgpr_read_b32 v197, a81
    v_accvgpr_read_b32 v198, a82
    v_accvgpr_read_b32 v199, a83
    v_pk_fma_f32 v[196:197], v[196:197], s[80:81], v[222:223] op_sel_hi:[1,1,0]
    v_pk_fma_f32 v[198:199], v[198:199], s[80:81], v[222:223] op_sel_hi:[1,1,0]
    v_exp_f32 v196, v196
    v_exp_f32 v197, v197
    v_exp_f32 v198, v198
    v_exp_f32 v199, v199
    v_xor_b32 v243, 96, v22
    v_cvt_pk_bf16_f32 v238, v124, v125
    v_cvt_pk_bf16_f32 v239, v126, v127
    v_pk_add_f32 v[186:187], v[124:125], v[186:187]
    v_pk_add_f32 v[186:187], v[126:127], v[186:187]
    ds_write_b64 v243, v[238:239]
    v_accvgpr_read_b32 v200, a84
    v_accvgpr_read_b32 v201, a85
    v_accvgpr_read_b32 v202, a86
    v_accvgpr_read_b32 v203, a87
    v_pk_fma_f32 v[200:201], v[200:201], s[80:81], v[222:223] op_sel_hi:[1,1,0]
    v_pk_fma_f32 v[202:203], v[202:203], s[80:81], v[222:223] op_sel_hi:[1,1,0]
    v_exp_f32 v200, v200
    v_exp_f32 v201, v201
    v_exp_f32 v202, v202
    v_exp_f32 v203, v203
    v_xor_b32 v240, 128, v22
    v_cvt_pk_bf16_f32 v232, v196, v197
    v_cvt_pk_bf16_f32 v233, v198, v199
    v_pk_add_f32 v[186:187], v[196:197], v[186:187]
    v_pk_add_f32 v[186:187], v[198:199], v[186:187]
    ds_write_b64 v240, v[232:233]
    s_add_u32 s47, s31, 98304
    buffer_load_dwordx2 a[176:177], v9, s[20:23], s47 offen nt
    v_accvgpr_read_b32 v204, a88
    v_accvgpr_read_b32 v205, a89
    v_accvgpr_read_b32 v206, a90
    v_accvgpr_read_b32 v207, a91
    v_pk_fma_f32 v[204:205], v[204:205], s[80:81], v[222:223] op_sel_hi:[1,1,0]
    v_pk_fma_f32 v[206:207], v[206:207], s[80:81], v[222:223] op_sel_hi:[1,1,0]
    v_exp_f32 v204, v204
    v_exp_f32 v205, v205
    v_exp_f32 v206, v206
    v_exp_f32 v207, v207
    v_xor_b32 v241, 160, v22
    v_cvt_pk_bf16_f32 v234, v200, v201
    v_cvt_pk_bf16_f32 v235, v202, v203
    v_pk_add_f32 v[186:187], v[200:201], v[186:187]
    v_pk_add_f32 v[186:187], v[202:203], v[186:187]
    ds_write_b64 v241, v[234:235]
    v_accvgpr_read_b32 v208, a92
    v_accvgpr_read_b32 v209, a93
    v_accvgpr_read_b32 v210, a94
    v_accvgpr_read_b32 v211, a95
    v_pk_fma_f32 v[208:209], v[208:209], s[80:81], v[222:223] op_sel_hi:[1,1,0]
    v_pk_fma_f32 v[210:211], v[210:211], s[80:81], v[222:223] op_sel_hi:[1,1,0]
    v_exp_f32 v208, v208
    v_exp_f32 v209, v209
    v_exp_f32 v210, v210
    v_exp_f32 v211, v211
    v_xor_b32 v242, 192, v22
    v_cvt_pk_bf16_f32 v236, v204, v205
    v_cvt_pk_bf16_f32 v237, v206, v207
    v_pk_add_f32 v[186:187], v[204:205], v[186:187]
    v_pk_add_f32 v[186:187], v[206:207], v[186:187]
    ds_write_b64 v242, v[236:237]
    s_add_u32 s58, s31, 98304
    buffer_load_dwordx2 a[178:179], v9, s[20:23], s58 offen offset:512 nt
    v_pk_fma_f32 v[128:129], v[128:129], s[80:81], v[224:225] op_sel_hi:[1,1,0]
    v_pk_fma_f32 v[130:131], v[130:131], s[80:81], v[224:225] op_sel_hi:[1,1,0]
    v_exp_f32 v128, v128
    v_exp_f32 v129, v129
    v_exp_f32 v130, v130
    v_exp_f32 v131, v131
    v_xor_b32 v243, 224, v22
    v_cvt_pk_bf16_f32 v238, v208, v209
    v_cvt_pk_bf16_f32 v239, v210, v211
    v_pk_add_f32 v[186:187], v[208:209], v[186:187]
    v_pk_add_f32 v[186:187], v[210:211], v[186:187]
    ds_write_b64 v243, v[238:239]
    v_pk_fma_f32 v[132:133], v[132:133], s[80:81], v[224:225] op_sel_hi:[1,1,0]
    v_pk_fma_f32 v[134:135], v[134:135], s[80:81], v[224:225] op_sel_hi:[1,1,0]
    v_exp_f32 v132, v132
    v_exp_f32 v133, v133
    v_exp_f32 v134, v134
    v_exp_f32 v135, v135
    v_add_u32 v22, 98304, v21
    v_xor_b32 v240, 0, v22
    v_cvt_pk_bf16_f32 v232, v128, v129
    v_cvt_pk_bf16_f32 v233, v130, v131
    v_pk_add_f32 v[188:189], v[128:129], v[130:131]
    ds_write_b64 v240, v[232:233]
    s_add_u32 s59, s31, 98304
    buffer_load_dwordx2 a[156:157], v9, s[20:23], s59 offen offset:1024 nt
    v_pk_fma_f32 v[136:137], v[136:137], s[80:81], v[224:225] op_sel_hi:[1,1,0]
    v_pk_fma_f32 v[138:139], v[138:139], s[80:81], v[224:225] op_sel_hi:[1,1,0]
    v_exp_f32 v136, v136
    v_exp_f32 v137, v137
    v_exp_f32 v138, v138
    v_exp_f32 v139, v139
    v_xor_b32 v241, 32, v22
    v_cvt_pk_bf16_f32 v234, v132, v133
    v_cvt_pk_bf16_f32 v235, v134, v135
    v_pk_add_f32 v[188:189], v[132:133], v[188:189]
    v_pk_add_f32 v[188:189], v[134:135], v[188:189]
    ds_write_b64 v241, v[234:235]
    v_pk_fma_f32 v[140:141], v[140:141], s[80:81], v[224:225] op_sel_hi:[1,1,0]
    v_pk_fma_f32 v[142:143], v[142:143], s[80:81], v[224:225] op_sel_hi:[1,1,0]
    v_exp_f32 v140, v140
    v_exp_f32 v141, v141
    v_exp_f32 v142, v142
    v_exp_f32 v143, v143
    v_xor_b32 v242, 64, v22
    v_cvt_pk_bf16_f32 v236, v136, v137
    v_cvt_pk_bf16_f32 v237, v138, v139
    v_pk_add_f32 v[188:189], v[136:137], v[188:189]
    v_pk_add_f32 v[188:189], v[138:139], v[188:189]
    ds_write_b64 v242, v[236:237]
    s_add_u32 s46, s31, 98304
    buffer_load_dwordx2 a[158:159], v9, s[20:23], s46 offen offset:1536 nt
    v_accvgpr_read_b32 v196, a96
    v_accvgpr_read_b32 v197, a97
    v_accvgpr_read_b32 v198, a98
    v_accvgpr_read_b32 v199, a99
    v_pk_fma_f32 v[196:197], v[196:197], s[80:81], v[224:225] op_sel_hi:[1,1,0]
    v_pk_fma_f32 v[198:199], v[198:199], s[80:81], v[224:225] op_sel_hi:[1,1,0]
    v_exp_f32 v196, v196
    v_exp_f32 v197, v197
    v_exp_f32 v198, v198
    v_exp_f32 v199, v199
    v_xor_b32 v243, 96, v22
    v_cvt_pk_bf16_f32 v238, v140, v141
    v_cvt_pk_bf16_f32 v239, v142, v143
    v_pk_add_f32 v[188:189], v[140:141], v[188:189]
    v_pk_add_f32 v[188:189], v[142:143], v[188:189]
    ds_write_b64 v243, v[238:239]
    v_accvgpr_read_b32 v200, a100
    v_accvgpr_read_b32 v201, a101
    v_accvgpr_read_b32 v202, a102
    v_accvgpr_read_b32 v203, a103
    v_pk_fma_f32 v[200:201], v[200:201], s[80:81], v[224:225] op_sel_hi:[1,1,0]
    v_pk_fma_f32 v[202:203], v[202:203], s[80:81], v[224:225] op_sel_hi:[1,1,0]
    v_exp_f32 v200, v200
    v_exp_f32 v201, v201
    v_exp_f32 v202, v202
    v_exp_f32 v203, v203
    v_xor_b32 v240, 128, v22
    v_cvt_pk_bf16_f32 v232, v196, v197
    v_cvt_pk_bf16_f32 v233, v198, v199
    v_pk_add_f32 v[188:189], v[196:197], v[188:189]
    v_pk_add_f32 v[188:189], v[198:199], v[188:189]
    ds_write_b64 v240, v[232:233]
    s_add_u32 s47, s31, 98304
    buffer_load_dwordx2 a[168:169], v9, s[20:23], s47 offen offset:2048 nt
    v_accvgpr_read_b32 v204, a104
    v_accvgpr_read_b32 v205, a105
    v_accvgpr_read_b32 v206, a106
    v_accvgpr_read_b32 v207, a107
    v_pk_fma_f32 v[204:205], v[204:205], s[80:81], v[224:225] op_sel_hi:[1,1,0]
    v_pk_fma_f32 v[206:207], v[206:207], s[80:81], v[224:225] op_sel_hi:[1,1,0]
    v_exp_f32 v204, v204
    v_exp_f32 v205, v205
    v_exp_f32 v206, v206
    v_exp_f32 v207, v207
    v_xor_b32 v241, 160, v22
    v_cvt_pk_bf16_f32 v234, v200, v201
    v_cvt_pk_bf16_f32 v235, v202, v203
    v_pk_add_f32 v[188:189], v[200:201], v[188:189]
    v_pk_add_f32 v[188:189], v[202:203], v[188:189]
    ds_write_b64 v241, v[234:235]
    v_accvgpr_read_b32 v208, a108
    v_accvgpr_read_b32 v209, a109
    v_accvgpr_read_b32 v210, a110
    v_accvgpr_read_b32 v211, a111
    v_pk_fma_f32 v[208:209], v[208:209], s[80:81], v[224:225] op_sel_hi:[1,1,0]
    v_pk_fma_f32 v[210:211], v[210:211], s[80:81], v[224:225] op_sel_hi:[1,1,0]
    v_exp_f32 v208, v208
    v_exp_f32 v209, v209
    v_exp_f32 v210, v210
    v_exp_f32 v211, v211
    v_xor_b32 v242, 192, v22
    v_cvt_pk_bf16_f32 v236, v204, v205
    v_cvt_pk_bf16_f32 v237, v206, v207
    v_pk_add_f32 v[188:189], v[204:205], v[188:189]
    v_pk_add_f32 v[188:189], v[206:207], v[188:189]
    ds_write_b64 v242, v[236:237]
    s_add_u32 s58, s31, 98304
    buffer_load_dwordx2 a[170:171], v9, s[20:23], s58 offen offset:2560 nt
    v_pk_fma_f32 v[144:145], v[144:145], s[80:81], v[226:227] op_sel_hi:[1,1,0]
    v_pk_fma_f32 v[146:147], v[146:147], s[80:81], v[226:227] op_sel_hi:[1,1,0]
    v_exp_f32 v144, v144
    v_exp_f32 v145, v145
    v_exp_f32 v146, v146
    v_exp_f32 v147, v147
    v_xor_b32 v243, 224, v22
    v_cvt_pk_bf16_f32 v238, v208, v209
    v_cvt_pk_bf16_f32 v239, v210, v211
    v_pk_add_f32 v[188:189], v[208:209], v[188:189]
    v_pk_add_f32 v[188:189], v[210:211], v[188:189]
    ds_write_b64 v243, v[238:239]
    v_pk_fma_f32 v[148:149], v[148:149], s[80:81], v[226:227] op_sel_hi:[1,1,0]
    v_pk_fma_f32 v[150:151], v[150:151], s[80:81], v[226:227] op_sel_hi:[1,1,0]
    v_exp_f32 v148, v148
    v_exp_f32 v149, v149
    v_exp_f32 v150, v150
    v_exp_f32 v151, v151
    v_add_u32 v22, 114688, v21
    v_xor_b32 v240, 0, v22
    v_cvt_pk_bf16_f32 v232, v144, v145
    v_cvt_pk_bf16_f32 v233, v146, v147
    v_pk_add_f32 v[190:191], v[144:145], v[146:147]
    ds_write_b64 v240, v[232:233]
    s_add_u32 s59, s31, 98304
    buffer_load_dwordx2 a[184:185], v9, s[20:23], s59 offen offset:3072 nt
    v_pk_fma_f32 v[152:153], v[152:153], s[80:81], v[226:227] op_sel_hi:[1,1,0]
    v_pk_fma_f32 v[154:155], v[154:155], s[80:81], v[226:227] op_sel_hi:[1,1,0]
    v_exp_f32 v152, v152
    v_exp_f32 v153, v153
    v_exp_f32 v154, v154
    v_exp_f32 v155, v155
    v_xor_b32 v241, 32, v22
    v_cvt_pk_bf16_f32 v234, v148, v149
    v_cvt_pk_bf16_f32 v235, v150, v151
    v_pk_add_f32 v[190:191], v[148:149], v[190:191]
    v_pk_add_f32 v[190:191], v[150:151], v[190:191]
    ds_write_b64 v241, v[234:235]
    v_pk_fma_f32 v[156:157], v[156:157], s[80:81], v[226:227] op_sel_hi:[1,1,0]
    v_pk_fma_f32 v[158:159], v[158:159], s[80:81], v[226:227] op_sel_hi:[1,1,0]
    v_exp_f32 v156, v156
    v_exp_f32 v157, v157
    v_exp_f32 v158, v158
    v_exp_f32 v159, v159
    v_xor_b32 v242, 64, v22
    v_cvt_pk_bf16_f32 v236, v152, v153
    v_cvt_pk_bf16_f32 v237, v154, v155
    v_pk_add_f32 v[190:191], v[152:153], v[190:191]
    v_pk_add_f32 v[190:191], v[154:155], v[190:191]
    ds_write_b64 v242, v[236:237]
    s_add_u32 s46, s31, 98304
    buffer_load_dwordx2 a[186:187], v9, s[20:23], s46 offen offset:3584 nt
    v_accvgpr_read_b32 v196, a112
    v_accvgpr_read_b32 v197, a113
    v_accvgpr_read_b32 v198, a114
    v_accvgpr_read_b32 v199, a115
    v_pk_fma_f32 v[196:197], v[196:197], s[80:81], v[226:227] op_sel_hi:[1,1,0]
    v_pk_fma_f32 v[198:199], v[198:199], s[80:81], v[226:227] op_sel_hi:[1,1,0]
    v_exp_f32 v196, v196
    v_exp_f32 v197, v197
    v_exp_f32 v198, v198
    v_exp_f32 v199, v199
    v_xor_b32 v243, 96, v22
    v_cvt_pk_bf16_f32 v238, v156, v157
    v_cvt_pk_bf16_f32 v239, v158, v159
    v_pk_add_f32 v[190:191], v[156:157], v[190:191]
    v_pk_add_f32 v[190:191], v[158:159], v[190:191]
    ds_write_b64 v243, v[238:239]
    v_accvgpr_read_b32 v200, a116
    v_accvgpr_read_b32 v201, a117
    v_accvgpr_read_b32 v202, a118
    v_accvgpr_read_b32 v203, a119
    v_pk_fma_f32 v[200:201], v[200:201], s[80:81], v[226:227] op_sel_hi:[1,1,0]
    v_pk_fma_f32 v[202:203], v[202:203], s[80:81], v[226:227] op_sel_hi:[1,1,0]
    v_exp_f32 v200, v200
    v_exp_f32 v201, v201
    v_exp_f32 v202, v202
    v_exp_f32 v203, v203
    v_xor_b32 v240, 128, v22
    v_cvt_pk_bf16_f32 v232, v196, v197
    v_cvt_pk_bf16_f32 v233, v198, v199
    v_pk_add_f32 v[190:191], v[196:197], v[190:191]
    v_pk_add_f32 v[190:191], v[198:199], v[190:191]
    ds_write_b64 v240, v[232:233]
    s_add_u32 s47, s31, 114688
    buffer_load_dwordx2 v[32:33], v9, s[20:23], s47 offen nt
    v_accvgpr_read_b32 v204, a120
    v_accvgpr_read_b32 v205, a121
    v_accvgpr_read_b32 v206, a122
    v_accvgpr_read_b32 v207, a123
    v_pk_fma_f32 v[204:205], v[204:205], s[80:81], v[226:227] op_sel_hi:[1,1,0]
    v_pk_fma_f32 v[206:207], v[206:207], s[80:81], v[226:227] op_sel_hi:[1,1,0]
    v_exp_f32 v204, v204
    v_exp_f32 v205, v205
    v_exp_f32 v206, v206
    v_exp_f32 v207, v207
    v_xor_b32 v241, 160, v22
    v_cvt_pk_bf16_f32 v234, v200, v201
    v_cvt_pk_bf16_f32 v235, v202, v203
    v_pk_add_f32 v[190:191], v[200:201], v[190:191]
    v_pk_add_f32 v[190:191], v[202:203], v[190:191]
    ds_write_b64 v241, v[234:235]
    v_accvgpr_read_b32 v208, a124
    v_accvgpr_read_b32 v209, a125
    v_accvgpr_read_b32 v210, a126
    v_accvgpr_read_b32 v211, a127
    v_pk_fma_f32 v[208:209], v[208:209], s[80:81], v[226:227] op_sel_hi:[1,1,0]
    v_pk_fma_f32 v[210:211], v[210:211], s[80:81], v[226:227] op_sel_hi:[1,1,0]
    v_exp_f32 v208, v208
    v_exp_f32 v209, v209
    v_exp_f32 v210, v210
    v_exp_f32 v211, v211
    v_xor_b32 v242, 192, v22
    v_cvt_pk_bf16_f32 v236, v204, v205
    v_cvt_pk_bf16_f32 v237, v206, v207
    v_pk_add_f32 v[190:191], v[204:205], v[190:191]
    v_pk_add_f32 v[190:191], v[206:207], v[190:191]
    ds_write_b64 v242, v[236:237]
    s_add_u32 s58, s31, 114688
    buffer_load_dwordx2 v[34:35], v9, s[20:23], s58 offen offset:512 nt
    v_pk_fma_f32 v[160:161], v[160:161], s[80:81], v[228:229] op_sel_hi:[1,1,0]
    v_pk_fma_f32 v[162:163], v[162:163], s[80:81], v[228:229] op_sel_hi:[1,1,0]
    v_exp_f32 v160, v160
    v_exp_f32 v161, v161
    v_exp_f32 v162, v162
    v_exp_f32 v163, v163
    v_xor_b32 v243, 224, v22
    v_cvt_pk_bf16_f32 v238, v208, v209
    v_cvt_pk_bf16_f32 v239, v210, v211
    v_pk_add_f32 v[190:191], v[208:209], v[190:191]
    v_pk_add_f32 v[190:191], v[210:211], v[190:191]
    ds_write_b64 v243, v[238:239]
    v_pk_fma_f32 v[164:165], v[164:165], s[80:81], v[228:229] op_sel_hi:[1,1,0]
    v_pk_fma_f32 v[166:167], v[166:167], s[80:81], v[228:229] op_sel_hi:[1,1,0]
    v_exp_f32 v164, v164
    v_exp_f32 v165, v165
    v_exp_f32 v166, v166
    v_exp_f32 v167, v167
    v_add_u32 v22, 131072, v21
    v_xor_b32 v240, 0, v22
    v_cvt_pk_bf16_f32 v232, v160, v161
    v_cvt_pk_bf16_f32 v233, v162, v163
    v_pk_add_f32 v[192:193], v[160:161], v[162:163]
    ds_write_b64 v240, v[232:233]
    s_add_u32 s59, s31, 114688
    buffer_load_dwordx2 v[36:37], v9, s[20:23], s59 offen offset:1024 nt
    v_pk_fma_f32 v[168:169], v[168:169], s[80:81], v[228:229] op_sel_hi:[1,1,0]
    v_pk_fma_f32 v[170:171], v[170:171], s[80:81], v[228:229] op_sel_hi:[1,1,0]
    v_exp_f32 v168, v168
    v_exp_f32 v169, v169
    v_exp_f32 v170, v170
    v_exp_f32 v171, v171
    v_xor_b32 v241, 32, v22
    v_cvt_pk_bf16_f32 v234, v164, v165
    v_cvt_pk_bf16_f32 v235, v166, v167
    v_pk_add_f32 v[192:193], v[164:165], v[192:193]
    v_pk_add_f32 v[192:193], v[166:167], v[192:193]
    ds_write_b64 v241, v[234:235]
    v_pk_fma_f32 v[172:173], v[172:173], s[80:81], v[228:229] op_sel_hi:[1,1,0]
    v_pk_fma_f32 v[174:175], v[174:175], s[80:81], v[228:229] op_sel_hi:[1,1,0]
    v_exp_f32 v172, v172
    v_exp_f32 v173, v173
    v_exp_f32 v174, v174
    v_exp_f32 v175, v175
    v_xor_b32 v242, 64, v22
    v_cvt_pk_bf16_f32 v236, v168, v169
    v_cvt_pk_bf16_f32 v237, v170, v171
    v_pk_add_f32 v[192:193], v[168:169], v[192:193]
    v_pk_add_f32 v[192:193], v[170:171], v[192:193]
    ds_write_b64 v242, v[236:237]
    s_add_u32 s46, s31, 114688
    buffer_load_dwordx2 v[38:39], v9, s[20:23], s46 offen offset:1536 nt
    v_accvgpr_read_b32 v196, a128
    v_accvgpr_read_b32 v197, a129
    v_accvgpr_read_b32 v198, a130
    v_accvgpr_read_b32 v199, a131
    v_pk_fma_f32 v[196:197], v[196:197], s[80:81], v[228:229] op_sel_hi:[1,1,0]
    v_pk_fma_f32 v[198:199], v[198:199], s[80:81], v[228:229] op_sel_hi:[1,1,0]
    v_exp_f32 v196, v196
    v_exp_f32 v197, v197
    v_exp_f32 v198, v198
    v_exp_f32 v199, v199
    v_xor_b32 v243, 96, v22
    v_cvt_pk_bf16_f32 v238, v172, v173
    v_cvt_pk_bf16_f32 v239, v174, v175
    v_pk_add_f32 v[192:193], v[172:173], v[192:193]
    v_pk_add_f32 v[192:193], v[174:175], v[192:193]
    ds_write_b64 v243, v[238:239]
    v_accvgpr_read_b32 v200, a132
    v_accvgpr_read_b32 v201, a133
    v_accvgpr_read_b32 v202, a134
    v_accvgpr_read_b32 v203, a135
    v_pk_fma_f32 v[200:201], v[200:201], s[80:81], v[228:229] op_sel_hi:[1,1,0]
    v_pk_fma_f32 v[202:203], v[202:203], s[80:81], v[228:229] op_sel_hi:[1,1,0]
    v_exp_f32 v200, v200
    v_exp_f32 v201, v201
    v_exp_f32 v202, v202
    v_exp_f32 v203, v203
    v_xor_b32 v240, 128, v22
    v_cvt_pk_bf16_f32 v232, v196, v197
    v_cvt_pk_bf16_f32 v233, v198, v199
    v_pk_add_f32 v[192:193], v[196:197], v[192:193]
    v_pk_add_f32 v[192:193], v[198:199], v[192:193]
    ds_write_b64 v240, v[232:233]
    s_add_u32 s47, s31, 114688
    buffer_load_dwordx2 v[40:41], v9, s[20:23], s47 offen offset:2048 nt
    v_accvgpr_read_b32 v204, a136
    v_accvgpr_read_b32 v205, a137
    v_accvgpr_read_b32 v206, a138
    v_accvgpr_read_b32 v207, a139
    v_pk_fma_f32 v[204:205], v[204:205], s[80:81], v[228:229] op_sel_hi:[1,1,0]
    v_pk_fma_f32 v[206:207], v[206:207], s[80:81], v[228:229] op_sel_hi:[1,1,0]
    v_exp_f32 v204, v204
    v_exp_f32 v205, v205
    v_exp_f32 v206, v206
    v_exp_f32 v207, v207
    v_xor_b32 v241, 160, v22
    v_cvt_pk_bf16_f32 v234, v200, v201
    v_cvt_pk_bf16_f32 v235, v202, v203
    v_pk_add_f32 v[192:193], v[200:201], v[192:193]
    v_pk_add_f32 v[192:193], v[202:203], v[192:193]
    ds_write_b64 v241, v[234:235]
    v_accvgpr_read_b32 v208, a140
    v_accvgpr_read_b32 v209, a141
    v_accvgpr_read_b32 v210, a142
    v_accvgpr_read_b32 v211, a143
    v_pk_fma_f32 v[208:209], v[208:209], s[80:81], v[228:229] op_sel_hi:[1,1,0]
    v_pk_fma_f32 v[210:211], v[210:211], s[80:81], v[228:229] op_sel_hi:[1,1,0]
    v_exp_f32 v208, v208
    v_exp_f32 v209, v209
    v_exp_f32 v210, v210
    v_exp_f32 v211, v211
    v_xor_b32 v242, 192, v22
    v_cvt_pk_bf16_f32 v236, v204, v205
    v_cvt_pk_bf16_f32 v237, v206, v207
    v_pk_add_f32 v[192:193], v[204:205], v[192:193]
    v_pk_add_f32 v[192:193], v[206:207], v[192:193]
    ds_write_b64 v242, v[236:237]
    s_add_u32 s58, s31, 114688
    buffer_load_dwordx2 v[42:43], v9, s[20:23], s58 offen offset:2560 nt
    v_xor_b32 v243, 224, v22
    v_cvt_pk_bf16_f32 v238, v208, v209
    v_cvt_pk_bf16_f32 v239, v210, v211
    v_pk_add_f32 v[192:193], v[208:209], v[192:193]
    v_pk_add_f32 v[192:193], v[210:211], v[192:193]
    ds_write_b64 v243, v[238:239]
    v_mul_u32_u24 v28, 576, v27
    v_lshl_add_u32 v28, v2, 2, v28
    v_add_u32 v28, 149760, v28
    v_add_f32 v176, v176, v177
    v_add_f32 v178, v178, v179
    v_add_f32 v180, v180, v181
    v_add_f32 v182, v182, v183
    v_add_f32 v184, v184, v185
    v_add_f32 v186, v186, v187
    v_add_f32 v188, v188, v189
    v_add_f32 v190, v190, v191
    v_add_f32 v192, v192, v193
    v_mov_b32 v177, v176
    v_mov_b32 v179, v178
    v_mov_b32 v181, v180
    v_mov_b32 v183, v182
    v_mov_b32 v185, v184
    v_mov_b32 v187, v186
    v_mov_b32 v189, v188
    v_mov_b32 v191, v190
    v_mov_b32 v193, v192
    v_permlane32_swap_b32 v177, v176
    v_permlane32_swap_b32 v179, v178
    v_permlane32_swap_b32 v181, v180
    v_permlane32_swap_b32 v183, v182
    v_permlane32_swap_b32 v185, v184
    v_permlane32_swap_b32 v187, v186
    v_permlane32_swap_b32 v189, v188
    v_permlane32_swap_b32 v191, v190
    v_permlane32_swap_b32 v193, v192
    v_add_f32 v176, v177, v176
    v_add_f32 v178, v179, v178
    v_add_f32 v180, v181, v180
    v_add_f32 v182, v183, v182
    v_add_f32 v184, v185, v184
    v_add_f32 v186, v187, v186
    v_add_f32 v188, v189, v188
    v_add_f32 v190, v191, v190
    v_add_f32 v192, v193, v192
    v_mov_b32 v177, v176
    v_mov_b32 v179, v178
    v_mov_b32 v181, v180
    v_mov_b32 v183, v182
    v_mov_b32 v185, v184
    v_mov_b32 v187, v186
    v_mov_b32 v189, v188
    v_mov_b32 v191, v190
    v_mov_b32 v193, v192
    v_permlane16_swap_b32 v177, v176
    v_permlane16_swap_b32 v179, v178
    v_permlane16_swap_b32 v181, v180
    v_permlane16_swap_b32 v183, v182
    v_permlane16_swap_b32 v185, v184
    v_permlane16_swap_b32 v187, v186
    v_permlane16_swap_b32 v189, v188
    v_permlane16_swap_b32 v191, v190
    v_permlane16_swap_b32 v193, v192
    v_add_f32 v176, v177, v176
    ds_write_b32 v28, v176
    v_add_f32 v178, v179, v178
    ds_write_b32 v28, v178 offset:64
    v_add_f32 v180, v181, v180
    ds_write_b32 v28, v180 offset:128
    v_add_f32 v182, v183, v182
    ds_write_b32 v28, v182 offset:192
    v_add_f32 v184, v185, v184
    ds_write_b32 v28, v184 offset:256
    v_add_f32 v186, v187, v186
    ds_write_b32 v28, v186 offset:320
    v_add_f32 v188, v189, v188
    ds_write_b32 v28, v188 offset:384
    v_add_f32 v190, v191, v190
    ds_write_b32 v28, v190 offset:448
    v_add_f32 v192, v193, v192
    ds_write_b32 v28, v192 offset:512
    s_waitcnt lgkmcnt(0)
    s_barrier
    v_xor_b32 v24, 0, v23
    v_add_u32 v25, 65536, v24
    v_add_u32 v26, 131072, v24
    ds_read_b128 v[176:179], v24
    ds_read_b128 v[180:183], v24 offset:16384
    ds_read_b128 v[184:187], v24 offset:32768
    ds_read_b128 v[188:191], v24 offset:49152
    ds_read_b128 v[192:195], v25
    ds_read_b128 v[196:199], v25 offset:16384
    ds_read_b128 v[200:203], v25 offset:32768
    ds_read_b128 v[204:207], v25 offset:49152
    ds_read_b128 v[208:211], v26
    s_waitcnt vmcnt(54)
    v_accvgpr_read_b32 v244, a164
    v_accvgpr_read_b32 v245, a165
    v_accvgpr_read_b32 v246, a166
    v_accvgpr_read_b32 v247, a167
    v_accvgpr_read_b32 v248, a172
    v_accvgpr_read_b32 v249, a173
    v_accvgpr_read_b32 v250, a174
    v_accvgpr_read_b32 v251, a175
    v_accvgpr_read_b32 v252, a180
    v_accvgpr_read_b32 v253, a181
    v_accvgpr_read_b32 v254, a182
    v_accvgpr_read_b32 v255, a183
    v_accvgpr_read_b32 v10, a188
    v_accvgpr_read_b32 v11, a189
    v_accvgpr_read_b32 v12, a190
    v_accvgpr_read_b32 v13, a191
    v_perm_b32 v212, v246, v244, s34
    v_perm_b32 v213, v250, v248, s34
    v_perm_b32 v214, v254, v252, s34
    v_perm_b32 v215, v12, v10, s34
    v_perm_b32 v216, v246, v244, s35
    v_perm_b32 v217, v250, v248, s35
    v_perm_b32 v218, v254, v252, s35
    v_perm_b32 v219, v12, v10, s35
    v_perm_b32 v220, v247, v245, s34
    v_perm_b32 v221, v251, v249, s34
    v_perm_b32 v222, v255, v253, s34
    v_perm_b32 v223, v13, v11, s34
    v_perm_b32 v224, v247, v245, s35
    v_perm_b32 v225, v251, v249, s35
    v_perm_b32 v226, v255, v253, s35
    v_perm_b32 v227, v13, v11, s35
    v_lshlrev_b32 v28, 4, v3
    v_add_u32 v28, 149760, v28
    v_xor_b32 v24, 64, v23
    v_add_u32 v25, 65536, v24
    v_add_u32 v26, 131072, v24
    s_waitcnt lgkmcnt(8)
    v_mfma_f32_16x16x32_bf16 a[0:3], v[176:179], v[212:215], 0
    s_waitcnt vmcnt(46)
    v_mfma_f32_16x16x32_bf16 a[4:7], v[176:179], v[216:219], 0
    v_accvgpr_read_b32 v244, a192
    v_mfma_f32_16x16x32_bf16 a[8:11], v[176:179], v[220:223], 0
    v_accvgpr_read_b32 v245, a193
    v_mfma_f32_16x16x32_bf16 a[12:15], v[176:179], v[224:227], 0
    v_accvgpr_read_b32 v246, a194
    s_add_u32 s59, s31, 114688
    buffer_load_dwordx2 v[44:45], v9, s[20:23], s59 offen offset:3072 nt
    ds_read_b128 v[176:179], v24
    s_waitcnt lgkmcnt(8)
    v_mfma_f32_16x16x32_bf16 a[16:19], v[180:183], v[212:215], 0
    v_accvgpr_read_b32 v247, a195
    v_mfma_f32_16x16x32_bf16 a[20:23], v[180:183], v[216:219], 0
    v_accvgpr_read_b32 v248, a200
    v_mfma_f32_16x16x32_bf16 a[24:27], v[180:183], v[220:223], 0
    v_accvgpr_read_b32 v249, a201
    v_mfma_f32_16x16x32_bf16 a[28:31], v[180:183], v[224:227], 0
    v_accvgpr_read_b32 v250, a202
    s_add_u32 s46, s31, 114688
    buffer_load_dwordx2 v[46:47], v9, s[20:23], s46 offen offset:3584 nt
    ds_read_b128 v[180:183], v24 offset:16384
    s_waitcnt lgkmcnt(8)
    v_mfma_f32_16x16x32_bf16 a[32:35], v[184:187], v[212:215], 0
    v_accvgpr_read_b32 v251, a203
    v_mfma_f32_16x16x32_bf16 a[36:39], v[184:187], v[216:219], 0
    v_accvgpr_read_b32 v252, a208
    v_mfma_f32_16x16x32_bf16 a[40:43], v[184:187], v[220:223], 0
    v_accvgpr_read_b32 v253, a209
    v_mfma_f32_16x16x32_bf16 a[44:47], v[184:187], v[224:227], 0
    v_accvgpr_read_b32 v254, a210
    s_add_u32 s47, s31, 131072
    buffer_load_dwordx2 v[48:49], v9, s[20:23], s47 offen nt
    ds_read_b128 v[184:187], v24 offset:32768
    s_waitcnt lgkmcnt(8)
    v_mfma_f32_16x16x32_bf16 a[48:51], v[188:191], v[212:215], 0
    v_accvgpr_read_b32 v255, a211
    v_mfma_f32_16x16x32_bf16 a[52:55], v[188:191], v[216:219], 0
    v_accvgpr_read_b32 v10, a216
    v_mfma_f32_16x16x32_bf16 a[56:59], v[188:191], v[220:223], 0
    v_accvgpr_read_b32 v11, a217
    v_mfma_f32_16x16x32_bf16 a[60:63], v[188:191], v[224:227], 0
    v_accvgpr_read_b32 v12, a218
    s_add_u32 s58, s31, 131072
    buffer_load_dwordx2 v[50:51], v9, s[20:23], s58 offen offset:512 nt
    ds_read_b128 v[188:191], v24 offset:49152
    s_waitcnt lgkmcnt(8)
    v_mfma_f32_16x16x32_bf16 a[64:67], v[192:195], v[212:215], 0
    v_accvgpr_read_b32 v13, a219
    v_mfma_f32_16x16x32_bf16 a[68:71], v[192:195], v[216:219], 0
    v_perm_b32 v228, v246, v244, s34
    v_mfma_f32_16x16x32_bf16 a[72:75], v[192:195], v[220:223], 0
    v_perm_b32 v229, v250, v248, s34
    v_mfma_f32_16x16x32_bf16 a[76:79], v[192:195], v[224:227], 0
    v_perm_b32 v230, v254, v252, s34
    s_add_u32 s59, s31, 131072
    buffer_load_dwordx2 v[52:53], v9, s[20:23], s59 offen offset:1024 nt
    ds_read_b128 v[192:195], v25
    s_waitcnt lgkmcnt(8)
    v_mfma_f32_16x16x32_bf16 a[80:83], v[196:199], v[212:215], 0
    v_perm_b32 v231, v12, v10, s34
    v_mfma_f32_16x16x32_bf16 a[84:87], v[196:199], v[216:219], 0
    v_perm_b32 v232, v246, v244, s35
    v_mfma_f32_16x16x32_bf16 a[88:91], v[196:199], v[220:223], 0
    v_perm_b32 v233, v250, v248, s35
    v_mfma_f32_16x16x32_bf16 a[92:95], v[196:199], v[224:227], 0
    v_perm_b32 v234, v254, v252, s35
    s_add_u32 s46, s31, 131072
    buffer_load_dwordx2 v[54:55], v9, s[20:23], s46 offen offset:1536 nt
    ds_read_b128 v[196:199], v25 offset:16384
    s_waitcnt lgkmcnt(8)
    v_mfma_f32_16x16x32_bf16 a[96:99], v[200:203], v[212:215], 0
    v_perm_b32 v235, v12, v10, s35
    v_mfma_f32_16x16x32_bf16 a[100:103], v[200:203], v[216:219], 0
    v_perm_b32 v236, v247, v245, s34
    v_mfma_f32_16x16x32_bf16 a[104:107], v[200:203], v[220:223], 0
    v_perm_b32 v237, v251, v249, s34
    v_mfma_f32_16x16x32_bf16 a[108:111], v[200:203], v[224:227], 0
    v_perm_b32 v238, v255, v253, s34
    s_add_u32 s47, s31, 131072
    buffer_load_dwordx2 v[56:57], v9, s[20:23], s47 offen offset:2048 nt
    ds_read_b128 v[200:203], v25 offset:32768
    s_waitcnt lgkmcnt(8)
    v_mfma_f32_16x16x32_bf16 a[112:115], v[204:207], v[212:215], 0
    v_perm_b32 v239, v13, v11, s34
    v_mfma_f32_16x16x32_bf16 a[116:119], v[204:207], v[216:219], 0
    v_perm_b32 v240, v247, v245, s35
    v_mfma_f32_16x16x32_bf16 a[120:123], v[204:207], v[220:223], 0
    v_perm_b32 v241, v251, v249, s35
    v_mfma_f32_16x16x32_bf16 a[124:127], v[204:207], v[224:227], 0
    v_perm_b32 v242, v255, v253, s35
    s_add_u32 s58, s31, 131072
    buffer_load_dwordx2 v[58:59], v9, s[20:23], s58 offen offset:2560 nt
    ds_read_b128 v[204:207], v25 offset:49152
    s_waitcnt lgkmcnt(8)
    v_mfma_f32_16x16x32_bf16 a[128:131], v[208:211], v[212:215], 0
    v_perm_b32 v243, v13, v11, s35
    v_mfma_f32_16x16x32_bf16 a[132:135], v[208:211], v[216:219], 0
    v_mfma_f32_16x16x32_bf16 a[136:139], v[208:211], v[220:223], 0
    v_mfma_f32_16x16x32_bf16 a[140:143], v[208:211], v[224:227], 0
    s_add_u32 s59, s31, 131072
    buffer_load_dwordx2 v[60:61], v9, s[20:23], s59 offen offset:3072 nt
    ds_read_b128 v[208:211], v26
    v_xor_b32 v24, 128, v23
    v_add_u32 v25, 65536, v24
    v_add_u32 v26, 131072, v24
    s_waitcnt lgkmcnt(8)
    v_mfma_f32_16x16x32_bf16 a[0:3], v[176:179], v[228:231], a[0:3]
    s_waitcnt vmcnt(47)
    v_mfma_f32_16x16x32_bf16 a[4:7], v[176:179], v[232:235], a[4:7]
    v_accvgpr_read_b32 v244, a196
    v_mfma_f32_16x16x32_bf16 a[8:11], v[176:179], v[236:239], a[8:11]
    v_accvgpr_read_b32 v245, a197
    v_mfma_f32_16x16x32_bf16 a[12:15], v[176:179], v[240:243], a[12:15]
    v_accvgpr_read_b32 v246, a198
    s_add_u32 s46, s31, 131072
    buffer_load_dwordx2 v[62:63], v9, s[20:23], s46 offen offset:3584 nt
    ds_read_b128 v[176:179], v24
    s_waitcnt lgkmcnt(8)
    v_mfma_f32_16x16x32_bf16 a[16:19], v[180:183], v[228:231], a[16:19]
    v_accvgpr_read_b32 v247, a199
    v_mfma_f32_16x16x32_bf16 a[20:23], v[180:183], v[232:235], a[20:23]
    v_accvgpr_read_b32 v248, a204
    v_mfma_f32_16x16x32_bf16 a[24:27], v[180:183], v[236:239], a[24:27]
    v_accvgpr_read_b32 v249, a205
    v_mfma_f32_16x16x32_bf16 a[28:31], v[180:183], v[240:243], a[28:31]
    v_accvgpr_read_b32 v250, a206
    s_add_u32 s47, s31, 147456
    buffer_load_dwordx2 v[64:65], v9, s[20:23], s47 offen nt
    ds_read_b128 v[180:183], v24 offset:16384
    s_waitcnt lgkmcnt(8)
    v_mfma_f32_16x16x32_bf16 a[32:35], v[184:187], v[228:231], a[32:35]
    v_accvgpr_read_b32 v251, a207
    v_mfma_f32_16x16x32_bf16 a[36:39], v[184:187], v[232:235], a[36:39]
    v_accvgpr_read_b32 v252, a212
    v_mfma_f32_16x16x32_bf16 a[40:43], v[184:187], v[236:239], a[40:43]
    v_accvgpr_read_b32 v253, a213
    v_mfma_f32_16x16x32_bf16 a[44:47], v[184:187], v[240:243], a[44:47]
    v_accvgpr_read_b32 v254, a214
    s_add_u32 s58, s31, 147456
    buffer_load_dwordx2 v[66:67], v9, s[20:23], s58 offen offset:512 nt
    ds_read_b128 v[184:187], v24 offset:32768
    s_waitcnt lgkmcnt(8)
    v_mfma_f32_16x16x32_bf16 a[48:51], v[188:191], v[228:231], a[48:51]
    v_accvgpr_read_b32 v255, a215
    v_mfma_f32_16x16x32_bf16 a[52:55], v[188:191], v[232:235], a[52:55]
    v_accvgpr_read_b32 v10, a220
    v_mfma_f32_16x16x32_bf16 a[56:59], v[188:191], v[236:239], a[56:59]
    v_accvgpr_read_b32 v11, a221
    v_mfma_f32_16x16x32_bf16 a[60:63], v[188:191], v[240:243], a[60:63]
    v_accvgpr_read_b32 v12, a222
    s_add_u32 s59, s31, 147456
    buffer_load_dwordx2 v[68:69], v9, s[20:23], s59 offen offset:1024 nt
    ds_read_b128 v[188:191], v24 offset:49152
    s_waitcnt lgkmcnt(8)
    v_mfma_f32_16x16x32_bf16 a[64:67], v[192:195], v[228:231], a[64:67]
    v_accvgpr_read_b32 v13, a223
    v_mfma_f32_16x16x32_bf16 a[68:71], v[192:195], v[232:235], a[68:71]
    v_perm_b32 v212, v246, v244, s34
    v_mfma_f32_16x16x32_bf16 a[72:75], v[192:195], v[236:239], a[72:75]
    v_perm_b32 v213, v250, v248, s34
    v_mfma_f32_16x16x32_bf16 a[76:79], v[192:195], v[240:243], a[76:79]
    v_perm_b32 v214, v254, v252, s34
    s_add_u32 s46, s31, 147456
    buffer_load_dwordx2 v[70:71], v9, s[20:23], s46 offen offset:1536 nt
    ds_read_b128 v[192:195], v25
    s_waitcnt lgkmcnt(8)
    v_mfma_f32_16x16x32_bf16 a[80:83], v[196:199], v[228:231], a[80:83]
    v_perm_b32 v215, v12, v10, s34
    v_mfma_f32_16x16x32_bf16 a[84:87], v[196:199], v[232:235], a[84:87]
    v_perm_b32 v216, v246, v244, s35
    v_mfma_f32_16x16x32_bf16 a[88:91], v[196:199], v[236:239], a[88:91]
    v_perm_b32 v217, v250, v248, s35
    v_mfma_f32_16x16x32_bf16 a[92:95], v[196:199], v[240:243], a[92:95]
    v_perm_b32 v218, v254, v252, s35
    s_add_u32 s47, s31, 147456
    buffer_load_dwordx2 v[72:73], v9, s[20:23], s47 offen offset:2048 nt
    ds_read_b128 v[196:199], v25 offset:16384
    s_waitcnt lgkmcnt(8)
    v_mfma_f32_16x16x32_bf16 a[96:99], v[200:203], v[228:231], a[96:99]
    v_perm_b32 v219, v12, v10, s35
    v_mfma_f32_16x16x32_bf16 a[100:103], v[200:203], v[232:235], a[100:103]
    v_perm_b32 v220, v247, v245, s34
    v_mfma_f32_16x16x32_bf16 a[104:107], v[200:203], v[236:239], a[104:107]
    v_perm_b32 v221, v251, v249, s34
    v_mfma_f32_16x16x32_bf16 a[108:111], v[200:203], v[240:243], a[108:111]
    v_perm_b32 v222, v255, v253, s34
    s_add_u32 s58, s31, 147456
    buffer_load_dwordx2 v[74:75], v9, s[20:23], s58 offen offset:2560 nt
    ds_read_b128 v[200:203], v25 offset:32768
    s_waitcnt lgkmcnt(8)
    v_mfma_f32_16x16x32_bf16 a[112:115], v[204:207], v[228:231], a[112:115]
    v_perm_b32 v223, v13, v11, s34
    v_mfma_f32_16x16x32_bf16 a[116:119], v[204:207], v[232:235], a[116:119]
    v_perm_b32 v224, v247, v245, s35
    v_mfma_f32_16x16x32_bf16 a[120:123], v[204:207], v[236:239], a[120:123]
    v_perm_b32 v225, v251, v249, s35
    v_mfma_f32_16x16x32_bf16 a[124:127], v[204:207], v[240:243], a[124:127]
    v_perm_b32 v226, v255, v253, s35
    s_add_u32 s59, s31, 147456
    buffer_load_dwordx2 v[76:77], v9, s[20:23], s59 offen offset:3072 nt
    ds_read_b128 v[204:207], v25 offset:49152
    s_waitcnt lgkmcnt(8)
    v_mfma_f32_16x16x32_bf16 a[128:131], v[208:211], v[228:231], a[128:131]
    v_perm_b32 v227, v13, v11, s35
    v_mfma_f32_16x16x32_bf16 a[132:135], v[208:211], v[232:235], a[132:135]
    v_mfma_f32_16x16x32_bf16 a[136:139], v[208:211], v[236:239], a[136:139]
    v_mfma_f32_16x16x32_bf16 a[140:143], v[208:211], v[240:243], a[140:143]
    s_add_u32 s46, s31, 147456
    buffer_load_dwordx2 v[78:79], v9, s[20:23], s46 offen offset:3584 nt
    ds_read_b128 v[208:211], v26
    v_xor_b32 v24, 192, v23
    v_add_u32 v25, 65536, v24
    v_add_u32 v26, 131072, v24
    s_waitcnt lgkmcnt(8)
    v_mfma_f32_16x16x32_bf16 a[0:3], v[176:179], v[212:215], a[0:3]
    s_waitcnt vmcnt(48)
    v_mfma_f32_16x16x32_bf16 a[4:7], v[176:179], v[216:219], a[4:7]
    v_accvgpr_read_b32 v244, a224
    v_mfma_f32_16x16x32_bf16 a[8:11], v[176:179], v[220:223], a[8:11]
    v_accvgpr_read_b32 v245, a225
    v_mfma_f32_16x16x32_bf16 a[12:15], v[176:179], v[224:227], a[12:15]
    v_accvgpr_read_b32 v246, a226
    s_add_u32 s47, s31, 163840
    buffer_load_dwordx2 v[80:81], v9, s[20:23], s47 offen nt
    ds_read_b128 v[176:179], v24
    s_waitcnt lgkmcnt(8)
    v_mfma_f32_16x16x32_bf16 a[16:19], v[180:183], v[212:215], a[16:19]
    v_accvgpr_read_b32 v247, a227
    v_mfma_f32_16x16x32_bf16 a[20:23], v[180:183], v[216:219], a[20:23]
    v_accvgpr_read_b32 v248, a232
    v_mfma_f32_16x16x32_bf16 a[24:27], v[180:183], v[220:223], a[24:27]
    v_accvgpr_read_b32 v249, a233
    v_mfma_f32_16x16x32_bf16 a[28:31], v[180:183], v[224:227], a[28:31]
    v_accvgpr_read_b32 v250, a234
    s_add_u32 s58, s31, 163840
    buffer_load_dwordx2 v[82:83], v9, s[20:23], s58 offen offset:512 nt
    ds_read_b128 v[180:183], v24 offset:16384
    s_waitcnt lgkmcnt(8)
    v_mfma_f32_16x16x32_bf16 a[32:35], v[184:187], v[212:215], a[32:35]
    v_accvgpr_read_b32 v251, a235
    v_mfma_f32_16x16x32_bf16 a[36:39], v[184:187], v[216:219], a[36:39]
    v_accvgpr_read_b32 v252, a240
    v_mfma_f32_16x16x32_bf16 a[40:43], v[184:187], v[220:223], a[40:43]
    v_accvgpr_read_b32 v253, a241
    v_mfma_f32_16x16x32_bf16 a[44:47], v[184:187], v[224:227], a[44:47]
    v_accvgpr_read_b32 v254, a242
    s_add_u32 s59, s31, 163840
    buffer_load_dwordx2 v[84:85], v9, s[20:23], s59 offen offset:1024 nt
    ds_read_b128 v[184:187], v24 offset:32768
    s_waitcnt lgkmcnt(8)
    v_mfma_f32_16x16x32_bf16 a[48:51], v[188:191], v[212:215], a[48:51]
    v_accvgpr_read_b32 v255, a243
    v_mfma_f32_16x16x32_bf16 a[52:55], v[188:191], v[216:219], a[52:55]
    v_accvgpr_read_b32 v10, a248
    v_mfma_f32_16x16x32_bf16 a[56:59], v[188:191], v[220:223], a[56:59]
    v_accvgpr_read_b32 v11, a249
    v_mfma_f32_16x16x32_bf16 a[60:63], v[188:191], v[224:227], a[60:63]
    v_accvgpr_read_b32 v12, a250
    s_add_u32 s46, s31, 163840
    buffer_load_dwordx2 v[86:87], v9, s[20:23], s46 offen offset:1536 nt
    ds_read_b128 v[188:191], v24 offset:49152
    s_waitcnt lgkmcnt(8)
    v_mfma_f32_16x16x32_bf16 a[64:67], v[192:195], v[212:215], a[64:67]
    v_accvgpr_read_b32 v13, a251
    v_mfma_f32_16x16x32_bf16 a[68:71], v[192:195], v[216:219], a[68:71]
    v_perm_b32 v228, v246, v244, s34
    v_mfma_f32_16x16x32_bf16 a[72:75], v[192:195], v[220:223], a[72:75]
    v_perm_b32 v229, v250, v248, s34
    v_mfma_f32_16x16x32_bf16 a[76:79], v[192:195], v[224:227], a[76:79]
    v_perm_b32 v230, v254, v252, s34
    s_add_u32 s47, s31, 163840
    buffer_load_dwordx2 v[88:89], v9, s[20:23], s47 offen offset:2048 nt
    ds_read_b128 v[192:195], v25
    s_waitcnt lgkmcnt(8)
    v_mfma_f32_16x16x32_bf16 a[80:83], v[196:199], v[212:215], a[80:83]
    v_perm_b32 v231, v12, v10, s34
    v_mfma_f32_16x16x32_bf16 a[84:87], v[196:199], v[216:219], a[84:87]
    v_perm_b32 v232, v246, v244, s35
    v_mfma_f32_16x16x32_bf16 a[88:91], v[196:199], v[220:223], a[88:91]
    v_perm_b32 v233, v250, v248, s35
    v_mfma_f32_16x16x32_bf16 a[92:95], v[196:199], v[224:227], a[92:95]
    v_perm_b32 v234, v254, v252, s35
    s_add_u32 s58, s31, 163840
    buffer_load_dwordx2 v[90:91], v9, s[20:23], s58 offen offset:2560 nt
    ds_read_b128 v[196:199], v25 offset:16384
    s_waitcnt lgkmcnt(8)
    v_mfma_f32_16x16x32_bf16 a[96:99], v[200:203], v[212:215], a[96:99]
    v_perm_b32 v235, v12, v10, s35
    v_mfma_f32_16x16x32_bf16 a[100:103], v[200:203], v[216:219], a[100:103]
    v_perm_b32 v236, v247, v245, s34
    v_mfma_f32_16x16x32_bf16 a[104:107], v[200:203], v[220:223], a[104:107]
    v_perm_b32 v237, v251, v249, s34
    v_mfma_f32_16x16x32_bf16 a[108:111], v[200:203], v[224:227], a[108:111]
    v_perm_b32 v238, v255, v253, s34
    s_add_u32 s59, s31, 163840
    buffer_load_dwordx2 v[92:93], v9, s[20:23], s59 offen offset:3072 nt
    ds_read_b128 v[200:203], v25 offset:32768
    s_waitcnt lgkmcnt(8)
    v_mfma_f32_16x16x32_bf16 a[112:115], v[204:207], v[212:215], a[112:115]
    v_perm_b32 v239, v13, v11, s34
    v_mfma_f32_16x16x32_bf16 a[116:119], v[204:207], v[216:219], a[116:119]
    v_perm_b32 v240, v247, v245, s35
    v_mfma_f32_16x16x32_bf16 a[120:123], v[204:207], v[220:223], a[120:123]
    v_perm_b32 v241, v251, v249, s35
    v_mfma_f32_16x16x32_bf16 a[124:127], v[204:207], v[224:227], a[124:127]
    v_perm_b32 v242, v255, v253, s35
    s_add_u32 s46, s31, 163840
    buffer_load_dwordx2 v[94:95], v9, s[20:23], s46 offen offset:3584 nt
    ds_read_b128 v[204:207], v25 offset:49152
    s_waitcnt lgkmcnt(8)
    v_mfma_f32_16x16x32_bf16 a[128:131], v[208:211], v[212:215], a[128:131]
    v_perm_b32 v243, v13, v11, s35
    v_mfma_f32_16x16x32_bf16 a[132:135], v[208:211], v[216:219], a[132:135]
    v_mfma_f32_16x16x32_bf16 a[136:139], v[208:211], v[220:223], a[136:139]
    v_mfma_f32_16x16x32_bf16 a[140:143], v[208:211], v[224:227], a[140:143]
    s_add_u32 s47, s31, 180224
    buffer_load_dwordx2 v[96:97], v9, s[20:23], s47 offen nt
    ds_read_b128 v[208:211], v26
    v_xor_b32 v24, 0, v23
    v_add_u32 v25, 65536, v24
    v_add_u32 v26, 131072, v24
    s_waitcnt lgkmcnt(8)
    v_mfma_f32_16x16x32_bf16 a[0:3], v[176:179], v[228:231], a[0:3]
    s_waitcnt vmcnt(49)
    v_mfma_f32_16x16x32_bf16 a[4:7], v[176:179], v[232:235], a[4:7]
    v_accvgpr_read_b32 v244, a228
    v_mfma_f32_16x16x32_bf16 a[8:11], v[176:179], v[236:239], a[8:11]
    v_accvgpr_read_b32 v245, a229
    v_mfma_f32_16x16x32_bf16 a[12:15], v[176:179], v[240:243], a[12:15]
    v_accvgpr_read_b32 v246, a230
    s_add_u32 s58, s31, 180224
    buffer_load_dwordx2 v[98:99], v9, s[20:23], s58 offen offset:512 nt
    ds_read_b128 v[176:179], v24 offset:256
    s_waitcnt lgkmcnt(8)
    v_mfma_f32_16x16x32_bf16 a[16:19], v[180:183], v[228:231], a[16:19]
    v_accvgpr_read_b32 v247, a231
    v_mfma_f32_16x16x32_bf16 a[20:23], v[180:183], v[232:235], a[20:23]
    v_accvgpr_read_b32 v248, a236
    v_mfma_f32_16x16x32_bf16 a[24:27], v[180:183], v[236:239], a[24:27]
    v_accvgpr_read_b32 v249, a237
    v_mfma_f32_16x16x32_bf16 a[28:31], v[180:183], v[240:243], a[28:31]
    v_accvgpr_read_b32 v250, a238
    s_add_u32 s59, s31, 180224
    buffer_load_dwordx2 v[100:101], v9, s[20:23], s59 offen offset:1024 nt
    ds_read_b128 v[180:183], v24 offset:16640
    s_waitcnt lgkmcnt(8)
    v_mfma_f32_16x16x32_bf16 a[32:35], v[184:187], v[228:231], a[32:35]
    v_accvgpr_read_b32 v251, a239
    v_mfma_f32_16x16x32_bf16 a[36:39], v[184:187], v[232:235], a[36:39]
    v_accvgpr_read_b32 v252, a244
    v_mfma_f32_16x16x32_bf16 a[40:43], v[184:187], v[236:239], a[40:43]
    v_accvgpr_read_b32 v253, a245
    v_mfma_f32_16x16x32_bf16 a[44:47], v[184:187], v[240:243], a[44:47]
    v_accvgpr_read_b32 v254, a246
    s_add_u32 s46, s31, 180224
    buffer_load_dwordx2 v[102:103], v9, s[20:23], s46 offen offset:1536 nt
    ds_read_b128 v[184:187], v24 offset:33024
    s_waitcnt lgkmcnt(8)
    v_mfma_f32_16x16x32_bf16 a[48:51], v[188:191], v[228:231], a[48:51]
    v_accvgpr_read_b32 v255, a247
    v_mfma_f32_16x16x32_bf16 a[52:55], v[188:191], v[232:235], a[52:55]
    v_accvgpr_read_b32 v10, a252
    v_mfma_f32_16x16x32_bf16 a[56:59], v[188:191], v[236:239], a[56:59]
    v_accvgpr_read_b32 v11, a253
    v_mfma_f32_16x16x32_bf16 a[60:63], v[188:191], v[240:243], a[60:63]
    v_accvgpr_read_b32 v12, a254
    s_add_u32 s47, s31, 180224
    buffer_load_dwordx2 v[104:105], v9, s[20:23], s47 offen offset:2048 nt
    ds_read_b128 v[188:191], v24 offset:49408
    s_waitcnt lgkmcnt(8)
    v_mfma_f32_16x16x32_bf16 a[64:67], v[192:195], v[228:231], a[64:67]
    v_accvgpr_read_b32 v13, a255
    v_mfma_f32_16x16x32_bf16 a[68:71], v[192:195], v[232:235], a[68:71]
    v_perm_b32 v212, v246, v244, s34
    v_mfma_f32_16x16x32_bf16 a[72:75], v[192:195], v[236:239], a[72:75]
    v_perm_b32 v213, v250, v248, s34
    v_mfma_f32_16x16x32_bf16 a[76:79], v[192:195], v[240:243], a[76:79]
    v_perm_b32 v214, v254, v252, s34
    s_add_u32 s58, s31, 180224
    buffer_load_dwordx2 v[106:107], v9, s[20:23], s58 offen offset:2560 nt
    ds_read_b128 v[192:195], v25 offset:256
    s_waitcnt lgkmcnt(8)
    v_mfma_f32_16x16x32_bf16 a[80:83], v[196:199], v[228:231], a[80:83]
    v_perm_b32 v215, v12, v10, s34
    v_mfma_f32_16x16x32_bf16 a[84:87], v[196:199], v[232:235], a[84:87]
    v_perm_b32 v216, v246, v244, s35
    v_mfma_f32_16x16x32_bf16 a[88:91], v[196:199], v[236:239], a[88:91]
    v_perm_b32 v217, v250, v248, s35
    v_mfma_f32_16x16x32_bf16 a[92:95], v[196:199], v[240:243], a[92:95]
    v_perm_b32 v218, v254, v252, s35
    s_add_u32 s59, s31, 180224
    buffer_load_dwordx2 v[108:109], v9, s[20:23], s59 offen offset:3072 nt
    ds_read_b128 v[196:199], v25 offset:16640
    s_waitcnt lgkmcnt(8)
    v_mfma_f32_16x16x32_bf16 a[96:99], v[200:203], v[228:231], a[96:99]
    v_perm_b32 v219, v12, v10, s35
    v_mfma_f32_16x16x32_bf16 a[100:103], v[200:203], v[232:235], a[100:103]
    v_perm_b32 v220, v247, v245, s34
    v_mfma_f32_16x16x32_bf16 a[104:107], v[200:203], v[236:239], a[104:107]
    v_perm_b32 v221, v251, v249, s34
    v_mfma_f32_16x16x32_bf16 a[108:111], v[200:203], v[240:243], a[108:111]
    v_perm_b32 v222, v255, v253, s34
    s_add_u32 s46, s31, 180224
    buffer_load_dwordx2 v[110:111], v9, s[20:23], s46 offen offset:3584 nt
    ds_read_b128 v[200:203], v25 offset:33024
    s_waitcnt lgkmcnt(8)
    v_mfma_f32_16x16x32_bf16 a[112:115], v[204:207], v[228:231], a[112:115]
    v_perm_b32 v223, v13, v11, s34
    v_mfma_f32_16x16x32_bf16 a[116:119], v[204:207], v[232:235], a[116:119]
    v_perm_b32 v224, v247, v245, s35
    v_mfma_f32_16x16x32_bf16 a[120:123], v[204:207], v[236:239], a[120:123]
    v_perm_b32 v225, v251, v249, s35
    v_mfma_f32_16x16x32_bf16 a[124:127], v[204:207], v[240:243], a[124:127]
    v_perm_b32 v226, v255, v253, s35
    s_add_u32 s47, s31, 196608
    buffer_load_dwordx2 v[112:113], v9, s[20:23], s47 offen nt
    ds_read_b128 v[204:207], v25 offset:49408
    s_waitcnt lgkmcnt(8)
    v_mfma_f32_16x16x32_bf16 a[128:131], v[208:211], v[228:231], a[128:131]
    v_perm_b32 v227, v13, v11, s35
    v_mfma_f32_16x16x32_bf16 a[132:135], v[208:211], v[232:235], a[132:135]
    v_mfma_f32_16x16x32_bf16 a[136:139], v[208:211], v[236:239], a[136:139]
    v_mfma_f32_16x16x32_bf16 a[140:143], v[208:211], v[240:243], a[140:143]
    s_add_u32 s58, s31, 196608
    buffer_load_dwordx2 v[114:115], v9, s[20:23], s58 offen offset:512 nt
    ds_read_b128 v[208:211], v26 offset:256
    v_xor_b32 v24, 64, v23
    v_add_u32 v25, 65536, v24
    v_add_u32 v26, 131072, v24
    s_waitcnt lgkmcnt(8)
    v_mfma_f32_16x16x32_bf16 a[0:3], v[176:179], v[212:215], a[0:3]
    s_waitcnt vmcnt(50)
    v_mfma_f32_16x16x32_bf16 a[4:7], v[176:179], v[216:219], a[4:7]
    v_accvgpr_read_b32 v244, a144
    v_mfma_f32_16x16x32_bf16 a[8:11], v[176:179], v[220:223], a[8:11]
    v_accvgpr_read_b32 v245, a145
    v_mfma_f32_16x16x32_bf16 a[12:15], v[176:179], v[224:227], a[12:15]
    v_accvgpr_read_b32 v246, a146
    s_add_u32 s59, s31, 196608
    buffer_load_dwordx2 v[116:117], v9, s[20:23], s59 offen offset:1024 nt
    ds_read_b128 v[176:179], v24 offset:256
    s_waitcnt lgkmcnt(8)
    v_mfma_f32_16x16x32_bf16 a[16:19], v[180:183], v[212:215], a[16:19]
    v_accvgpr_read_b32 v247, a147
    v_mfma_f32_16x16x32_bf16 a[20:23], v[180:183], v[216:219], a[20:23]
    v_accvgpr_read_b32 v248, a152
    v_mfma_f32_16x16x32_bf16 a[24:27], v[180:183], v[220:223], a[24:27]
    v_accvgpr_read_b32 v249, a153
    v_mfma_f32_16x16x32_bf16 a[28:31], v[180:183], v[224:227], a[28:31]
    v_accvgpr_read_b32 v250, a154
    s_add_u32 s46, s31, 196608
    buffer_load_dwordx2 v[118:119], v9, s[20:23], s46 offen offset:1536 nt
    ds_read_b128 v[180:183], v24 offset:16640
    s_waitcnt lgkmcnt(8)
    v_mfma_f32_16x16x32_bf16 a[32:35], v[184:187], v[212:215], a[32:35]
    v_accvgpr_read_b32 v251, a155
    v_mfma_f32_16x16x32_bf16 a[36:39], v[184:187], v[216:219], a[36:39]
    v_accvgpr_read_b32 v252, a148
    v_mfma_f32_16x16x32_bf16 a[40:43], v[184:187], v[220:223], a[40:43]
    v_accvgpr_read_b32 v253, a149
    v_mfma_f32_16x16x32_bf16 a[44:47], v[184:187], v[224:227], a[44:47]
    v_accvgpr_read_b32 v254, a150
    s_add_u32 s47, s31, 196608
    buffer_load_dwordx2 v[120:121], v9, s[20:23], s47 offen offset:2048 nt
    ds_read_b128 v[184:187], v24 offset:33024
    s_waitcnt lgkmcnt(8)
    v_mfma_f32_16x16x32_bf16 a[48:51], v[188:191], v[212:215], a[48:51]
    v_accvgpr_read_b32 v255, a151
    v_mfma_f32_16x16x32_bf16 a[52:55], v[188:191], v[216:219], a[52:55]
    v_accvgpr_read_b32 v10, a160
    v_mfma_f32_16x16x32_bf16 a[56:59], v[188:191], v[220:223], a[56:59]
    v_accvgpr_read_b32 v11, a161
    v_mfma_f32_16x16x32_bf16 a[60:63], v[188:191], v[224:227], a[60:63]
    v_accvgpr_read_b32 v12, a162
    s_add_u32 s58, s31, 196608
    buffer_load_dwordx2 v[122:123], v9, s[20:23], s58 offen offset:2560 nt
    ds_read_b128 v[188:191], v24 offset:49408
    s_waitcnt lgkmcnt(8)
    v_mfma_f32_16x16x32_bf16 a[64:67], v[192:195], v[212:215], a[64:67]
    v_accvgpr_read_b32 v13, a163
    v_mfma_f32_16x16x32_bf16 a[68:71], v[192:195], v[216:219], a[68:71]
    v_perm_b32 v228, v246, v244, s34
    v_mfma_f32_16x16x32_bf16 a[72:75], v[192:195], v[220:223], a[72:75]
    v_perm_b32 v229, v250, v248, s34
    v_mfma_f32_16x16x32_bf16 a[76:79], v[192:195], v[224:227], a[76:79]
    v_perm_b32 v230, v254, v252, s34
    s_add_u32 s59, s31, 196608
    buffer_load_dwordx2 v[124:125], v9, s[20:23], s59 offen offset:3072 nt
    ds_read_b128 v[192:195], v25 offset:256
    s_waitcnt lgkmcnt(8)
    v_mfma_f32_16x16x32_bf16 a[80:83], v[196:199], v[212:215], a[80:83]
    v_perm_b32 v231, v12, v10, s34
    v_mfma_f32_16x16x32_bf16 a[84:87], v[196:199], v[216:219], a[84:87]
    v_perm_b32 v232, v246, v244, s35
    v_mfma_f32_16x16x32_bf16 a[88:91], v[196:199], v[220:223], a[88:91]
    v_perm_b32 v233, v250, v248, s35
    v_mfma_f32_16x16x32_bf16 a[92:95], v[196:199], v[224:227], a[92:95]
    v_perm_b32 v234, v254, v252, s35
    s_add_u32 s46, s31, 196608
    buffer_load_dwordx2 v[126:127], v9, s[20:23], s46 offen offset:3584 nt
    ds_read_b128 v[196:199], v25 offset:16640
    s_waitcnt lgkmcnt(8)
    v_mfma_f32_16x16x32_bf16 a[96:99], v[200:203], v[212:215], a[96:99]
    v_perm_b32 v235, v12, v10, s35
    v_mfma_f32_16x16x32_bf16 a[100:103], v[200:203], v[216:219], a[100:103]
    v_perm_b32 v236, v247, v245, s34
    v_mfma_f32_16x16x32_bf16 a[104:107], v[200:203], v[220:223], a[104:107]
    v_perm_b32 v237, v251, v249, s34
    v_mfma_f32_16x16x32_bf16 a[108:111], v[200:203], v[224:227], a[108:111]
    v_perm_b32 v238, v255, v253, s34
    s_add_u32 s47, s31, 212992
    buffer_load_dwordx2 v[128:129], v9, s[20:23], s47 offen nt
    ds_read_b128 v[200:203], v25 offset:33024
    s_waitcnt lgkmcnt(8)
    v_mfma_f32_16x16x32_bf16 a[112:115], v[204:207], v[212:215], a[112:115]
    v_perm_b32 v239, v13, v11, s34
    v_mfma_f32_16x16x32_bf16 a[116:119], v[204:207], v[216:219], a[116:119]
    v_perm_b32 v240, v247, v245, s35
    v_mfma_f32_16x16x32_bf16 a[120:123], v[204:207], v[220:223], a[120:123]
    v_perm_b32 v241, v251, v249, s35
    v_mfma_f32_16x16x32_bf16 a[124:127], v[204:207], v[224:227], a[124:127]
    v_perm_b32 v242, v255, v253, s35
    s_add_u32 s58, s31, 212992
    buffer_load_dwordx2 v[130:131], v9, s[20:23], s58 offen offset:512 nt
    ds_read_b128 v[204:207], v25 offset:49408
    s_waitcnt lgkmcnt(8)
    v_mfma_f32_16x16x32_bf16 a[128:131], v[208:211], v[212:215], a[128:131]
    v_perm_b32 v243, v13, v11, s35
    v_mfma_f32_16x16x32_bf16 a[132:135], v[208:211], v[216:219], a[132:135]
    v_mfma_f32_16x16x32_bf16 a[136:139], v[208:211], v[220:223], a[136:139]
    v_mfma_f32_16x16x32_bf16 a[140:143], v[208:211], v[224:227], a[140:143]
    s_add_u32 s59, s31, 212992
    buffer_load_dwordx2 v[132:133], v9, s[20:23], s59 offen offset:1024 nt
    ds_read_b128 v[208:211], v26 offset:256
    v_xor_b32 v24, 128, v23
    v_add_u32 v25, 65536, v24
    v_add_u32 v26, 131072, v24
    s_waitcnt lgkmcnt(8)
    v_mfma_f32_16x16x32_bf16 a[0:3], v[176:179], v[228:231], a[0:3]
    s_waitcnt vmcnt(51)
    v_mfma_f32_16x16x32_bf16 a[4:7], v[176:179], v[232:235], a[4:7]
    v_accvgpr_read_b32 v244, a176
    v_mfma_f32_16x16x32_bf16 a[8:11], v[176:179], v[236:239], a[8:11]
    v_accvgpr_read_b32 v245, a177
    v_mfma_f32_16x16x32_bf16 a[12:15], v[176:179], v[240:243], a[12:15]
    v_accvgpr_read_b32 v246, a178
    s_add_u32 s46, s31, 212992
    buffer_load_dwordx2 v[134:135], v9, s[20:23], s46 offen offset:1536 nt
    ds_read_b128 v[176:179], v24 offset:256
    s_waitcnt lgkmcnt(8)
    v_mfma_f32_16x16x32_bf16 a[16:19], v[180:183], v[228:231], a[16:19]
    v_accvgpr_read_b32 v247, a179
    v_mfma_f32_16x16x32_bf16 a[20:23], v[180:183], v[232:235], a[20:23]
    v_accvgpr_read_b32 v248, a156
    v_mfma_f32_16x16x32_bf16 a[24:27], v[180:183], v[236:239], a[24:27]
    v_accvgpr_read_b32 v249, a157
    v_mfma_f32_16x16x32_bf16 a[28:31], v[180:183], v[240:243], a[28:31]
    v_accvgpr_read_b32 v250, a158
    s_add_u32 s47, s31, 212992
    buffer_load_dwordx2 v[136:137], v9, s[20:23], s47 offen offset:2048 nt
    ds_read_b128 v[180:183], v24 offset:16640
    s_waitcnt lgkmcnt(8)
    v_mfma_f32_16x16x32_bf16 a[32:35], v[184:187], v[228:231], a[32:35]
    v_accvgpr_read_b32 v251, a159
    v_mfma_f32_16x16x32_bf16 a[36:39], v[184:187], v[232:235], a[36:39]
    v_accvgpr_read_b32 v252, a168
    v_mfma_f32_16x16x32_bf16 a[40:43], v[184:187], v[236:239], a[40:43]
    v_accvgpr_read_b32 v253, a169
    v_mfma_f32_16x16x32_bf16 a[44:47], v[184:187], v[240:243], a[44:47]
    v_accvgpr_read_b32 v254, a170
    s_add_u32 s58, s31, 212992
    buffer_load_dwordx2 v[138:139], v9, s[20:23], s58 offen offset:2560 nt
    ds_read_b128 v[184:187], v24 offset:33024
    s_waitcnt lgkmcnt(8)
    v_mfma_f32_16x16x32_bf16 a[48:51], v[188:191], v[228:231], a[48:51]
    v_accvgpr_read_b32 v255, a171
    v_mfma_f32_16x16x32_bf16 a[52:55], v[188:191], v[232:235], a[52:55]
    v_accvgpr_read_b32 v10, a184
    v_mfma_f32_16x16x32_bf16 a[56:59], v[188:191], v[236:239], a[56:59]
    v_accvgpr_read_b32 v11, a185
    v_mfma_f32_16x16x32_bf16 a[60:63], v[188:191], v[240:243], a[60:63]
    v_accvgpr_read_b32 v12, a186
    s_add_u32 s59, s31, 212992
    buffer_load_dwordx2 v[140:141], v9, s[20:23], s59 offen offset:3072 nt
    ds_read_b128 v[188:191], v24 offset:49408
    s_waitcnt lgkmcnt(8)
    v_mfma_f32_16x16x32_bf16 a[64:67], v[192:195], v[228:231], a[64:67]
    v_accvgpr_read_b32 v13, a187
    v_mfma_f32_16x16x32_bf16 a[68:71], v[192:195], v[232:235], a[68:71]
    v_perm_b32 v212, v246, v244, s34
    v_mfma_f32_16x16x32_bf16 a[72:75], v[192:195], v[236:239], a[72:75]
    v_perm_b32 v213, v250, v248, s34
    v_mfma_f32_16x16x32_bf16 a[76:79], v[192:195], v[240:243], a[76:79]
    v_perm_b32 v214, v254, v252, s34
    s_add_u32 s46, s31, 212992
    buffer_load_dwordx2 v[142:143], v9, s[20:23], s46 offen offset:3584 nt
    ds_read_b128 v[192:195], v25 offset:256
    s_waitcnt lgkmcnt(8)
    v_mfma_f32_16x16x32_bf16 a[80:83], v[196:199], v[228:231], a[80:83]
    v_perm_b32 v215, v12, v10, s34
    v_mfma_f32_16x16x32_bf16 a[84:87], v[196:199], v[232:235], a[84:87]
    v_perm_b32 v216, v246, v244, s35
    v_mfma_f32_16x16x32_bf16 a[88:91], v[196:199], v[236:239], a[88:91]
    v_perm_b32 v217, v250, v248, s35
    v_mfma_f32_16x16x32_bf16 a[92:95], v[196:199], v[240:243], a[92:95]
    v_perm_b32 v218, v254, v252, s35
    s_add_u32 s47, s31, 229376
    buffer_load_dwordx2 v[144:145], v9, s[20:23], s47 offen nt
    ds_read_b128 v[196:199], v25 offset:16640
    s_waitcnt lgkmcnt(8)
    v_mfma_f32_16x16x32_bf16 a[96:99], v[200:203], v[228:231], a[96:99]
    v_perm_b32 v219, v12, v10, s35
    v_mfma_f32_16x16x32_bf16 a[100:103], v[200:203], v[232:235], a[100:103]
    v_perm_b32 v220, v247, v245, s34
    v_mfma_f32_16x16x32_bf16 a[104:107], v[200:203], v[236:239], a[104:107]
    v_perm_b32 v221, v251, v249, s34
    v_mfma_f32_16x16x32_bf16 a[108:111], v[200:203], v[240:243], a[108:111]
    v_perm_b32 v222, v255, v253, s34
    s_add_u32 s58, s31, 229376
    buffer_load_dwordx2 v[146:147], v9, s[20:23], s58 offen offset:512 nt
    ds_read_b128 v[200:203], v25 offset:33024
    s_waitcnt lgkmcnt(8)
    v_mfma_f32_16x16x32_bf16 a[112:115], v[204:207], v[228:231], a[112:115]
    v_perm_b32 v223, v13, v11, s34
    v_mfma_f32_16x16x32_bf16 a[116:119], v[204:207], v[232:235], a[116:119]
    v_perm_b32 v224, v247, v245, s35
    v_mfma_f32_16x16x32_bf16 a[120:123], v[204:207], v[236:239], a[120:123]
    v_perm_b32 v225, v251, v249, s35
    v_mfma_f32_16x16x32_bf16 a[124:127], v[204:207], v[240:243], a[124:127]
    v_perm_b32 v226, v255, v253, s35
    s_add_u32 s59, s31, 229376
    buffer_load_dwordx2 v[148:149], v9, s[20:23], s59 offen offset:1024 nt
    ds_read_b128 v[204:207], v25 offset:49408
    s_waitcnt lgkmcnt(8)
    v_mfma_f32_16x16x32_bf16 a[128:131], v[208:211], v[228:231], a[128:131]
    v_perm_b32 v227, v13, v11, s35
    v_mfma_f32_16x16x32_bf16 a[132:135], v[208:211], v[232:235], a[132:135]
    v_mfma_f32_16x16x32_bf16 a[136:139], v[208:211], v[236:239], a[136:139]
    v_mfma_f32_16x16x32_bf16 a[140:143], v[208:211], v[240:243], a[140:143]
    s_add_u32 s46, s31, 229376
    buffer_load_dwordx2 v[150:151], v9, s[20:23], s46 offen offset:1536 nt
    ds_read_b128 v[208:211], v26 offset:256
    v_xor_b32 v24, 192, v23
    v_add_u32 v25, 65536, v24
    v_add_u32 v26, 131072, v24
    s_waitcnt lgkmcnt(8)
    v_mfma_f32_16x16x32_bf16 a[0:3], v[176:179], v[212:215], a[0:3]
    s_waitcnt vmcnt(52)
    v_mfma_f32_16x16x32_bf16 a[4:7], v[176:179], v[216:219], a[4:7]
    v_perm_b32 v228, v34, v32, s34
    v_mfma_f32_16x16x32_bf16 a[8:11], v[176:179], v[220:223], a[8:11]
    v_perm_b32 v229, v38, v36, s34
    v_mfma_f32_16x16x32_bf16 a[12:15], v[176:179], v[224:227], a[12:15]
    v_perm_b32 v230, v42, v40, s34
    s_add_u32 s47, s31, 229376
    buffer_load_dwordx2 v[152:153], v9, s[20:23], s47 offen offset:2048 nt
    ds_read_b128 v[176:179], v24 offset:256
    s_waitcnt lgkmcnt(8)
    v_mfma_f32_16x16x32_bf16 a[16:19], v[180:183], v[212:215], a[16:19]
    v_perm_b32 v231, v46, v44, s34
    v_mfma_f32_16x16x32_bf16 a[20:23], v[180:183], v[216:219], a[20:23]
    v_perm_b32 v232, v34, v32, s35
    v_mfma_f32_16x16x32_bf16 a[24:27], v[180:183], v[220:223], a[24:27]
    v_perm_b32 v233, v38, v36, s35
    v_mfma_f32_16x16x32_bf16 a[28:31], v[180:183], v[224:227], a[28:31]
    v_perm_b32 v234, v42, v40, s35
    s_add_u32 s58, s31, 229376
    buffer_load_dwordx2 v[154:155], v9, s[20:23], s58 offen offset:2560 nt
    ds_read_b128 v[180:183], v24 offset:16640
    s_waitcnt lgkmcnt(8)
    v_mfma_f32_16x16x32_bf16 a[32:35], v[184:187], v[212:215], a[32:35]
    v_perm_b32 v235, v46, v44, s35
    v_mfma_f32_16x16x32_bf16 a[36:39], v[184:187], v[216:219], a[36:39]
    v_perm_b32 v236, v35, v33, s34
    v_mfma_f32_16x16x32_bf16 a[40:43], v[184:187], v[220:223], a[40:43]
    v_perm_b32 v237, v39, v37, s34
    v_mfma_f32_16x16x32_bf16 a[44:47], v[184:187], v[224:227], a[44:47]
    v_perm_b32 v238, v43, v41, s34
    s_add_u32 s59, s31, 229376
    buffer_load_dwordx2 v[156:157], v9, s[20:23], s59 offen offset:3072 nt
    ds_read_b128 v[184:187], v24 offset:33024
    s_waitcnt lgkmcnt(8)
    v_mfma_f32_16x16x32_bf16 a[48:51], v[188:191], v[212:215], a[48:51]
    v_perm_b32 v239, v47, v45, s34
    v_mfma_f32_16x16x32_bf16 a[52:55], v[188:191], v[216:219], a[52:55]
    v_perm_b32 v240, v35, v33, s35
    v_mfma_f32_16x16x32_bf16 a[56:59], v[188:191], v[220:223], a[56:59]
    v_perm_b32 v241, v39, v37, s35
    v_mfma_f32_16x16x32_bf16 a[60:63], v[188:191], v[224:227], a[60:63]
    v_perm_b32 v242, v43, v41, s35
    s_add_u32 s46, s31, 229376
    buffer_load_dwordx2 v[158:159], v9, s[20:23], s46 offen offset:3584 nt
    ds_read_b128 v[188:191], v24 offset:49408
    s_waitcnt lgkmcnt(8)
    v_mfma_f32_16x16x32_bf16 a[64:67], v[192:195], v[212:215], a[64:67]
    v_perm_b32 v243, v47, v45, s35
    v_mfma_f32_16x16x32_bf16 a[68:71], v[192:195], v[216:219], a[68:71]
    v_mfma_f32_16x16x32_bf16 a[72:75], v[192:195], v[220:223], a[72:75]
    v_mfma_f32_16x16x32_bf16 a[76:79], v[192:195], v[224:227], a[76:79]
    s_add_u32 s47, s31, 245760
    buffer_load_dwordx2 v[160:161], v9, s[20:23], s47 offen nt
    ds_read_b128 v[192:195], v25 offset:256
    s_waitcnt lgkmcnt(8)
    v_mfma_f32_16x16x32_bf16 a[80:83], v[196:199], v[212:215], a[80:83]
    v_mfma_f32_16x16x32_bf16 a[84:87], v[196:199], v[216:219], a[84:87]
    v_mfma_f32_16x16x32_bf16 a[88:91], v[196:199], v[220:223], a[88:91]
    v_mfma_f32_16x16x32_bf16 a[92:95], v[196:199], v[224:227], a[92:95]
    s_add_u32 s58, s31, 245760
    buffer_load_dwordx2 v[162:163], v9, s[20:23], s58 offen offset:512 nt
    ds_read_b128 v[196:199], v25 offset:16640
    s_waitcnt lgkmcnt(8)
    v_mfma_f32_16x16x32_bf16 a[96:99], v[200:203], v[212:215], a[96:99]
    v_mfma_f32_16x16x32_bf16 a[100:103], v[200:203], v[216:219], a[100:103]
    v_mfma_f32_16x16x32_bf16 a[104:107], v[200:203], v[220:223], a[104:107]
    v_mfma_f32_16x16x32_bf16 a[108:111], v[200:203], v[224:227], a[108:111]
    s_add_u32 s59, s31, 245760
    buffer_load_dwordx2 v[164:165], v9, s[20:23], s59 offen offset:1024 nt
    ds_read_b128 v[200:203], v25 offset:33024
    s_waitcnt lgkmcnt(8)
    v_mfma_f32_16x16x32_bf16 a[112:115], v[204:207], v[212:215], a[112:115]
    v_mfma_f32_16x16x32_bf16 a[116:119], v[204:207], v[216:219], a[116:119]
    v_mfma_f32_16x16x32_bf16 a[120:123], v[204:207], v[220:223], a[120:123]
    v_mfma_f32_16x16x32_bf16 a[124:127], v[204:207], v[224:227], a[124:127]
    s_add_u32 s46, s31, 245760
    buffer_load_dwordx2 v[166:167], v9, s[20:23], s46 offen offset:1536 nt
    ds_read_b128 v[204:207], v25 offset:49408
    s_waitcnt lgkmcnt(8)
    v_mfma_f32_16x16x32_bf16 a[128:131], v[208:211], v[212:215], a[128:131]
    v_mfma_f32_16x16x32_bf16 a[132:135], v[208:211], v[216:219], a[132:135]
    v_mfma_f32_16x16x32_bf16 a[136:139], v[208:211], v[220:223], a[136:139]
    v_mfma_f32_16x16x32_bf16 a[140:143], v[208:211], v[224:227], a[140:143]
    s_add_u32 s47, s31, 245760
    buffer_load_dwordx2 v[168:169], v9, s[20:23], s47 offen offset:2048 nt
    ds_read_b128 v[208:211], v26 offset:256
    v_xor_b32 v24, 0, v23
    v_add_u32 v25, 65536, v24
    v_add_u32 v26, 131072, v24
    s_waitcnt lgkmcnt(8)
    v_mfma_f32_16x16x32_bf16 a[0:3], v[176:179], v[228:231], a[0:3]
    s_waitcnt vmcnt(53)
    v_mfma_f32_16x16x32_bf16 a[4:7], v[176:179], v[232:235], a[4:7]
    v_perm_b32 v212, v50, v48, s34
    v_mfma_f32_16x16x32_bf16 a[8:11], v[176:179], v[236:239], a[8:11]
    v_perm_b32 v213, v54, v52, s34
    v_mfma_f32_16x16x32_bf16 a[12:15], v[176:179], v[240:243], a[12:15]
    v_perm_b32 v214, v58, v56, s34
    s_add_u32 s58, s31, 245760
    buffer_load_dwordx2 v[170:171], v9, s[20:23], s58 offen offset:2560 nt
    ds_read_b128 v[176:179], v24 offset:512
    s_waitcnt lgkmcnt(8)
    v_mfma_f32_16x16x32_bf16 a[16:19], v[180:183], v[228:231], a[16:19]
    v_perm_b32 v215, v62, v60, s34
    v_mfma_f32_16x16x32_bf16 a[20:23], v[180:183], v[232:235], a[20:23]
    v_perm_b32 v216, v50, v48, s35
    v_mfma_f32_16x16x32_bf16 a[24:27], v[180:183], v[236:239], a[24:27]
    v_perm_b32 v217, v54, v52, s35
    v_mfma_f32_16x16x32_bf16 a[28:31], v[180:183], v[240:243], a[28:31]
    v_perm_b32 v218, v58, v56, s35
    s_add_u32 s59, s31, 245760
    buffer_load_dwordx2 v[172:173], v9, s[20:23], s59 offen offset:3072 nt
    ds_read_b128 v[180:183], v24 offset:16896
    s_waitcnt lgkmcnt(8)
    v_mfma_f32_16x16x32_bf16 a[32:35], v[184:187], v[228:231], a[32:35]
    v_perm_b32 v219, v62, v60, s35
    v_mfma_f32_16x16x32_bf16 a[36:39], v[184:187], v[232:235], a[36:39]
    v_perm_b32 v220, v51, v49, s34
    v_mfma_f32_16x16x32_bf16 a[40:43], v[184:187], v[236:239], a[40:43]
    v_perm_b32 v221, v55, v53, s34
    v_mfma_f32_16x16x32_bf16 a[44:47], v[184:187], v[240:243], a[44:47]
    v_perm_b32 v222, v59, v57, s34
    s_add_u32 s46, s31, 245760
    buffer_load_dwordx2 v[174:175], v9, s[20:23], s46 offen offset:3584 nt
    ds_read_b128 v[184:187], v24 offset:33280
    s_waitcnt lgkmcnt(8)
    v_mfma_f32_16x16x32_bf16 a[48:51], v[188:191], v[228:231], a[48:51]
    v_perm_b32 v223, v63, v61, s34
    v_mfma_f32_16x16x32_bf16 a[52:55], v[188:191], v[232:235], a[52:55]
    v_perm_b32 v224, v51, v49, s35
    v_mfma_f32_16x16x32_bf16 a[56:59], v[188:191], v[236:239], a[56:59]
    v_perm_b32 v225, v55, v53, s35
    v_mfma_f32_16x16x32_bf16 a[60:63], v[188:191], v[240:243], a[60:63]
    v_perm_b32 v226, v59, v57, s35
    ds_read_b128 v[188:191], v24 offset:49664
    s_waitcnt lgkmcnt(8)
    v_mfma_f32_16x16x32_bf16 a[64:67], v[192:195], v[228:231], a[64:67]
    v_perm_b32 v227, v63, v61, s35
    v_mfma_f32_16x16x32_bf16 a[68:71], v[192:195], v[232:235], a[68:71]
    v_mfma_f32_16x16x32_bf16 a[72:75], v[192:195], v[236:239], a[72:75]
    v_mfma_f32_16x16x32_bf16 a[76:79], v[192:195], v[240:243], a[76:79]
    ds_read_b128 v[192:195], v25 offset:512
    s_waitcnt lgkmcnt(8)
    v_mfma_f32_16x16x32_bf16 a[80:83], v[196:199], v[228:231], a[80:83]
    v_mfma_f32_16x16x32_bf16 a[84:87], v[196:199], v[232:235], a[84:87]
    v_mfma_f32_16x16x32_bf16 a[88:91], v[196:199], v[236:239], a[88:91]
    v_mfma_f32_16x16x32_bf16 a[92:95], v[196:199], v[240:243], a[92:95]
    ds_read_b128 v[196:199], v25 offset:16896
    s_waitcnt lgkmcnt(8)
    v_mfma_f32_16x16x32_bf16 a[96:99], v[200:203], v[228:231], a[96:99]
    v_mfma_f32_16x16x32_bf16 a[100:103], v[200:203], v[232:235], a[100:103]
    v_mfma_f32_16x16x32_bf16 a[104:107], v[200:203], v[236:239], a[104:107]
    v_mfma_f32_16x16x32_bf16 a[108:111], v[200:203], v[240:243], a[108:111]
    ds_read_b128 v[200:203], v25 offset:33280
    s_waitcnt lgkmcnt(8)
    v_mfma_f32_16x16x32_bf16 a[112:115], v[204:207], v[228:231], a[112:115]
    v_mfma_f32_16x16x32_bf16 a[116:119], v[204:207], v[232:235], a[116:119]
    v_mfma_f32_16x16x32_bf16 a[120:123], v[204:207], v[236:239], a[120:123]
    v_mfma_f32_16x16x32_bf16 a[124:127], v[204:207], v[240:243], a[124:127]
    ds_read_b128 v[204:207], v25 offset:49664
    s_waitcnt lgkmcnt(8)
    v_mfma_f32_16x16x32_bf16 a[128:131], v[208:211], v[228:231], a[128:131]
    v_mfma_f32_16x16x32_bf16 a[132:135], v[208:211], v[232:235], a[132:135]
    v_mfma_f32_16x16x32_bf16 a[136:139], v[208:211], v[236:239], a[136:139]
    v_mfma_f32_16x16x32_bf16 a[140:143], v[208:211], v[240:243], a[140:143]
    ds_read_b128 v[208:211], v26 offset:512
    v_xor_b32 v24, 64, v23
    v_add_u32 v25, 65536, v24
    v_add_u32 v26, 131072, v24
    s_waitcnt lgkmcnt(8)
    v_mfma_f32_16x16x32_bf16 a[0:3], v[176:179], v[212:215], a[0:3]
    s_waitcnt vmcnt(48)
    v_mfma_f32_16x16x32_bf16 a[4:7], v[176:179], v[216:219], a[4:7]
    v_perm_b32 v228, v66, v64, s34
    v_mfma_f32_16x16x32_bf16 a[8:11], v[176:179], v[220:223], a[8:11]
    v_perm_b32 v229, v70, v68, s34
    v_mfma_f32_16x16x32_bf16 a[12:15], v[176:179], v[224:227], a[12:15]
    v_perm_b32 v230, v74, v72, s34
    ds_read_b128 v[176:179], v24 offset:512
    s_waitcnt lgkmcnt(8)
    v_mfma_f32_16x16x32_bf16 a[16:19], v[180:183], v[212:215], a[16:19]
    v_perm_b32 v231, v78, v76, s34
    v_mfma_f32_16x16x32_bf16 a[20:23], v[180:183], v[216:219], a[20:23]
    v_perm_b32 v232, v66, v64, s35
    v_mfma_f32_16x16x32_bf16 a[24:27], v[180:183], v[220:223], a[24:27]
    v_perm_b32 v233, v70, v68, s35
    v_mfma_f32_16x16x32_bf16 a[28:31], v[180:183], v[224:227], a[28:31]
    v_perm_b32 v234, v74, v72, s35
    ds_read_b128 v[180:183], v24 offset:16896
    s_waitcnt lgkmcnt(8)
    v_mfma_f32_16x16x32_bf16 a[32:35], v[184:187], v[212:215], a[32:35]
    v_perm_b32 v235, v78, v76, s35
    v_mfma_f32_16x16x32_bf16 a[36:39], v[184:187], v[216:219], a[36:39]
    v_perm_b32 v236, v67, v65, s34
    v_mfma_f32_16x16x32_bf16 a[40:43], v[184:187], v[220:223], a[40:43]
    v_perm_b32 v237, v71, v69, s34
    v_mfma_f32_16x16x32_bf16 a[44:47], v[184:187], v[224:227], a[44:47]
    v_perm_b32 v238, v75, v73, s34
    ds_read_b128 v[184:187], v24 offset:33280
    s_waitcnt lgkmcnt(8)
    v_mfma_f32_16x16x32_bf16 a[48:51], v[188:191], v[212:215], a[48:51]
    v_perm_b32 v239, v79, v77, s34
    v_mfma_f32_16x16x32_bf16 a[52:55], v[188:191], v[216:219], a[52:55]
    v_perm_b32 v240, v67, v65, s35
    v_mfma_f32_16x16x32_bf16 a[56:59], v[188:191], v[220:223], a[56:59]
    v_perm_b32 v241, v71, v69, s35
    v_mfma_f32_16x16x32_bf16 a[60:63], v[188:191], v[224:227], a[60:63]
    v_perm_b32 v242, v75, v73, s35
    ds_read_b128 v[188:191], v24 offset:49664
    s_waitcnt lgkmcnt(8)
    v_mfma_f32_16x16x32_bf16 a[64:67], v[192:195], v[212:215], a[64:67]
    v_perm_b32 v243, v79, v77, s35
    v_mfma_f32_16x16x32_bf16 a[68:71], v[192:195], v[216:219], a[68:71]
    v_mfma_f32_16x16x32_bf16 a[72:75], v[192:195], v[220:223], a[72:75]
    v_mfma_f32_16x16x32_bf16 a[76:79], v[192:195], v[224:227], a[76:79]
    ds_read_b128 v[192:195], v25 offset:512
    s_waitcnt lgkmcnt(8)
    v_mfma_f32_16x16x32_bf16 a[80:83], v[196:199], v[212:215], a[80:83]
    v_mfma_f32_16x16x32_bf16 a[84:87], v[196:199], v[216:219], a[84:87]
    v_mfma_f32_16x16x32_bf16 a[88:91], v[196:199], v[220:223], a[88:91]
    v_mfma_f32_16x16x32_bf16 a[92:95], v[196:199], v[224:227], a[92:95]
    ds_read_b128 v[196:199], v25 offset:16896
    s_waitcnt lgkmcnt(8)
    v_mfma_f32_16x16x32_bf16 a[96:99], v[200:203], v[212:215], a[96:99]
    v_mfma_f32_16x16x32_bf16 a[100:103], v[200:203], v[216:219], a[100:103]
    v_mfma_f32_16x16x32_bf16 a[104:107], v[200:203], v[220:223], a[104:107]
    v_mfma_f32_16x16x32_bf16 a[108:111], v[200:203], v[224:227], a[108:111]
    ds_read_b128 v[200:203], v25 offset:33280
    s_waitcnt lgkmcnt(8)
    v_mfma_f32_16x16x32_bf16 a[112:115], v[204:207], v[212:215], a[112:115]
    v_mfma_f32_16x16x32_bf16 a[116:119], v[204:207], v[216:219], a[116:119]
    v_mfma_f32_16x16x32_bf16 a[120:123], v[204:207], v[220:223], a[120:123]
    v_mfma_f32_16x16x32_bf16 a[124:127], v[204:207], v[224:227], a[124:127]
    ds_read_b128 v[204:207], v25 offset:49664
    s_waitcnt lgkmcnt(8)
    v_mfma_f32_16x16x32_bf16 a[128:131], v[208:211], v[212:215], a[128:131]
    v_mfma_f32_16x16x32_bf16 a[132:135], v[208:211], v[216:219], a[132:135]
    v_mfma_f32_16x16x32_bf16 a[136:139], v[208:211], v[220:223], a[136:139]
    v_mfma_f32_16x16x32_bf16 a[140:143], v[208:211], v[224:227], a[140:143]
    ds_read_b128 v[208:211], v26 offset:512
    v_xor_b32 v24, 128, v23
    v_add_u32 v25, 65536, v24
    v_add_u32 v26, 131072, v24
    s_waitcnt lgkmcnt(8)
    v_mfma_f32_16x16x32_bf16 a[0:3], v[176:179], v[228:231], a[0:3]
    s_waitcnt vmcnt(40)
    v_mfma_f32_16x16x32_bf16 a[4:7], v[176:179], v[232:235], a[4:7]
    v_perm_b32 v212, v82, v80, s34
    v_mfma_f32_16x16x32_bf16 a[8:11], v[176:179], v[236:239], a[8:11]
    v_perm_b32 v213, v86, v84, s34
    v_mfma_f32_16x16x32_bf16 a[12:15], v[176:179], v[240:243], a[12:15]
    v_perm_b32 v214, v90, v88, s34
    ds_read_b128 v[176:179], v24 offset:512
    s_waitcnt lgkmcnt(8)
    v_mfma_f32_16x16x32_bf16 a[16:19], v[180:183], v[228:231], a[16:19]
    v_perm_b32 v215, v94, v92, s34
    v_mfma_f32_16x16x32_bf16 a[20:23], v[180:183], v[232:235], a[20:23]
    v_perm_b32 v216, v82, v80, s35
    v_mfma_f32_16x16x32_bf16 a[24:27], v[180:183], v[236:239], a[24:27]
    v_perm_b32 v217, v86, v84, s35
    v_mfma_f32_16x16x32_bf16 a[28:31], v[180:183], v[240:243], a[28:31]
    v_perm_b32 v218, v90, v88, s35
    ds_read_b128 v[180:183], v24 offset:16896
    s_waitcnt lgkmcnt(8)
    v_mfma_f32_16x16x32_bf16 a[32:35], v[184:187], v[228:231], a[32:35]
    v_perm_b32 v219, v94, v92, s35
    v_mfma_f32_16x16x32_bf16 a[36:39], v[184:187], v[232:235], a[36:39]
    v_perm_b32 v220, v83, v81, s34
    v_mfma_f32_16x16x32_bf16 a[40:43], v[184:187], v[236:239], a[40:43]
    v_perm_b32 v221, v87, v85, s34
    v_mfma_f32_16x16x32_bf16 a[44:47], v[184:187], v[240:243], a[44:47]
    v_perm_b32 v222, v91, v89, s34
    ds_read_b128 v[184:187], v24 offset:33280
    s_waitcnt lgkmcnt(8)
    v_mfma_f32_16x16x32_bf16 a[48:51], v[188:191], v[228:231], a[48:51]
    v_perm_b32 v223, v95, v93, s34
    v_mfma_f32_16x16x32_bf16 a[52:55], v[188:191], v[232:235], a[52:55]
    v_perm_b32 v224, v83, v81, s35
    v_mfma_f32_16x16x32_bf16 a[56:59], v[188:191], v[236:239], a[56:59]
    v_perm_b32 v225, v87, v85, s35
    v_mfma_f32_16x16x32_bf16 a[60:63], v[188:191], v[240:243], a[60:63]
    v_perm_b32 v226, v91, v89, s35
    ds_read_b128 v[188:191], v24 offset:49664
    s_waitcnt lgkmcnt(8)
    v_mfma_f32_16x16x32_bf16 a[64:67], v[192:195], v[228:231], a[64:67]
    v_perm_b32 v227, v95, v93, s35
    v_mfma_f32_16x16x32_bf16 a[68:71], v[192:195], v[232:235], a[68:71]
    v_mfma_f32_16x16x32_bf16 a[72:75], v[192:195], v[236:239], a[72:75]
    v_mfma_f32_16x16x32_bf16 a[76:79], v[192:195], v[240:243], a[76:79]
    ds_read_b128 v[192:195], v25 offset:512
    s_waitcnt lgkmcnt(8)
    v_mfma_f32_16x16x32_bf16 a[80:83], v[196:199], v[228:231], a[80:83]
    v_mfma_f32_16x16x32_bf16 a[84:87], v[196:199], v[232:235], a[84:87]
    v_mfma_f32_16x16x32_bf16 a[88:91], v[196:199], v[236:239], a[88:91]
    v_mfma_f32_16x16x32_bf16 a[92:95], v[196:199], v[240:243], a[92:95]
    ds_read_b128 v[196:199], v25 offset:16896
    s_waitcnt lgkmcnt(8)
    v_mfma_f32_16x16x32_bf16 a[96:99], v[200:203], v[228:231], a[96:99]
    v_mfma_f32_16x16x32_bf16 a[100:103], v[200:203], v[232:235], a[100:103]
    v_mfma_f32_16x16x32_bf16 a[104:107], v[200:203], v[236:239], a[104:107]
    v_mfma_f32_16x16x32_bf16 a[108:111], v[200:203], v[240:243], a[108:111]
    ds_read_b128 v[200:203], v25 offset:33280
    s_waitcnt lgkmcnt(8)
    v_mfma_f32_16x16x32_bf16 a[112:115], v[204:207], v[228:231], a[112:115]
    v_mfma_f32_16x16x32_bf16 a[116:119], v[204:207], v[232:235], a[116:119]
    v_mfma_f32_16x16x32_bf16 a[120:123], v[204:207], v[236:239], a[120:123]
    v_mfma_f32_16x16x32_bf16 a[124:127], v[204:207], v[240:243], a[124:127]
    ds_read_b128 v[204:207], v25 offset:49664
    s_waitcnt lgkmcnt(8)
    v_mfma_f32_16x16x32_bf16 a[128:131], v[208:211], v[228:231], a[128:131]
    v_mfma_f32_16x16x32_bf16 a[132:135], v[208:211], v[232:235], a[132:135]
    v_mfma_f32_16x16x32_bf16 a[136:139], v[208:211], v[236:239], a[136:139]
    v_mfma_f32_16x16x32_bf16 a[140:143], v[208:211], v[240:243], a[140:143]
    ds_read_b128 v[208:211], v26 offset:512
    v_xor_b32 v24, 192, v23
    v_add_u32 v25, 65536, v24
    v_add_u32 v26, 131072, v24
    s_waitcnt lgkmcnt(8)
    v_mfma_f32_16x16x32_bf16 a[0:3], v[176:179], v[212:215], a[0:3]
    s_waitcnt vmcnt(32)
    v_mfma_f32_16x16x32_bf16 a[4:7], v[176:179], v[216:219], a[4:7]
    v_perm_b32 v228, v98, v96, s34
    v_mfma_f32_16x16x32_bf16 a[8:11], v[176:179], v[220:223], a[8:11]
    v_perm_b32 v229, v102, v100, s34
    v_mfma_f32_16x16x32_bf16 a[12:15], v[176:179], v[224:227], a[12:15]
    v_perm_b32 v230, v106, v104, s34
    ds_read_b128 v[176:179], v24 offset:512
    s_waitcnt lgkmcnt(8)
    v_mfma_f32_16x16x32_bf16 a[16:19], v[180:183], v[212:215], a[16:19]
    v_perm_b32 v231, v110, v108, s34
    v_mfma_f32_16x16x32_bf16 a[20:23], v[180:183], v[216:219], a[20:23]
    v_perm_b32 v232, v98, v96, s35
    v_mfma_f32_16x16x32_bf16 a[24:27], v[180:183], v[220:223], a[24:27]
    v_perm_b32 v233, v102, v100, s35
    v_mfma_f32_16x16x32_bf16 a[28:31], v[180:183], v[224:227], a[28:31]
    v_perm_b32 v234, v106, v104, s35
    ds_read_b128 v[180:183], v24 offset:16896
    s_waitcnt lgkmcnt(8)
    v_mfma_f32_16x16x32_bf16 a[32:35], v[184:187], v[212:215], a[32:35]
    v_perm_b32 v235, v110, v108, s35
    v_mfma_f32_16x16x32_bf16 a[36:39], v[184:187], v[216:219], a[36:39]
    v_perm_b32 v236, v99, v97, s34
    v_mfma_f32_16x16x32_bf16 a[40:43], v[184:187], v[220:223], a[40:43]
    v_perm_b32 v237, v103, v101, s34
    v_mfma_f32_16x16x32_bf16 a[44:47], v[184:187], v[224:227], a[44:47]
    v_perm_b32 v238, v107, v105, s34
    ds_read_b128 v[184:187], v24 offset:33280
    s_waitcnt lgkmcnt(8)
    v_mfma_f32_16x16x32_bf16 a[48:51], v[188:191], v[212:215], a[48:51]
    v_perm_b32 v239, v111, v109, s34
    v_mfma_f32_16x16x32_bf16 a[52:55], v[188:191], v[216:219], a[52:55]
    v_perm_b32 v240, v99, v97, s35
    v_mfma_f32_16x16x32_bf16 a[56:59], v[188:191], v[220:223], a[56:59]
    v_perm_b32 v241, v103, v101, s35
    v_mfma_f32_16x16x32_bf16 a[60:63], v[188:191], v[224:227], a[60:63]
    v_perm_b32 v242, v107, v105, s35
    ds_read_b128 v[188:191], v24 offset:49664
    s_waitcnt lgkmcnt(8)
    v_mfma_f32_16x16x32_bf16 a[64:67], v[192:195], v[212:215], a[64:67]
    v_perm_b32 v243, v111, v109, s35
    v_mfma_f32_16x16x32_bf16 a[68:71], v[192:195], v[216:219], a[68:71]
    v_mfma_f32_16x16x32_bf16 a[72:75], v[192:195], v[220:223], a[72:75]
    v_mfma_f32_16x16x32_bf16 a[76:79], v[192:195], v[224:227], a[76:79]
    ds_read_b128 v[192:195], v25 offset:512
    s_waitcnt lgkmcnt(8)
    v_mfma_f32_16x16x32_bf16 a[80:83], v[196:199], v[212:215], a[80:83]
    v_mfma_f32_16x16x32_bf16 a[84:87], v[196:199], v[216:219], a[84:87]
    v_mfma_f32_16x16x32_bf16 a[88:91], v[196:199], v[220:223], a[88:91]
    v_mfma_f32_16x16x32_bf16 a[92:95], v[196:199], v[224:227], a[92:95]
    ds_read_b128 v[196:199], v25 offset:16896
    s_waitcnt lgkmcnt(8)
    v_mfma_f32_16x16x32_bf16 a[96:99], v[200:203], v[212:215], a[96:99]
    v_mfma_f32_16x16x32_bf16 a[100:103], v[200:203], v[216:219], a[100:103]
    v_mfma_f32_16x16x32_bf16 a[104:107], v[200:203], v[220:223], a[104:107]
    v_mfma_f32_16x16x32_bf16 a[108:111], v[200:203], v[224:227], a[108:111]
    ds_read_b128 v[200:203], v25 offset:33280
    s_waitcnt lgkmcnt(8)
    v_mfma_f32_16x16x32_bf16 a[112:115], v[204:207], v[212:215], a[112:115]
    v_mfma_f32_16x16x32_bf16 a[116:119], v[204:207], v[216:219], a[116:119]
    v_mfma_f32_16x16x32_bf16 a[120:123], v[204:207], v[220:223], a[120:123]
    v_mfma_f32_16x16x32_bf16 a[124:127], v[204:207], v[224:227], a[124:127]
    ds_read_b128 v[204:207], v25 offset:49664
    s_waitcnt lgkmcnt(8)
    v_mfma_f32_16x16x32_bf16 a[128:131], v[208:211], v[212:215], a[128:131]
    v_mfma_f32_16x16x32_bf16 a[132:135], v[208:211], v[216:219], a[132:135]
    v_mfma_f32_16x16x32_bf16 a[136:139], v[208:211], v[220:223], a[136:139]
    v_mfma_f32_16x16x32_bf16 a[140:143], v[208:211], v[224:227], a[140:143]
    ds_read_b128 v[208:211], v26 offset:512
    v_xor_b32 v24, 0, v23
    v_add_u32 v25, 65536, v24
    v_add_u32 v26, 131072, v24
    s_waitcnt lgkmcnt(8)
    v_mfma_f32_16x16x32_bf16 a[0:3], v[176:179], v[228:231], a[0:3]
    s_waitcnt vmcnt(24)
    v_mfma_f32_16x16x32_bf16 a[4:7], v[176:179], v[232:235], a[4:7]
    v_perm_b32 v212, v114, v112, s34
    v_mfma_f32_16x16x32_bf16 a[8:11], v[176:179], v[236:239], a[8:11]
    v_perm_b32 v213, v118, v116, s34
    v_mfma_f32_16x16x32_bf16 a[12:15], v[176:179], v[240:243], a[12:15]
    v_perm_b32 v214, v122, v120, s34
    ds_read_b128 v[176:179], v24 offset:768
    s_waitcnt lgkmcnt(8)
    v_mfma_f32_16x16x32_bf16 a[16:19], v[180:183], v[228:231], a[16:19]
    v_perm_b32 v215, v126, v124, s34
    v_mfma_f32_16x16x32_bf16 a[20:23], v[180:183], v[232:235], a[20:23]
    v_perm_b32 v216, v114, v112, s35
    v_mfma_f32_16x16x32_bf16 a[24:27], v[180:183], v[236:239], a[24:27]
    v_perm_b32 v217, v118, v116, s35
    v_mfma_f32_16x16x32_bf16 a[28:31], v[180:183], v[240:243], a[28:31]
    v_perm_b32 v218, v122, v120, s35
    ds_read_b128 v[180:183], v24 offset:17152
    s_waitcnt lgkmcnt(8)
    v_mfma_f32_16x16x32_bf16 a[32:35], v[184:187], v[228:231], a[32:35]
    v_perm_b32 v219, v126, v124, s35
    v_mfma_f32_16x16x32_bf16 a[36:39], v[184:187], v[232:235], a[36:39]
    v_perm_b32 v220, v115, v113, s34
    v_mfma_f32_16x16x32_bf16 a[40:43], v[184:187], v[236:239], a[40:43]
    v_perm_b32 v221, v119, v117, s34
    v_mfma_f32_16x16x32_bf16 a[44:47], v[184:187], v[240:243], a[44:47]
    v_perm_b32 v222, v123, v121, s34
    ds_read_b128 v[184:187], v24 offset:33536
    s_waitcnt lgkmcnt(8)
    v_mfma_f32_16x16x32_bf16 a[48:51], v[188:191], v[228:231], a[48:51]
    v_perm_b32 v223, v127, v125, s34
    v_mfma_f32_16x16x32_bf16 a[52:55], v[188:191], v[232:235], a[52:55]
    v_perm_b32 v224, v115, v113, s35
    v_mfma_f32_16x16x32_bf16 a[56:59], v[188:191], v[236:239], a[56:59]
    v_perm_b32 v225, v119, v117, s35
    v_mfma_f32_16x16x32_bf16 a[60:63], v[188:191], v[240:243], a[60:63]
    v_perm_b32 v226, v123, v121, s35
    ds_read_b128 v[188:191], v24 offset:49920
    s_waitcnt lgkmcnt(8)
    v_mfma_f32_16x16x32_bf16 a[64:67], v[192:195], v[228:231], a[64:67]
    v_perm_b32 v227, v127, v125, s35
    v_mfma_f32_16x16x32_bf16 a[68:71], v[192:195], v[232:235], a[68:71]
    v_mfma_f32_16x16x32_bf16 a[72:75], v[192:195], v[236:239], a[72:75]
    v_mfma_f32_16x16x32_bf16 a[76:79], v[192:195], v[240:243], a[76:79]
    ds_read_b128 v[192:195], v25 offset:768
    s_waitcnt lgkmcnt(8)
    v_mfma_f32_16x16x32_bf16 a[80:83], v[196:199], v[228:231], a[80:83]
    v_mfma_f32_16x16x32_bf16 a[84:87], v[196:199], v[232:235], a[84:87]
    v_mfma_f32_16x16x32_bf16 a[88:91], v[196:199], v[236:239], a[88:91]
    v_mfma_f32_16x16x32_bf16 a[92:95], v[196:199], v[240:243], a[92:95]
    ds_read_b128 v[196:199], v25 offset:17152
    s_waitcnt lgkmcnt(8)
    v_mfma_f32_16x16x32_bf16 a[96:99], v[200:203], v[228:231], a[96:99]
    v_mfma_f32_16x16x32_bf16 a[100:103], v[200:203], v[232:235], a[100:103]
    v_mfma_f32_16x16x32_bf16 a[104:107], v[200:203], v[236:239], a[104:107]
    v_mfma_f32_16x16x32_bf16 a[108:111], v[200:203], v[240:243], a[108:111]
    ds_read_b128 v[200:203], v25 offset:33536
    s_waitcnt lgkmcnt(8)
    v_mfma_f32_16x16x32_bf16 a[112:115], v[204:207], v[228:231], a[112:115]
    v_mfma_f32_16x16x32_bf16 a[116:119], v[204:207], v[232:235], a[116:119]
    v_mfma_f32_16x16x32_bf16 a[120:123], v[204:207], v[236:239], a[120:123]
    v_mfma_f32_16x16x32_bf16 a[124:127], v[204:207], v[240:243], a[124:127]
    ds_read_b128 v[204:207], v25 offset:49920
    s_waitcnt lgkmcnt(8)
    v_mfma_f32_16x16x32_bf16 a[128:131], v[208:211], v[228:231], a[128:131]
    v_mfma_f32_16x16x32_bf16 a[132:135], v[208:211], v[232:235], a[132:135]
    v_mfma_f32_16x16x32_bf16 a[136:139], v[208:211], v[236:239], a[136:139]
    v_mfma_f32_16x16x32_bf16 a[140:143], v[208:211], v[240:243], a[140:143]
    ds_read_b128 v[208:211], v26 offset:768
    v_xor_b32 v24, 64, v23
    v_add_u32 v25, 65536, v24
    v_add_u32 v26, 131072, v24
    s_waitcnt lgkmcnt(8)
    v_mfma_f32_16x16x32_bf16 a[0:3], v[176:179], v[212:215], a[0:3]
    s_waitcnt vmcnt(16)
    v_mfma_f32_16x16x32_bf16 a[4:7], v[176:179], v[216:219], a[4:7]
    v_perm_b32 v228, v130, v128, s34
    v_mfma_f32_16x16x32_bf16 a[8:11], v[176:179], v[220:223], a[8:11]
    v_perm_b32 v229, v134, v132, s34
    v_mfma_f32_16x16x32_bf16 a[12:15], v[176:179], v[224:227], a[12:15]
    v_perm_b32 v230, v138, v136, s34
    ds_read_b128 v[176:179], v24 offset:768
    s_waitcnt lgkmcnt(8)
    v_mfma_f32_16x16x32_bf16 a[16:19], v[180:183], v[212:215], a[16:19]
    v_perm_b32 v231, v142, v140, s34
    v_mfma_f32_16x16x32_bf16 a[20:23], v[180:183], v[216:219], a[20:23]
    v_perm_b32 v232, v130, v128, s35
    v_mfma_f32_16x16x32_bf16 a[24:27], v[180:183], v[220:223], a[24:27]
    v_perm_b32 v233, v134, v132, s35
    v_mfma_f32_16x16x32_bf16 a[28:31], v[180:183], v[224:227], a[28:31]
    v_perm_b32 v234, v138, v136, s35
    ds_read_b128 v[180:183], v24 offset:17152
    s_waitcnt lgkmcnt(8)
    v_mfma_f32_16x16x32_bf16 a[32:35], v[184:187], v[212:215], a[32:35]
    v_perm_b32 v235, v142, v140, s35
    v_mfma_f32_16x16x32_bf16 a[36:39], v[184:187], v[216:219], a[36:39]
    v_perm_b32 v236, v131, v129, s34
    v_mfma_f32_16x16x32_bf16 a[40:43], v[184:187], v[220:223], a[40:43]
    v_perm_b32 v237, v135, v133, s34
    v_mfma_f32_16x16x32_bf16 a[44:47], v[184:187], v[224:227], a[44:47]
    v_perm_b32 v238, v139, v137, s34
    ds_read_b128 v[184:187], v24 offset:33536
    s_waitcnt lgkmcnt(8)
    v_mfma_f32_16x16x32_bf16 a[48:51], v[188:191], v[212:215], a[48:51]
    v_perm_b32 v239, v143, v141, s34
    v_mfma_f32_16x16x32_bf16 a[52:55], v[188:191], v[216:219], a[52:55]
    v_perm_b32 v240, v131, v129, s35
    v_mfma_f32_16x16x32_bf16 a[56:59], v[188:191], v[220:223], a[56:59]
    v_perm_b32 v241, v135, v133, s35
    v_mfma_f32_16x16x32_bf16 a[60:63], v[188:191], v[224:227], a[60:63]
    v_perm_b32 v242, v139, v137, s35
    ds_read_b128 v[188:191], v24 offset:49920
    s_waitcnt lgkmcnt(8)
    v_mfma_f32_16x16x32_bf16 a[64:67], v[192:195], v[212:215], a[64:67]
    v_perm_b32 v243, v143, v141, s35
    v_mfma_f32_16x16x32_bf16 a[68:71], v[192:195], v[216:219], a[68:71]
    v_mfma_f32_16x16x32_bf16 a[72:75], v[192:195], v[220:223], a[72:75]
    v_mfma_f32_16x16x32_bf16 a[76:79], v[192:195], v[224:227], a[76:79]
    ds_read_b128 v[192:195], v25 offset:768
    s_waitcnt lgkmcnt(8)
    v_mfma_f32_16x16x32_bf16 a[80:83], v[196:199], v[212:215], a[80:83]
    v_mfma_f32_16x16x32_bf16 a[84:87], v[196:199], v[216:219], a[84:87]
    v_mfma_f32_16x16x32_bf16 a[88:91], v[196:199], v[220:223], a[88:91]
    v_mfma_f32_16x16x32_bf16 a[92:95], v[196:199], v[224:227], a[92:95]
    ds_read_b128 v[196:199], v25 offset:17152
    s_waitcnt lgkmcnt(8)
    v_mfma_f32_16x16x32_bf16 a[96:99], v[200:203], v[212:215], a[96:99]
    v_mfma_f32_16x16x32_bf16 a[100:103], v[200:203], v[216:219], a[100:103]
    v_mfma_f32_16x16x32_bf16 a[104:107], v[200:203], v[220:223], a[104:107]
    v_mfma_f32_16x16x32_bf16 a[108:111], v[200:203], v[224:227], a[108:111]
    ds_read_b128 v[200:203], v25 offset:33536
    s_waitcnt lgkmcnt(8)
    v_mfma_f32_16x16x32_bf16 a[112:115], v[204:207], v[212:215], a[112:115]
    v_mfma_f32_16x16x32_bf16 a[116:119], v[204:207], v[216:219], a[116:119]
    v_mfma_f32_16x16x32_bf16 a[120:123], v[204:207], v[220:223], a[120:123]
    v_mfma_f32_16x16x32_bf16 a[124:127], v[204:207], v[224:227], a[124:127]
    ds_read_b128 v[204:207], v25 offset:49920
    s_waitcnt lgkmcnt(8)
    v_mfma_f32_16x16x32_bf16 a[128:131], v[208:211], v[212:215], a[128:131]
    v_mfma_f32_16x16x32_bf16 a[132:135], v[208:211], v[216:219], a[132:135]
    v_mfma_f32_16x16x32_bf16 a[136:139], v[208:211], v[220:223], a[136:139]
    v_mfma_f32_16x16x32_bf16 a[140:143], v[208:211], v[224:227], a[140:143]
    ds_read_b128 v[208:211], v26 offset:768
    v_xor_b32 v24, 128, v23
    v_add_u32 v25, 65536, v24
    v_add_u32 v26, 131072, v24
    s_waitcnt lgkmcnt(8)
    v_mfma_f32_16x16x32_bf16 a[0:3], v[176:179], v[228:231], a[0:3]
    s_waitcnt vmcnt(8)
    v_perm_b32 v212, v146, v144, s34
    v_mfma_f32_16x16x32_bf16 a[4:7], v[176:179], v[232:235], a[4:7]
    v_perm_b32 v213, v150, v148, s34
    v_perm_b32 v214, v154, v152, s34
    v_mfma_f32_16x16x32_bf16 a[8:11], v[176:179], v[236:239], a[8:11]
    v_perm_b32 v215, v158, v156, s34
    v_perm_b32 v216, v146, v144, s35
    v_mfma_f32_16x16x32_bf16 a[12:15], v[176:179], v[240:243], a[12:15]
    v_perm_b32 v217, v150, v148, s35
    v_perm_b32 v218, v154, v152, s35
    ds_read_b128 v[176:179], v24 offset:768
    s_waitcnt lgkmcnt(8)
    v_mfma_f32_16x16x32_bf16 a[16:19], v[180:183], v[228:231], a[16:19]
    v_perm_b32 v219, v158, v156, s35
    v_perm_b32 v220, v147, v145, s34
    v_mfma_f32_16x16x32_bf16 a[20:23], v[180:183], v[232:235], a[20:23]
    v_perm_b32 v221, v151, v149, s34
    v_perm_b32 v222, v155, v153, s34
    v_mfma_f32_16x16x32_bf16 a[24:27], v[180:183], v[236:239], a[24:27]
    v_perm_b32 v223, v159, v157, s34
    v_perm_b32 v224, v147, v145, s35
    v_mfma_f32_16x16x32_bf16 a[28:31], v[180:183], v[240:243], a[28:31]
    v_perm_b32 v225, v151, v149, s35
    v_perm_b32 v226, v155, v153, s35
    ds_read_b128 v[180:183], v24 offset:17152
    s_waitcnt lgkmcnt(8)
    v_mfma_f32_16x16x32_bf16 a[32:35], v[184:187], v[228:231], a[32:35]
    v_perm_b32 v227, v159, v157, s35
    ds_read_b128 v[32:35], v28
    ds_read_b128 v[36:39], v28 offset:576
    ds_read_b128 v[40:43], v28 offset:1152
    ds_read_b128 v[44:47], v28 offset:1728
    v_mfma_f32_16x16x32_bf16 a[36:39], v[184:187], v[232:235], a[36:39]
    ds_read_b128 v[48:51], v28 offset:64
    ds_read_b128 v[52:55], v28 offset:640
    ds_read_b128 v[56:59], v28 offset:1216
    ds_read_b128 v[60:63], v28 offset:1792
    ds_read_b128 v[64:67], v28 offset:128
    ds_read_b128 v[68:71], v28 offset:704
    ds_read_b128 v[72:75], v28 offset:1280
    ds_read_b128 v[76:79], v28 offset:1856
    v_mfma_f32_16x16x32_bf16 a[40:43], v[184:187], v[236:239], a[40:43]
    s_waitcnt lgkmcnt(8)
    v_pk_add_f32 v[32:33], v[32:33], v[36:37]
    v_mfma_f32_16x16x32_bf16 a[44:47], v[184:187], v[240:243], a[44:47]
    v_pk_add_f32 v[40:41], v[40:41], v[44:45]
    v_pk_add_f32 v[34:35], v[34:35], v[38:39]
    ds_read_b128 v[184:187], v24 offset:33536
    v_mfma_f32_16x16x32_bf16 a[48:51], v[188:191], v[228:231], a[48:51]
    v_pk_add_f32 v[42:43], v[42:43], v[46:47]
    v_pk_add_f32 v[32:33], v[32:33], v[40:41]
    v_mfma_f32_16x16x32_bf16 a[52:55], v[188:191], v[232:235], a[52:55]
    v_pk_add_f32 v[34:35], v[34:35], v[42:43]
    v_rcp_f32 v96, v32
    v_mfma_f32_16x16x32_bf16 a[56:59], v[188:191], v[236:239], a[56:59]
    v_rcp_f32 v97, v33
    v_rcp_f32 v98, v34
    v_mfma_f32_16x16x32_bf16 a[60:63], v[188:191], v[240:243], a[60:63]
    v_rcp_f32 v99, v35
    ds_read_b128 v[80:83], v28 offset:192
    ds_read_b128 v[84:87], v28 offset:768
    ds_read_b128 v[88:91], v28 offset:1344
    ds_read_b128 v[92:95], v28 offset:1920
    ds_read_b128 v[188:191], v24 offset:49920
    v_mfma_f32_16x16x32_bf16 a[64:67], v[192:195], v[228:231], a[64:67]
    s_waitcnt lgkmcnt(10)
    v_pk_add_f32 v[48:49], v[48:49], v[52:53]
    v_mfma_f32_16x16x32_bf16 a[68:71], v[192:195], v[232:235], a[68:71]
    v_pk_add_f32 v[56:57], v[56:57], v[60:61]
    v_pk_add_f32 v[50:51], v[50:51], v[54:55]
    v_mfma_f32_16x16x32_bf16 a[72:75], v[192:195], v[236:239], a[72:75]
    v_pk_add_f32 v[58:59], v[58:59], v[62:63]
    v_pk_add_f32 v[48:49], v[48:49], v[56:57]
    v_mfma_f32_16x16x32_bf16 a[76:79], v[192:195], v[240:243], a[76:79]
    v_pk_add_f32 v[50:51], v[50:51], v[58:59]
    v_rcp_f32 v100, v48
    ds_read_b128 v[192:195], v25 offset:768
    v_mfma_f32_16x16x32_bf16 a[80:83], v[196:199], v[228:231], a[80:83]
    v_rcp_f32 v101, v49
    v_rcp_f32 v102, v50
    v_mfma_f32_16x16x32_bf16 a[84:87], v[196:199], v[232:235], a[84:87]
    v_rcp_f32 v103, v51
    ds_read_b128 v[32:35], v28 offset:256
    ds_read_b128 v[36:39], v28 offset:832
    ds_read_b128 v[40:43], v28 offset:1408
    ds_read_b128 v[44:47], v28 offset:1984
    v_mfma_f32_16x16x32_bf16 a[88:91], v[196:199], v[236:239], a[88:91]
    s_waitcnt lgkmcnt(11)
    v_pk_add_f32 v[64:65], v[64:65], v[68:69]
    v_mfma_f32_16x16x32_bf16 a[92:95], v[196:199], v[240:243], a[92:95]
    v_pk_add_f32 v[72:73], v[72:73], v[76:77]
    ds_read_b128 v[196:199], v25 offset:17152
    v_mfma_f32_16x16x32_bf16 a[96:99], v[200:203], v[228:231], a[96:99]
    v_mfma_f32_16x16x32_bf16 a[100:103], v[200:203], v[232:235], a[100:103]
    v_mfma_f32_16x16x32_bf16 a[104:107], v[200:203], v[236:239], a[104:107]
    v_mfma_f32_16x16x32_bf16 a[108:111], v[200:203], v[240:243], a[108:111]
    ds_read_b128 v[200:203], v25 offset:33536
    v_mfma_f32_16x16x32_bf16 a[112:115], v[204:207], v[228:231], a[112:115]
    v_mfma_f32_16x16x32_bf16 a[116:119], v[204:207], v[232:235], a[116:119]
    v_mfma_f32_16x16x32_bf16 a[120:123], v[204:207], v[236:239], a[120:123]
    v_mfma_f32_16x16x32_bf16 a[124:127], v[204:207], v[240:243], a[124:127]
    ds_read_b128 v[204:207], v25 offset:49920
    v_mfma_f32_16x16x32_bf16 a[128:131], v[208:211], v[228:231], a[128:131]
    v_mfma_f32_16x16x32_bf16 a[132:135], v[208:211], v[232:235], a[132:135]
    v_mfma_f32_16x16x32_bf16 a[136:139], v[208:211], v[236:239], a[136:139]
    v_mfma_f32_16x16x32_bf16 a[140:143], v[208:211], v[240:243], a[140:143]
    ds_read_b128 v[208:211], v26 offset:768
    v_xor_b32 v24, 192, v23
    v_add_u32 v25, 65536, v24
    v_add_u32 v26, 131072, v24
    v_mfma_f32_16x16x32_bf16 a[0:3], v[176:179], v[212:215], a[0:3]
    s_waitcnt vmcnt(0)
    v_perm_b32 v228, v162, v160, s34
    v_mfma_f32_16x16x32_bf16 a[4:7], v[176:179], v[216:219], a[4:7]
    v_perm_b32 v229, v166, v164, s34
    v_perm_b32 v230, v170, v168, s34
    v_mfma_f32_16x16x32_bf16 a[8:11], v[176:179], v[220:223], a[8:11]
    v_perm_b32 v231, v174, v172, s34
    v_perm_b32 v232, v162, v160, s35
    v_mfma_f32_16x16x32_bf16 a[12:15], v[176:179], v[224:227], a[12:15]
    v_perm_b32 v233, v166, v164, s35
    v_perm_b32 v234, v170, v168, s35
    ds_read_b128 v[176:179], v24 offset:768
    v_mfma_f32_16x16x32_bf16 a[16:19], v[180:183], v[212:215], a[16:19]
    v_perm_b32 v235, v174, v172, s35
    v_perm_b32 v236, v163, v161, s34
    v_mfma_f32_16x16x32_bf16 a[20:23], v[180:183], v[216:219], a[20:23]
    v_perm_b32 v237, v167, v165, s34
    v_perm_b32 v238, v171, v169, s34
    v_mfma_f32_16x16x32_bf16 a[24:27], v[180:183], v[220:223], a[24:27]
    v_perm_b32 v239, v175, v173, s34
    v_perm_b32 v240, v163, v161, s35
    v_mfma_f32_16x16x32_bf16 a[28:31], v[180:183], v[224:227], a[28:31]
    v_perm_b32 v241, v167, v165, s35
    v_perm_b32 v242, v171, v169, s35
    ds_read_b128 v[180:183], v24 offset:17152
    s_waitcnt lgkmcnt(15)
    v_mfma_f32_16x16x32_bf16 a[32:35], v[184:187], v[212:215], a[32:35]
    v_perm_b32 v243, v175, v173, s35
    v_pk_add_f32 v[66:67], v[66:67], v[70:71]
    v_mfma_f32_16x16x32_bf16 a[36:39], v[184:187], v[216:219], a[36:39]
    v_pk_add_f32 v[74:75], v[74:75], v[78:79]
    v_pk_add_f32 v[64:65], v[64:65], v[72:73]
    v_mfma_f32_16x16x32_bf16 a[40:43], v[184:187], v[220:223], a[40:43]
    v_pk_add_f32 v[66:67], v[66:67], v[74:75]
    v_rcp_f32 v104, v64
    v_mfma_f32_16x16x32_bf16 a[44:47], v[184:187], v[224:227], a[44:47]
    v_rcp_f32 v105, v65
    v_rcp_f32 v106, v66
    ds_read_b128 v[184:187], v24 offset:33536
    s_waitcnt lgkmcnt(12)
    v_mfma_f32_16x16x32_bf16 a[48:51], v[188:191], v[212:215], a[48:51]
    v_rcp_f32 v107, v67
    ds_read_b128 v[48:51], v28 offset:320
    ds_read_b128 v[52:55], v28 offset:896
    ds_read_b128 v[56:59], v28 offset:1472
    ds_read_b128 v[60:63], v28 offset:2048
    v_mfma_f32_16x16x32_bf16 a[52:55], v[188:191], v[216:219], a[52:55]
    v_pk_add_f32 v[80:81], v[80:81], v[84:85]
    v_mfma_f32_16x16x32_bf16 a[56:59], v[188:191], v[220:223], a[56:59]
    v_pk_add_f32 v[88:89], v[88:89], v[92:93]
    v_pk_add_f32 v[82:83], v[82:83], v[86:87]
    v_mfma_f32_16x16x32_bf16 a[60:63], v[188:191], v[224:227], a[60:63]
    v_pk_add_f32 v[90:91], v[90:91], v[94:95]
    v_pk_add_f32 v[80:81], v[80:81], v[88:89]
    ds_read_b128 v[188:191], v24 offset:49920
    s_waitcnt lgkmcnt(15)
    v_mfma_f32_16x16x32_bf16 a[64:67], v[192:195], v[212:215], a[64:67]
    v_pk_add_f32 v[82:83], v[82:83], v[90:91]
    v_rcp_f32 v108, v80
    v_mfma_f32_16x16x32_bf16 a[68:71], v[192:195], v[216:219], a[68:71]
    v_rcp_f32 v109, v81
    v_rcp_f32 v110, v82
    v_mfma_f32_16x16x32_bf16 a[72:75], v[192:195], v[220:223], a[72:75]
    v_rcp_f32 v111, v83
    ds_read_b128 v[64:67], v28 offset:384
    ds_read_b128 v[68:71], v28 offset:960
    ds_read_b128 v[72:75], v28 offset:1536
    ds_read_b128 v[76:79], v28 offset:2112
    v_mfma_f32_16x16x32_bf16 a[76:79], v[192:195], v[224:227], a[76:79]
    s_waitcnt lgkmcnt(15)
    v_pk_add_f32 v[32:33], v[32:33], v[36:37]
    ds_read_b128 v[192:195], v25 offset:768
    v_mfma_f32_16x16x32_bf16 a[80:83], v[196:199], v[212:215], a[80:83]
    v_pk_add_f32 v[40:41], v[40:41], v[44:45]
    v_pk_add_f32 v[34:35], v[34:35], v[38:39]
    v_mfma_f32_16x16x32_bf16 a[84:87], v[196:199], v[216:219], a[84:87]
    v_pk_add_f32 v[42:43], v[42:43], v[46:47]
    v_pk_add_f32 v[32:33], v[32:33], v[40:41]
    v_mfma_f32_16x16x32_bf16 a[88:91], v[196:199], v[220:223], a[88:91]
    v_pk_add_f32 v[34:35], v[34:35], v[42:43]
    v_rcp_f32 v112, v32
    v_mfma_f32_16x16x32_bf16 a[92:95], v[196:199], v[224:227], a[92:95]
    v_rcp_f32 v113, v33
    ds_read_b128 v[196:199], v25 offset:17152
    s_waitcnt lgkmcnt(15)
    v_mfma_f32_16x16x32_bf16 a[96:99], v[200:203], v[212:215], a[96:99]
    v_mfma_f32_16x16x32_bf16 a[100:103], v[200:203], v[216:219], a[100:103]
    v_mfma_f32_16x16x32_bf16 a[104:107], v[200:203], v[220:223], a[104:107]
    v_mfma_f32_16x16x32_bf16 a[108:111], v[200:203], v[224:227], a[108:111]
    ds_read_b128 v[200:203], v25 offset:33536
    v_mfma_f32_16x16x32_bf16 a[112:115], v[204:207], v[212:215], a[112:115]
    v_mfma_f32_16x16x32_bf16 a[116:119], v[204:207], v[216:219], a[116:119]
    v_mfma_f32_16x16x32_bf16 a[120:123], v[204:207], v[220:223], a[120:123]
    v_mfma_f32_16x16x32_bf16 a[124:127], v[204:207], v[224:227], a[124:127]
    ds_read_b128 v[204:207], v25 offset:49920
    s_waitcnt lgkmcnt(15)
    v_mfma_f32_16x16x32_bf16 a[128:131], v[208:211], v[212:215], a[128:131]
    v_mfma_f32_16x16x32_bf16 a[132:135], v[208:211], v[216:219], a[132:135]
    v_mfma_f32_16x16x32_bf16 a[136:139], v[208:211], v[220:223], a[136:139]
    v_mfma_f32_16x16x32_bf16 a[140:143], v[208:211], v[224:227], a[140:143]
    ds_read_b128 v[208:211], v26 offset:768
    v_mfma_f32_16x16x32_bf16 a[0:3], v[176:179], v[228:231], a[0:3]
    v_rcp_f32 v114, v34
    v_rcp_f32 v115, v35
    v_mfma_f32_16x16x32_bf16 a[4:7], v[176:179], v[232:235], a[4:7]
    ds_read_b128 v[80:83], v28 offset:448
    ds_read_b128 v[84:87], v28 offset:1024
    ds_read_b128 v[88:91], v28 offset:1600
    ds_read_b128 v[92:95], v28 offset:2176
    s_waitcnt lgkmcnt(14)
    v_mfma_f32_16x16x32_bf16 a[8:11], v[176:179], v[236:239], a[8:11]
    v_pk_add_f32 v[48:49], v[48:49], v[52:53]
    v_pk_add_f32 v[56:57], v[56:57], v[60:61]
    v_mfma_f32_16x16x32_bf16 a[12:15], v[176:179], v[240:243], a[12:15]
    v_pk_add_f32 v[50:51], v[50:51], v[54:55]
    v_pk_add_f32 v[58:59], v[58:59], v[62:63]
    v_mfma_f32_16x16x32_bf16 a[16:19], v[180:183], v[228:231], a[16:19]
    v_pk_add_f32 v[48:49], v[48:49], v[56:57]
    v_pk_add_f32 v[50:51], v[50:51], v[58:59]
    v_mfma_f32_16x16x32_bf16 a[20:23], v[180:183], v[232:235], a[20:23]
    v_rcp_f32 v116, v48
    v_rcp_f32 v117, v49
    v_mfma_f32_16x16x32_bf16 a[24:27], v[180:183], v[236:239], a[24:27]
    v_rcp_f32 v118, v50
    v_rcp_f32 v119, v51
    v_mfma_f32_16x16x32_bf16 a[28:31], v[180:183], v[240:243], a[28:31]
    ds_read_b128 v[32:35], v28 offset:512
    ds_read_b128 v[36:39], v28 offset:1088
    ds_read_b128 v[40:43], v28 offset:1664
    ds_read_b128 v[44:47], v28 offset:2240
    s_waitcnt lgkmcnt(13)
    v_mfma_f32_16x16x32_bf16 a[32:35], v[184:187], v[228:231], a[32:35]
    v_pk_add_f32 v[64:65], v[64:65], v[68:69]
    v_pk_add_f32 v[72:73], v[72:73], v[76:77]
    v_mfma_f32_16x16x32_bf16 a[36:39], v[184:187], v[232:235], a[36:39]
    v_pk_add_f32 v[66:67], v[66:67], v[70:71]
    v_pk_add_f32 v[74:75], v[74:75], v[78:79]
    v_mfma_f32_16x16x32_bf16 a[40:43], v[184:187], v[236:239], a[40:43]
    v_pk_add_f32 v[64:65], v[64:65], v[72:73]
    v_pk_add_f32 v[66:67], v[66:67], v[74:75]
    v_mfma_f32_16x16x32_bf16 a[44:47], v[184:187], v[240:243], a[44:47]
    v_rcp_f32 v120, v64
    v_rcp_f32 v121, v65
    v_mfma_f32_16x16x32_bf16 a[48:51], v[188:191], v[228:231], a[48:51]
    v_rcp_f32 v122, v66
    v_rcp_f32 v123, v67
    v_mfma_f32_16x16x32_bf16 a[52:55], v[188:191], v[232:235], a[52:55]
    s_waitcnt lgkmcnt(4)
    v_pk_add_f32 v[80:81], v[80:81], v[84:85]
    v_mfma_f32_16x16x32_bf16 a[56:59], v[188:191], v[236:239], a[56:59]
    v_pk_add_f32 v[88:89], v[88:89], v[92:93]
    v_pk_add_f32 v[82:83], v[82:83], v[86:87]
    v_mfma_f32_16x16x32_bf16 a[60:63], v[188:191], v[240:243], a[60:63]
    v_pk_add_f32 v[90:91], v[90:91], v[94:95]
    v_pk_add_f32 v[80:81], v[80:81], v[88:89]
    v_mfma_f32_16x16x32_bf16 a[64:67], v[192:195], v[228:231], a[64:67]
    v_pk_add_f32 v[82:83], v[82:83], v[90:91]
    v_rcp_f32 v124, v80
    v_mfma_f32_16x16x32_bf16 a[68:71], v[192:195], v[232:235], a[68:71]
    v_rcp_f32 v125, v81
    v_rcp_f32 v126, v82
    v_mfma_f32_16x16x32_bf16 a[72:75], v[192:195], v[236:239], a[72:75]
    v_rcp_f32 v127, v83
    s_waitcnt lgkmcnt(0)
    v_mfma_f32_16x16x32_bf16 a[76:79], v[192:195], v[240:243], a[76:79]
    v_pk_add_f32 v[32:33], v[32:33], v[36:37]
    v_pk_add_f32 v[40:41], v[40:41], v[44:45]
    v_mfma_f32_16x16x32_bf16 a[80:83], v[196:199], v[228:231], a[80:83]
    v_pk_add_f32 v[34:35], v[34:35], v[38:39]
    v_pk_add_f32 v[42:43], v[42:43], v[46:47]
    v_mfma_f32_16x16x32_bf16 a[84:87], v[196:199], v[232:235], a[84:87]
    v_pk_add_f32 v[32:33], v[32:33], v[40:41]
    v_pk_add_f32 v[34:35], v[34:35], v[42:43]
    v_mfma_f32_16x16x32_bf16 a[88:91], v[196:199], v[236:239], a[88:91]
    v_rcp_f32 v128, v32
    v_rcp_f32 v129, v33
    v_mfma_f32_16x16x32_bf16 a[92:95], v[196:199], v[240:243], a[92:95]
    v_rcp_f32 v130, v34
    v_rcp_f32 v131, v35
    v_mfma_f32_16x16x32_bf16 a[96:99], v[200:203], v[228:231], a[96:99]
    v_mfma_f32_16x16x32_bf16 a[100:103], v[200:203], v[232:235], a[100:103]
    v_mfma_f32_16x16x32_bf16 a[104:107], v[200:203], v[236:239], a[104:107]
    v_mfma_f32_16x16x32_bf16 a[108:111], v[200:203], v[240:243], a[108:111]
    v_mfma_f32_16x16x32_bf16 a[112:115], v[204:207], v[228:231], a[112:115]
    v_mfma_f32_16x16x32_bf16 a[116:119], v[204:207], v[232:235], a[116:119]
    v_mfma_f32_16x16x32_bf16 a[120:123], v[204:207], v[236:239], a[120:123]
    v_mfma_f32_16x16x32_bf16 a[124:127], v[204:207], v[240:243], a[124:127]
    v_mfma_f32_16x16x32_bf16 a[128:131], v[208:211], v[228:231], a[128:131]
    v_mfma_f32_16x16x32_bf16 a[132:135], v[208:211], v[232:235], a[132:135]
    v_mfma_f32_16x16x32_bf16 a[136:139], v[208:211], v[236:239], a[136:139]
    v_mfma_f32_16x16x32_bf16 a[140:143], v[208:211], v[240:243], a[140:143]
    v_lshrrev_b32 v29, 1, v2
    v_lshlrev_b32 v30, 2, v3
    v_xor_b32 v30, v30, v29
    v_lshlrev_b32 v30, 4, v30
    v_lshl_add_u32 v30, v29, 8, v30
    v_and_b32 v29, 1, v2
    v_lshl_add_u32 v30, v29, 3, v30
    v_lshl_add_u32 v30, v27, 11, v30
    v_add_u32 v10, 152064, v30
    v_xor_b32 v11, 16, v10
    v_xor_b32 v12, 32, v10
    v_xor_b32 v13, 48, v10
    v_xor_b32 v30, v2, v3
    v_lshlrev_b32 v30, 4, v30
    v_lshl_add_u32 v30, v3, 8, v30
    v_lshl_add_u32 v30, v27, 11, v30
    v_add_u32 v14, 152064, v30
    v_xor_b32 v15, 64, v14
    v_lshlrev_b32 v16, 4, v1
    v_accvgpr_read_b32 v176, a0
    v_accvgpr_read_b32 v177, a4
    v_accvgpr_read_b32 v178, a8
    v_accvgpr_read_b32 v179, a12
    v_mul_f32 v176, v176, v96
    v_mul_f32 v177, v177, v96
    v_mul_f32 v178, v178, v96
    v_mul_f32 v179, v179, v96
    v_cvt_pk_bf16_f32 v180, v176, v177
    v_cvt_pk_bf16_f32 v181, v178, v179
    ds_write_b64 v10, v[180:181]
    v_accvgpr_read_b32 v182, a1
    v_accvgpr_read_b32 v183, a5
    v_accvgpr_read_b32 v184, a9
    v_accvgpr_read_b32 v185, a13
    v_mul_f32 v182, v182, v97
    v_mul_f32 v183, v183, v97
    v_mul_f32 v184, v184, v97
    v_mul_f32 v185, v185, v97
    v_cvt_pk_bf16_f32 v186, v182, v183
    v_cvt_pk_bf16_f32 v187, v184, v185
    ds_write_b64 v11, v[186:187]
    v_accvgpr_read_b32 v188, a2
    v_accvgpr_read_b32 v189, a6
    v_accvgpr_read_b32 v190, a10
    v_accvgpr_read_b32 v191, a14
    v_mul_f32 v188, v188, v98
    v_mul_f32 v189, v189, v98
    v_mul_f32 v190, v190, v98
    v_mul_f32 v191, v191, v98
    v_cvt_pk_bf16_f32 v192, v188, v189
    v_cvt_pk_bf16_f32 v193, v190, v191
    ds_write_b64 v12, v[192:193]
    v_accvgpr_read_b32 v194, a3
    v_accvgpr_read_b32 v195, a7
    v_accvgpr_read_b32 v196, a11
    v_accvgpr_read_b32 v197, a15
    v_mul_f32 v194, v194, v99
    v_mul_f32 v195, v195, v99
    v_mul_f32 v196, v196, v99
    v_mul_f32 v197, v197, v99
    v_cvt_pk_bf16_f32 v198, v194, v195
    v_cvt_pk_bf16_f32 v199, v196, v197
    ds_write_b64 v13, v[198:199]
    ds_read_b128 v[212:215], v14
    ds_read_b128 v[216:219], v15 offset:1024
    v_accvgpr_read_b32 v176, a16
    v_accvgpr_read_b32 v177, a20
    v_accvgpr_read_b32 v178, a24
    v_accvgpr_read_b32 v179, a28
    v_mul_f32 v176, v176, v100
    v_mul_f32 v177, v177, v100
    v_mul_f32 v178, v178, v100
    v_mul_f32 v179, v179, v100
    v_cvt_pk_bf16_f32 v180, v176, v177
    v_cvt_pk_bf16_f32 v181, v178, v179
    ds_write_b64 v10, v[180:181]
    v_accvgpr_read_b32 v182, a17
    v_accvgpr_read_b32 v183, a21
    v_accvgpr_read_b32 v184, a25
    v_accvgpr_read_b32 v185, a29
    v_mul_f32 v182, v182, v101
    v_mul_f32 v183, v183, v101
    v_mul_f32 v184, v184, v101
    v_mul_f32 v185, v185, v101
    v_cvt_pk_bf16_f32 v186, v182, v183
    v_cvt_pk_bf16_f32 v187, v184, v185
    ds_write_b64 v11, v[186:187]
    v_accvgpr_read_b32 v188, a18
    v_accvgpr_read_b32 v189, a22
    v_accvgpr_read_b32 v190, a26
    v_accvgpr_read_b32 v191, a30
    v_mul_f32 v188, v188, v102
    v_mul_f32 v189, v189, v102
    v_mul_f32 v190, v190, v102
    v_mul_f32 v191, v191, v102
    v_cvt_pk_bf16_f32 v192, v188, v189
    v_cvt_pk_bf16_f32 v193, v190, v191
    ds_write_b64 v12, v[192:193]
    v_accvgpr_read_b32 v194, a19
    v_accvgpr_read_b32 v195, a23
    v_accvgpr_read_b32 v196, a27
    v_accvgpr_read_b32 v197, a31
    v_mul_f32 v194, v194, v103
    v_mul_f32 v195, v195, v103
    v_mul_f32 v196, v196, v103
    v_mul_f32 v197, v197, v103
    v_cvt_pk_bf16_f32 v198, v194, v195
    v_cvt_pk_bf16_f32 v199, v196, v197
    ds_write_b64 v13, v[198:199]
    ds_read_b128 v[220:223], v14
    ds_read_b128 v[224:227], v15 offset:1024
    s_waitcnt lgkmcnt(6)
    s_add_u32 s47, s32, 0
    buffer_store_dwordx4 v[212:215], v16, s[24:27], s47 offen
    buffer_store_dwordx4 v[216:219], v16, s[24:27], s47 offen offset:1024
    v_accvgpr_read_b32 v176, a32
    v_accvgpr_read_b32 v177, a36
    v_accvgpr_read_b32 v178, a40
    v_accvgpr_read_b32 v179, a44
    v_mul_f32 v176, v176, v104
    v_mul_f32 v177, v177, v104
    v_mul_f32 v178, v178, v104
    v_mul_f32 v179, v179, v104
    v_cvt_pk_bf16_f32 v180, v176, v177
    v_cvt_pk_bf16_f32 v181, v178, v179
    ds_write_b64 v10, v[180:181]
    v_accvgpr_read_b32 v182, a33
    v_accvgpr_read_b32 v183, a37
    v_accvgpr_read_b32 v184, a41
    v_accvgpr_read_b32 v185, a45
    v_mul_f32 v182, v182, v105
    v_mul_f32 v183, v183, v105
    v_mul_f32 v184, v184, v105
    v_mul_f32 v185, v185, v105
    v_cvt_pk_bf16_f32 v186, v182, v183
    v_cvt_pk_bf16_f32 v187, v184, v185
    ds_write_b64 v11, v[186:187]
    v_accvgpr_read_b32 v188, a34
    v_accvgpr_read_b32 v189, a38
    v_accvgpr_read_b32 v190, a42
    v_accvgpr_read_b32 v191, a46
    v_mul_f32 v188, v188, v106
    v_mul_f32 v189, v189, v106
    v_mul_f32 v190, v190, v106
    v_mul_f32 v191, v191, v106
    v_cvt_pk_bf16_f32 v192, v188, v189
    v_cvt_pk_bf16_f32 v193, v190, v191
    ds_write_b64 v12, v[192:193]
    v_accvgpr_read_b32 v194, a35
    v_accvgpr_read_b32 v195, a39
    v_accvgpr_read_b32 v196, a43
    v_accvgpr_read_b32 v197, a47
    v_mul_f32 v194, v194, v107
    v_mul_f32 v195, v195, v107
    v_mul_f32 v196, v196, v107
    v_mul_f32 v197, v197, v107
    v_cvt_pk_bf16_f32 v198, v194, v195
    v_cvt_pk_bf16_f32 v199, v196, v197
    ds_write_b64 v13, v[198:199]
    ds_read_b128 v[212:215], v14
    ds_read_b128 v[216:219], v15 offset:1024
    s_waitcnt lgkmcnt(6)
    s_add_u32 s58, s32, 131072
    buffer_store_dwordx4 v[220:223], v16, s[24:27], s58 offen
    buffer_store_dwordx4 v[224:227], v16, s[24:27], s58 offen offset:1024
    v_accvgpr_read_b32 v176, a48
    v_accvgpr_read_b32 v177, a52
    v_accvgpr_read_b32 v178, a56
    v_accvgpr_read_b32 v179, a60
    v_mul_f32 v176, v176, v108
    v_mul_f32 v177, v177, v108
    v_mul_f32 v178, v178, v108
    v_mul_f32 v179, v179, v108
    v_cvt_pk_bf16_f32 v180, v176, v177
    v_cvt_pk_bf16_f32 v181, v178, v179
    ds_write_b64 v10, v[180:181]
    v_accvgpr_read_b32 v182, a49
    v_accvgpr_read_b32 v183, a53
    v_accvgpr_read_b32 v184, a57
    v_accvgpr_read_b32 v185, a61
    v_mul_f32 v182, v182, v109
    v_mul_f32 v183, v183, v109
    v_mul_f32 v184, v184, v109
    v_mul_f32 v185, v185, v109
    v_cvt_pk_bf16_f32 v186, v182, v183
    v_cvt_pk_bf16_f32 v187, v184, v185
    ds_write_b64 v11, v[186:187]
    v_accvgpr_read_b32 v188, a50
    v_accvgpr_read_b32 v189, a54
    v_accvgpr_read_b32 v190, a58
    v_accvgpr_read_b32 v191, a62
    v_mul_f32 v188, v188, v110
    v_mul_f32 v189, v189, v110
    v_mul_f32 v190, v190, v110
    v_mul_f32 v191, v191, v110
    v_cvt_pk_bf16_f32 v192, v188, v189
    v_cvt_pk_bf16_f32 v193, v190, v191
    ds_write_b64 v12, v[192:193]
    v_accvgpr_read_b32 v194, a51
    v_accvgpr_read_b32 v195, a55
    v_accvgpr_read_b32 v196, a59
    v_accvgpr_read_b32 v197, a63
    v_mul_f32 v194, v194, v111
    v_mul_f32 v195, v195, v111
    v_mul_f32 v196, v196, v111
    v_mul_f32 v197, v197, v111
    v_cvt_pk_bf16_f32 v198, v194, v195
    v_cvt_pk_bf16_f32 v199, v196, v197
    ds_write_b64 v13, v[198:199]
    ds_read_b128 v[220:223], v14
    ds_read_b128 v[224:227], v15 offset:1024
    s_waitcnt lgkmcnt(6)
    s_add_u32 s59, s32, 262144
    buffer_store_dwordx4 v[212:215], v16, s[24:27], s59 offen
    buffer_store_dwordx4 v[216:219], v16, s[24:27], s59 offen offset:1024
    v_accvgpr_read_b32 v176, a64
    v_accvgpr_read_b32 v177, a68
    v_accvgpr_read_b32 v178, a72
    v_accvgpr_read_b32 v179, a76
    v_mul_f32 v176, v176, v112
    v_mul_f32 v177, v177, v112
    v_mul_f32 v178, v178, v112
    v_mul_f32 v179, v179, v112
    v_cvt_pk_bf16_f32 v180, v176, v177
    v_cvt_pk_bf16_f32 v181, v178, v179
    ds_write_b64 v10, v[180:181]
    v_accvgpr_read_b32 v182, a65
    v_accvgpr_read_b32 v183, a69
    v_accvgpr_read_b32 v184, a73
    v_accvgpr_read_b32 v185, a77
    v_mul_f32 v182, v182, v113
    v_mul_f32 v183, v183, v113
    v_mul_f32 v184, v184, v113
    v_mul_f32 v185, v185, v113
    v_cvt_pk_bf16_f32 v186, v182, v183
    v_cvt_pk_bf16_f32 v187, v184, v185
    ds_write_b64 v11, v[186:187]
    v_accvgpr_read_b32 v188, a66
    v_accvgpr_read_b32 v189, a70
    v_accvgpr_read_b32 v190, a74
    v_accvgpr_read_b32 v191, a78
    v_mul_f32 v188, v188, v114
    v_mul_f32 v189, v189, v114
    v_mul_f32 v190, v190, v114
    v_mul_f32 v191, v191, v114
    v_cvt_pk_bf16_f32 v192, v188, v189
    v_cvt_pk_bf16_f32 v193, v190, v191
    ds_write_b64 v12, v[192:193]
    v_accvgpr_read_b32 v194, a67
    v_accvgpr_read_b32 v195, a71
    v_accvgpr_read_b32 v196, a75
    v_accvgpr_read_b32 v197, a79
    v_mul_f32 v194, v194, v115
    v_mul_f32 v195, v195, v115
    v_mul_f32 v196, v196, v115
    v_mul_f32 v197, v197, v115
    v_cvt_pk_bf16_f32 v198, v194, v195
    v_cvt_pk_bf16_f32 v199, v196, v197
    ds_write_b64 v13, v[198:199]
    ds_read_b128 v[212:215], v14
    ds_read_b128 v[216:219], v15 offset:1024
    s_waitcnt lgkmcnt(6)
    s_add_u32 s46, s32, 393216
    buffer_store_dwordx4 v[220:223], v16, s[24:27], s46 offen
    buffer_store_dwordx4 v[224:227], v16, s[24:27], s46 offen offset:1024
    v_accvgpr_read_b32 v176, a80
    v_accvgpr_read_b32 v177, a84
    v_accvgpr_read_b32 v178, a88
    v_accvgpr_read_b32 v179, a92
    v_mul_f32 v176, v176, v116
    v_mul_f32 v177, v177, v116
    v_mul_f32 v178, v178, v116
    v_mul_f32 v179, v179, v116
    v_cvt_pk_bf16_f32 v180, v176, v177
    v_cvt_pk_bf16_f32 v181, v178, v179
    ds_write_b64 v10, v[180:181]
    v_accvgpr_read_b32 v182, a81
    v_accvgpr_read_b32 v183, a85
    v_accvgpr_read_b32 v184, a89
    v_accvgpr_read_b32 v185, a93
    v_mul_f32 v182, v182, v117
    v_mul_f32 v183, v183, v117
    v_mul_f32 v184, v184, v117
    v_mul_f32 v185, v185, v117
    v_cvt_pk_bf16_f32 v186, v182, v183
    v_cvt_pk_bf16_f32 v187, v184, v185
    ds_write_b64 v11, v[186:187]
    v_accvgpr_read_b32 v188, a82
    v_accvgpr_read_b32 v189, a86
    v_accvgpr_read_b32 v190, a90
    v_accvgpr_read_b32 v191, a94
    v_mul_f32 v188, v188, v118
    v_mul_f32 v189, v189, v118
    v_mul_f32 v190, v190, v118
    v_mul_f32 v191, v191, v118
    v_cvt_pk_bf16_f32 v192, v188, v189
    v_cvt_pk_bf16_f32 v193, v190, v191
    ds_write_b64 v12, v[192:193]
    v_accvgpr_read_b32 v194, a83
    v_accvgpr_read_b32 v195, a87
    v_accvgpr_read_b32 v196, a91
    v_accvgpr_read_b32 v197, a95
    v_mul_f32 v194, v194, v119
    v_mul_f32 v195, v195, v119
    v_mul_f32 v196, v196, v119
    v_mul_f32 v197, v197, v119
    v_cvt_pk_bf16_f32 v198, v194, v195
    v_cvt_pk_bf16_f32 v199, v196, v197
    ds_write_b64 v13, v[198:199]
    ds_read_b128 v[220:223], v14
    ds_read_b128 v[224:227], v15 offset:1024
    s_waitcnt lgkmcnt(6)
    s_add_u32 s47, s32, 524288
    buffer_store_dwordx4 v[212:215], v16, s[24:27], s47 offen
    buffer_store_dwordx4 v[216:219], v16, s[24:27], s47 offen offset:1024
    v_accvgpr_read_b32 v176, a96
    v_accvgpr_read_b32 v177, a100
    v_accvgpr_read_b32 v178, a104
    v_accvgpr_read_b32 v179, a108
    v_mul_f32 v176, v176, v120
    v_mul_f32 v177, v177, v120
    v_mul_f32 v178, v178, v120
    v_mul_f32 v179, v179, v120
    v_cvt_pk_bf16_f32 v180, v176, v177
    v_cvt_pk_bf16_f32 v181, v178, v179
    ds_write_b64 v10, v[180:181]
    v_accvgpr_read_b32 v182, a97
    v_accvgpr_read_b32 v183, a101
    v_accvgpr_read_b32 v184, a105
    v_accvgpr_read_b32 v185, a109
    v_mul_f32 v182, v182, v121
    v_mul_f32 v183, v183, v121
    v_mul_f32 v184, v184, v121
    v_mul_f32 v185, v185, v121
    v_cvt_pk_bf16_f32 v186, v182, v183
    v_cvt_pk_bf16_f32 v187, v184, v185
    ds_write_b64 v11, v[186:187]
    v_accvgpr_read_b32 v188, a98
    v_accvgpr_read_b32 v189, a102
    v_accvgpr_read_b32 v190, a106
    v_accvgpr_read_b32 v191, a110
    v_mul_f32 v188, v188, v122
    v_mul_f32 v189, v189, v122
    v_mul_f32 v190, v190, v122
    v_mul_f32 v191, v191, v122
    v_cvt_pk_bf16_f32 v192, v188, v189
    v_cvt_pk_bf16_f32 v193, v190, v191
    ds_write_b64 v12, v[192:193]
    v_accvgpr_read_b32 v194, a99
    v_accvgpr_read_b32 v195, a103
    v_accvgpr_read_b32 v196, a107
    v_accvgpr_read_b32 v197, a111
    v_mul_f32 v194, v194, v123
    v_mul_f32 v195, v195, v123
    v_mul_f32 v196, v196, v123
    v_mul_f32 v197, v197, v123
    v_cvt_pk_bf16_f32 v198, v194, v195
    v_cvt_pk_bf16_f32 v199, v196, v197
    ds_write_b64 v13, v[198:199]
    ds_read_b128 v[212:215], v14
    ds_read_b128 v[216:219], v15 offset:1024
    s_waitcnt lgkmcnt(6)
    s_add_u32 s58, s32, 655360
    buffer_store_dwordx4 v[220:223], v16, s[24:27], s58 offen
    buffer_store_dwordx4 v[224:227], v16, s[24:27], s58 offen offset:1024
    v_accvgpr_read_b32 v176, a112
    v_accvgpr_read_b32 v177, a116
    v_accvgpr_read_b32 v178, a120
    v_accvgpr_read_b32 v179, a124
    v_mul_f32 v176, v176, v124
    v_mul_f32 v177, v177, v124
    v_mul_f32 v178, v178, v124
    v_mul_f32 v179, v179, v124
    v_cvt_pk_bf16_f32 v180, v176, v177
    v_cvt_pk_bf16_f32 v181, v178, v179
    ds_write_b64 v10, v[180:181]
    v_accvgpr_read_b32 v182, a113
    v_accvgpr_read_b32 v183, a117
    v_accvgpr_read_b32 v184, a121
    v_accvgpr_read_b32 v185, a125
    v_mul_f32 v182, v182, v125
    v_mul_f32 v183, v183, v125
    v_mul_f32 v184, v184, v125
    v_mul_f32 v185, v185, v125
    v_cvt_pk_bf16_f32 v186, v182, v183
    v_cvt_pk_bf16_f32 v187, v184, v185
    ds_write_b64 v11, v[186:187]
    v_accvgpr_read_b32 v188, a114
    v_accvgpr_read_b32 v189, a118
    v_accvgpr_read_b32 v190, a122
    v_accvgpr_read_b32 v191, a126
    v_mul_f32 v188, v188, v126
    v_mul_f32 v189, v189, v126
    v_mul_f32 v190, v190, v126
    v_mul_f32 v191, v191, v126
    v_cvt_pk_bf16_f32 v192, v188, v189
    v_cvt_pk_bf16_f32 v193, v190, v191
    ds_write_b64 v12, v[192:193]
    v_accvgpr_read_b32 v194, a115
    v_accvgpr_read_b32 v195, a119
    v_accvgpr_read_b32 v196, a123
    v_accvgpr_read_b32 v197, a127
    v_mul_f32 v194, v194, v127
    v_mul_f32 v195, v195, v127
    v_mul_f32 v196, v196, v127
    v_mul_f32 v197, v197, v127
    v_cvt_pk_bf16_f32 v198, v194, v195
    v_cvt_pk_bf16_f32 v199, v196, v197
    ds_write_b64 v13, v[198:199]
    ds_read_b128 v[220:223], v14
    ds_read_b128 v[224:227], v15 offset:1024
    s_waitcnt lgkmcnt(6)
    s_add_u32 s59, s32, 786432
    buffer_store_dwordx4 v[212:215], v16, s[24:27], s59 offen
    buffer_store_dwordx4 v[216:219], v16, s[24:27], s59 offen offset:1024
    v_accvgpr_read_b32 v176, a128
    v_accvgpr_read_b32 v177, a132
    v_accvgpr_read_b32 v178, a136
    v_accvgpr_read_b32 v179, a140
    v_mul_f32 v176, v176, v128
    v_mul_f32 v177, v177, v128
    v_mul_f32 v178, v178, v128
    v_mul_f32 v179, v179, v128
    v_cvt_pk_bf16_f32 v180, v176, v177
    v_cvt_pk_bf16_f32 v181, v178, v179
    ds_write_b64 v10, v[180:181]
    v_accvgpr_read_b32 v182, a129
    v_accvgpr_read_b32 v183, a133
    v_accvgpr_read_b32 v184, a137
    v_accvgpr_read_b32 v185, a141
    v_mul_f32 v182, v182, v129
    v_mul_f32 v183, v183, v129
    v_mul_f32 v184, v184, v129
    v_mul_f32 v185, v185, v129
    v_cvt_pk_bf16_f32 v186, v182, v183
    v_cvt_pk_bf16_f32 v187, v184, v185
    ds_write_b64 v11, v[186:187]
    v_accvgpr_read_b32 v188, a130
    v_accvgpr_read_b32 v189, a134
    v_accvgpr_read_b32 v190, a138
    v_accvgpr_read_b32 v191, a142
    v_mul_f32 v188, v188, v130
    v_mul_f32 v189, v189, v130
    v_mul_f32 v190, v190, v130
    v_mul_f32 v191, v191, v130
    v_cvt_pk_bf16_f32 v192, v188, v189
    v_cvt_pk_bf16_f32 v193, v190, v191
    ds_write_b64 v12, v[192:193]
    v_accvgpr_read_b32 v194, a131
    v_accvgpr_read_b32 v195, a135
    v_accvgpr_read_b32 v196, a139
    v_accvgpr_read_b32 v197, a143
    v_mul_f32 v194, v194, v131
    v_mul_f32 v195, v195, v131
    v_mul_f32 v196, v196, v131
    v_mul_f32 v197, v197, v131
    v_cvt_pk_bf16_f32 v198, v194, v195
    v_cvt_pk_bf16_f32 v199, v196, v197
    ds_write_b64 v13, v[198:199]
    ds_read_b128 v[212:215], v14
    ds_read_b128 v[216:219], v15 offset:1024
    s_waitcnt lgkmcnt(6)
    s_add_u32 s46, s32, 917504
    buffer_store_dwordx4 v[220:223], v16, s[24:27], s46 offen
    buffer_store_dwordx4 v[224:227], v16, s[24:27], s46 offen offset:1024
    s_waitcnt lgkmcnt(0)
    s_add_u32 s47, s32, 1048576
    buffer_store_dwordx4 v[212:215], v16, s[24:27], s47 offen
    buffer_store_dwordx4 v[216:219], v16, s[24:27], s47 offen offset:1024
    s_waitcnt vmcnt(0)
L_attn_end:
    s_endpgm
.globl oproj_kernel
.p2align 8
.type oproj_kernel,@function
oproj_kernel:
    s_cmp_ge_u32 s2, 256
    s_cbranch_scc1 L_op_end
    s_and_b32 s3, s2, 7
    s_lshl_b32 s3, s3, 5
    s_lshr_b32 s4, s2, 3
    s_add_u32 s3, s3, s4
    s_cmp_ge_u32 s3, 252
    s_cbranch_scc1 L_op_end
    s_load_dwordx4 s[36:39], s[0:1], 32
    s_load_dwordx2 s[40:41], s[0:1], 56
    s_mul_i32 s4, s3, 9363
    s_lshr_b32 s4, s4, 16
    s_mul_i32 s5, s4, 7
    s_sub_u32 s5, s3, s5
    v_and_b32 v1, 63, v0
    v_and_b32 v2, 15, v0
    v_lshrrev_b32 v3, 4, v1
    v_lshrrev_b32 v4, 6, v0
    s_mov_b32 s34, 0x05040100
    s_mov_b32 s35, 0x07060302
    v_lshlrev_b32 v5, 4, v1
    v_lshl_add_u32 v5, v4, 14, v5
    s_mov_b32 s6, 458752
    v_mul_lo_u32 v6, s6, v4
    v_lshl_add_u32 v6, v1, 4, v6
    s_lshl_b32 s6, s4, 19
    s_add_u32 s64, s6, 0
    s_add_u32 s65, s6, 4096
    s_add_u32 s66, s6, 8192
    s_add_u32 s67, s6, 12288
    s_add_u32 s68, s6, 131072
    s_add_u32 s69, s6, 135168
    s_add_u32 s70, s6, 139264
    s_add_u32 s71, s6, 143360
    s_add_u32 s72, s6, 262144
    s_add_u32 s73, s6, 266240
    s_add_u32 s74, s6, 270336
    s_add_u32 s75, s6, 274432
    s_add_u32 s76, s6, 393216
    s_add_u32 s77, s6, 397312
    s_add_u32 s78, s6, 401408
    s_add_u32 s79, s6, 405504
    s_lshl_b32 s7, s5, 7
    s_lshl_b32 s33, s5, 12
    s_waitcnt lgkmcnt(0)
    s_mov_b32 s8, s40
    s_mov_b32 s9, s41
    s_mov_b32 s10, 18874368
    s_mov_b32 s11, 0x20000
    s_add_u32 s12, s40, 33554432
    s_addc_u32 s13, s41, 0
    s_mov_b32 s14, 3670016
    s_mov_b32 s15, 0x20000
    s_mov_b32 s16, s38
    s_mov_b32 s17, s39
    s_mov_b32 s18, 2064384
    s_mov_b32 s19, 0x20000
    s_add_u32 s53, s33, 0
    buffer_load_dwordx4 v[112:115], v6, s[12:15], s53 offen
    buffer_load_dwordx4 v[96:99], v5, s[8:11], s64 offen
    buffer_load_dwordx4 v[116:119], v6, s[12:15], s53 offen offset:1024
    buffer_load_dwordx4 v[100:103], v5, s[8:11], s68 offen
    buffer_load_dwordx4 v[120:123], v6, s[12:15], s53 offen offset:2048
    buffer_load_dwordx4 v[104:107], v5, s[8:11], s72 offen
    buffer_load_dwordx4 v[124:127], v6, s[12:15], s53 offen offset:3072
    buffer_load_dwordx4 v[108:111], v5, s[8:11], s76 offen
    s_add_u32 s54, s33, 28672
    buffer_load_dwordx4 v[144:147], v6, s[12:15], s54 offen
    buffer_load_dwordx4 v[128:131], v5, s[8:11], s64 offen offset:1024
    buffer_load_dwordx4 v[148:151], v6, s[12:15], s54 offen offset:1024
    buffer_load_dwordx4 v[132:135], v5, s[8:11], s68 offen offset:1024
    buffer_load_dwordx4 v[152:155], v6, s[12:15], s54 offen offset:2048
    buffer_load_dwordx4 v[136:139], v5, s[8:11], s72 offen offset:1024
    buffer_load_dwordx4 v[156:159], v6, s[12:15], s54 offen offset:3072
    buffer_load_dwordx4 v[140:143], v5, s[8:11], s76 offen offset:1024
    s_add_u32 s55, s33, 57344
    buffer_load_dwordx4 v[176:179], v6, s[12:15], s55 offen
    buffer_load_dwordx4 v[160:163], v5, s[8:11], s64 offen offset:2048
    buffer_load_dwordx4 v[180:183], v6, s[12:15], s55 offen offset:1024
    buffer_load_dwordx4 v[164:167], v5, s[8:11], s68 offen offset:2048
    buffer_load_dwordx4 v[184:187], v6, s[12:15], s55 offen offset:2048
    buffer_load_dwordx4 v[168:171], v5, s[8:11], s72 offen offset:2048
    buffer_load_dwordx4 v[188:191], v6, s[12:15], s55 offen offset:3072
    buffer_load_dwordx4 v[172:175], v5, s[8:11], s76 offen offset:2048
    s_add_u32 s52, s33, 86016
    buffer_load_dwordx4 v[208:211], v6, s[12:15], s52 offen
    buffer_load_dwordx4 v[192:195], v5, s[8:11], s64 offen offset:3072
    buffer_load_dwordx4 v[212:215], v6, s[12:15], s52 offen offset:1024
    buffer_load_dwordx4 v[196:199], v5, s[8:11], s68 offen offset:3072
    buffer_load_dwordx4 v[216:219], v6, s[12:15], s52 offen offset:2048
    buffer_load_dwordx4 v[200:203], v5, s[8:11], s72 offen offset:3072
    buffer_load_dwordx4 v[220:223], v6, s[12:15], s52 offen offset:3072
    buffer_load_dwordx4 v[204:207], v5, s[8:11], s76 offen offset:3072
    s_add_u32 s53, s33, 114688
    buffer_load_dwordx4 v[240:243], v6, s[12:15], s53 offen
    buffer_load_dwordx4 v[224:227], v5, s[8:11], s65 offen
    buffer_load_dwordx4 v[244:247], v6, s[12:15], s53 offen offset:1024
    buffer_load_dwordx4 v[228:231], v5, s[8:11], s69 offen
    buffer_load_dwordx4 v[248:251], v6, s[12:15], s53 offen offset:2048
    buffer_load_dwordx4 v[232:235], v5, s[8:11], s73 offen
    buffer_load_dwordx4 v[252:255], v6, s[12:15], s53 offen offset:3072
    buffer_load_dwordx4 v[236:239], v5, s[8:11], s77 offen
    s_waitcnt vmcnt(32)
    v_mfma_f32_16x16x32_bf16 v[32:35], v[96:99], v[112:115], 0
    v_mfma_f32_16x16x32_bf16 v[36:39], v[96:99], v[116:119], 0
    v_mfma_f32_16x16x32_bf16 v[40:43], v[96:99], v[120:123], 0
    v_mfma_f32_16x16x32_bf16 v[44:47], v[96:99], v[124:127], 0
    v_mfma_f32_16x16x32_bf16 v[48:51], v[100:103], v[112:115], 0
    v_mfma_f32_16x16x32_bf16 v[52:55], v[100:103], v[116:119], 0
    v_mfma_f32_16x16x32_bf16 v[56:59], v[100:103], v[120:123], 0
    v_mfma_f32_16x16x32_bf16 v[60:63], v[100:103], v[124:127], 0
    v_mfma_f32_16x16x32_bf16 v[64:67], v[104:107], v[112:115], 0
    v_mfma_f32_16x16x32_bf16 v[68:71], v[104:107], v[116:119], 0
    v_mfma_f32_16x16x32_bf16 v[72:75], v[104:107], v[120:123], 0
    v_mfma_f32_16x16x32_bf16 v[76:79], v[104:107], v[124:127], 0
    v_mfma_f32_16x16x32_bf16 v[80:83], v[108:111], v[112:115], 0
    v_mfma_f32_16x16x32_bf16 v[84:87], v[108:111], v[116:119], 0
    v_mfma_f32_16x16x32_bf16 v[88:91], v[108:111], v[120:123], 0
    v_mfma_f32_16x16x32_bf16 v[92:95], v[108:111], v[124:127], 0
    s_add_u32 s54, s33, 143360
    buffer_load_dwordx4 v[112:115], v6, s[12:15], s54 offen
    buffer_load_dwordx4 v[96:99], v5, s[8:11], s65 offen offset:1024
    buffer_load_dwordx4 v[116:119], v6, s[12:15], s54 offen offset:1024
    buffer_load_dwordx4 v[100:103], v5, s[8:11], s69 offen offset:1024
    buffer_load_dwordx4 v[120:123], v6, s[12:15], s54 offen offset:2048
    buffer_load_dwordx4 v[104:107], v5, s[8:11], s73 offen offset:1024
    buffer_load_dwordx4 v[124:127], v6, s[12:15], s54 offen offset:3072
    buffer_load_dwordx4 v[108:111], v5, s[8:11], s77 offen offset:1024
    s_waitcnt vmcnt(32)
    v_mfma_f32_16x16x32_bf16 v[32:35], v[128:131], v[144:147], v[32:35]
    v_mfma_f32_16x16x32_bf16 v[36:39], v[128:131], v[148:151], v[36:39]
    v_mfma_f32_16x16x32_bf16 v[40:43], v[128:131], v[152:155], v[40:43]
    v_mfma_f32_16x16x32_bf16 v[44:47], v[128:131], v[156:159], v[44:47]
    v_mfma_f32_16x16x32_bf16 v[48:51], v[132:135], v[144:147], v[48:51]
    v_mfma_f32_16x16x32_bf16 v[52:55], v[132:135], v[148:151], v[52:55]
    v_mfma_f32_16x16x32_bf16 v[56:59], v[132:135], v[152:155], v[56:59]
    v_mfma_f32_16x16x32_bf16 v[60:63], v[132:135], v[156:159], v[60:63]
    v_mfma_f32_16x16x32_bf16 v[64:67], v[136:139], v[144:147], v[64:67]
    v_mfma_f32_16x16x32_bf16 v[68:71], v[136:139], v[148:151], v[68:71]
    v_mfma_f32_16x16x32_bf16 v[72:75], v[136:139], v[152:155], v[72:75]
    v_mfma_f32_16x16x32_bf16 v[76:79], v[136:139], v[156:159], v[76:79]
    v_mfma_f32_16x16x32_bf16 v[80:83], v[140:143], v[144:147], v[80:83]
    v_mfma_f32_16x16x32_bf16 v[84:87], v[140:143], v[148:151], v[84:87]
    v_mfma_f32_16x16x32_bf16 v[88:91], v[140:143], v[152:155], v[88:91]
    v_mfma_f32_16x16x32_bf16 v[92:95], v[140:143], v[156:159], v[92:95]
    s_add_u32 s55, s33, 172032
    buffer_load_dwordx4 v[144:147], v6, s[12:15], s55 offen
    buffer_load_dwordx4 v[128:131], v5, s[8:11], s65 offen offset:2048
    buffer_load_dwordx4 v[148:151], v6, s[12:15], s55 offen offset:1024
    buffer_load_dwordx4 v[132:135], v5, s[8:11], s69 offen offset:2048
    buffer_load_dwordx4 v[152:155], v6, s[12:15], s55 offen offset:2048
    buffer_load_dwordx4 v[136:139], v5, s[8:11], s73 offen offset:2048
    buffer_load_dwordx4 v[156:159], v6, s[12:15], s55 offen offset:3072
    buffer_load_dwordx4 v[140:143], v5, s[8:11], s77 offen offset:2048
    s_waitcnt vmcnt(32)
    v_mfma_f32_16x16x32_bf16 v[32:35], v[160:163], v[176:179], v[32:35]
    v_mfma_f32_16x16x32_bf16 v[36:39], v[160:163], v[180:183], v[36:39]
    v_mfma_f32_16x16x32_bf16 v[40:43], v[160:163], v[184:187], v[40:43]
    v_mfma_f32_16x16x32_bf16 v[44:47], v[160:163], v[188:191], v[44:47]
    v_mfma_f32_16x16x32_bf16 v[48:51], v[164:167], v[176:179], v[48:51]
    v_mfma_f32_16x16x32_bf16 v[52:55], v[164:167], v[180:183], v[52:55]
    v_mfma_f32_16x16x32_bf16 v[56:59], v[164:167], v[184:187], v[56:59]
    v_mfma_f32_16x16x32_bf16 v[60:63], v[164:167], v[188:191], v[60:63]
    v_mfma_f32_16x16x32_bf16 v[64:67], v[168:171], v[176:179], v[64:67]
    v_mfma_f32_16x16x32_bf16 v[68:71], v[168:171], v[180:183], v[68:71]
    v_mfma_f32_16x16x32_bf16 v[72:75], v[168:171], v[184:187], v[72:75]
    v_mfma_f32_16x16x32_bf16 v[76:79], v[168:171], v[188:191], v[76:79]
    v_mfma_f32_16x16x32_bf16 v[80:83], v[172:175], v[176:179], v[80:83]
    v_mfma_f32_16x16x32_bf16 v[84:87], v[172:175], v[180:183], v[84:87]
    v_mfma_f32_16x16x32_bf16 v[88:91], v[172:175], v[184:187], v[88:91]
    v_mfma_f32_16x16x32_bf16 v[92:95], v[172:175], v[188:191], v[92:95]
    s_add_u32 s52, s33, 200704
    buffer_load_dwordx4 v[176:179], v6, s[12:15], s52 offen
    buffer_load_dwordx4 v[160:163], v5, s[8:11], s65 offen offset:3072
    buffer_load_dwordx4 v[180:183], v6, s[12:15], s52 offen offset:1024
    buffer_load_dwordx4 v[164:167], v5, s[8:11], s69 offen offset:3072
    buffer_load_dwordx4 v[184:187], v6, s[12:15], s52 offen offset:2048
    buffer_load_dwordx4 v[168:171], v5, s[8:11], s73 offen offset:3072
    buffer_load_dwordx4 v[188:191], v6, s[12:15], s52 offen offset:3072
    buffer_load_dwordx4 v[172:175], v5, s[8:11], s77 offen offset:3072
    s_waitcnt vmcnt(32)
    v_mfma_f32_16x16x32_bf16 v[32:35], v[192:195], v[208:211], v[32:35]
    v_mfma_f32_16x16x32_bf16 v[36:39], v[192:195], v[212:215], v[36:39]
    v_mfma_f32_16x16x32_bf16 v[40:43], v[192:195], v[216:219], v[40:43]
    v_mfma_f32_16x16x32_bf16 v[44:47], v[192:195], v[220:223], v[44:47]
    v_mfma_f32_16x16x32_bf16 v[48:51], v[196:199], v[208:211], v[48:51]
    v_mfma_f32_16x16x32_bf16 v[52:55], v[196:199], v[212:215], v[52:55]
    v_mfma_f32_16x16x32_bf16 v[56:59], v[196:199], v[216:219], v[56:59]
    v_mfma_f32_16x16x32_bf16 v[60:63], v[196:199], v[220:223], v[60:63]
    v_mfma_f32_16x16x32_bf16 v[64:67], v[200:203], v[208:211], v[64:67]
    v_mfma_f32_16x16x32_bf16 v[68:71], v[200:203], v[212:215], v[68:71]
    v_mfma_f32_16x16x32_bf16 v[72:75], v[200:203], v[216:219], v[72:75]
    v_mfma_f32_16x16x32_bf16 v[76:79], v[200:203], v[220:223], v[76:79]
    v_mfma_f32_16x16x32_bf16 v[80:83], v[204:207], v[208:211], v[80:83]
    v_mfma_f32_16x16x32_bf16 v[84:87], v[204:207], v[212:215], v[84:87]
    v_mfma_f32_16x16x32_bf16 v[88:91], v[204:207], v[216:219], v[88:91]
    v_mfma_f32_16x16x32_bf16 v[92:95], v[204:207], v[220:223], v[92:95]
    s_add_u32 s53, s33, 229376
    buffer_load_dwordx4 v[208:211], v6, s[12:15], s53 offen
    buffer_load_dwordx4 v[192:195], v5, s[8:11], s66 offen
    buffer_load_dwordx4 v[212:215], v6, s[12:15], s53 offen offset:1024
    buffer_load_dwordx4 v[196:199], v5, s[8:11], s70 offen
    buffer_load_dwordx4 v[216:219], v6, s[12:15], s53 offen offset:2048
    buffer_load_dwordx4 v[200:203], v5, s[8:11], s74 offen
    buffer_load_dwordx4 v[220:223], v6, s[12:15], s53 offen offset:3072
    buffer_load_dwordx4 v[204:207], v5, s[8:11], s78 offen
    s_waitcnt vmcnt(32)
    v_mfma_f32_16x16x32_bf16 v[32:35], v[224:227], v[240:243], v[32:35]
    v_mfma_f32_16x16x32_bf16 v[36:39], v[224:227], v[244:247], v[36:39]
    v_mfma_f32_16x16x32_bf16 v[40:43], v[224:227], v[248:251], v[40:43]
    v_mfma_f32_16x16x32_bf16 v[44:47], v[224:227], v[252:255], v[44:47]
    v_mfma_f32_16x16x32_bf16 v[48:51], v[228:231], v[240:243], v[48:51]
    v_mfma_f32_16x16x32_bf16 v[52:55], v[228:231], v[244:247], v[52:55]
    v_mfma_f32_16x16x32_bf16 v[56:59], v[228:231], v[248:251], v[56:59]
    v_mfma_f32_16x16x32_bf16 v[60:63], v[228:231], v[252:255], v[60:63]
    v_mfma_f32_16x16x32_bf16 v[64:67], v[232:235], v[240:243], v[64:67]
    v_mfma_f32_16x16x32_bf16 v[68:71], v[232:235], v[244:247], v[68:71]
    v_mfma_f32_16x16x32_bf16 v[72:75], v[232:235], v[248:251], v[72:75]
    v_mfma_f32_16x16x32_bf16 v[76:79], v[232:235], v[252:255], v[76:79]
    v_mfma_f32_16x16x32_bf16 v[80:83], v[236:239], v[240:243], v[80:83]
    v_mfma_f32_16x16x32_bf16 v[84:87], v[236:239], v[244:247], v[84:87]
    v_mfma_f32_16x16x32_bf16 v[88:91], v[236:239], v[248:251], v[88:91]
    v_mfma_f32_16x16x32_bf16 v[92:95], v[236:239], v[252:255], v[92:95]
    s_add_u32 s54, s33, 258048
    buffer_load_dwordx4 v[240:243], v6, s[12:15], s54 offen
    buffer_load_dwordx4 v[224:227], v5, s[8:11], s66 offen offset:1024
    buffer_load_dwordx4 v[244:247], v6, s[12:15], s54 offen offset:1024
    buffer_load_dwordx4 v[228:231], v5, s[8:11], s70 offen offset:1024
    buffer_load_dwordx4 v[248:251], v6, s[12:15], s54 offen offset:2048
    buffer_load_dwordx4 v[232:235], v5, s[8:11], s74 offen offset:1024
    buffer_load_dwordx4 v[252:255], v6, s[12:15], s54 offen offset:3072
    buffer_load_dwordx4 v[236:239], v5, s[8:11], s78 offen offset:1024
    s_waitcnt vmcnt(32)
    v_mfma_f32_16x16x32_bf16 v[32:35], v[96:99], v[112:115], v[32:35]
    v_mfma_f32_16x16x32_bf16 v[36:39], v[96:99], v[116:119], v[36:39]
    v_mfma_f32_16x16x32_bf16 v[40:43], v[96:99], v[120:123], v[40:43]
    v_mfma_f32_16x16x32_bf16 v[44:47], v[96:99], v[124:127], v[44:47]
    v_mfma_f32_16x16x32_bf16 v[48:51], v[100:103], v[112:115], v[48:51]
    v_mfma_f32_16x16x32_bf16 v[52:55], v[100:103], v[116:119], v[52:55]
    v_mfma_f32_16x16x32_bf16 v[56:59], v[100:103], v[120:123], v[56:59]
    v_mfma_f32_16x16x32_bf16 v[60:63], v[100:103], v[124:127], v[60:63]
    v_mfma_f32_16x16x32_bf16 v[64:67], v[104:107], v[112:115], v[64:67]
    v_mfma_f32_16x16x32_bf16 v[68:71], v[104:107], v[116:119], v[68:71]
    v_mfma_f32_16x16x32_bf16 v[72:75], v[104:107], v[120:123], v[72:75]
    v_mfma_f32_16x16x32_bf16 v[76:79], v[104:107], v[124:127], v[76:79]
    v_mfma_f32_16x16x32_bf16 v[80:83], v[108:111], v[112:115], v[80:83]
    v_mfma_f32_16x16x32_bf16 v[84:87], v[108:111], v[116:119], v[84:87]
    v_mfma_f32_16x16x32_bf16 v[88:91], v[108:111], v[120:123], v[88:91]
    v_mfma_f32_16x16x32_bf16 v[92:95], v[108:111], v[124:127], v[92:95]
    s_add_u32 s55, s33, 286720
    buffer_load_dwordx4 v[112:115], v6, s[12:15], s55 offen
    buffer_load_dwordx4 v[96:99], v5, s[8:11], s66 offen offset:2048
    buffer_load_dwordx4 v[116:119], v6, s[12:15], s55 offen offset:1024
    buffer_load_dwordx4 v[100:103], v5, s[8:11], s70 offen offset:2048
    buffer_load_dwordx4 v[120:123], v6, s[12:15], s55 offen offset:2048
    buffer_load_dwordx4 v[104:107], v5, s[8:11], s74 offen offset:2048
    buffer_load_dwordx4 v[124:127], v6, s[12:15], s55 offen offset:3072
    buffer_load_dwordx4 v[108:111], v5, s[8:11], s78 offen offset:2048
    s_waitcnt vmcnt(32)
    v_mfma_f32_16x16x32_bf16 v[32:35], v[128:131], v[144:147], v[32:35]
    v_mfma_f32_16x16x32_bf16 v[36:39], v[128:131], v[148:151], v[36:39]
    v_mfma_f32_16x16x32_bf16 v[40:43], v[128:131], v[152:155], v[40:43]
    v_mfma_f32_16x16x32_bf16 v[44:47], v[128:131], v[156:159], v[44:47]
    v_mfma_f32_16x16x32_bf16 v[48:51], v[132:135], v[144:147], v[48:51]
    v_mfma_f32_16x16x32_bf16 v[52:55], v[132:135], v[148:151], v[52:55]
    v_mfma_f32_16x16x32_bf16 v[56:59], v[132:135], v[152:155], v[56:59]
    v_mfma_f32_16x16x32_bf16 v[60:63], v[132:135], v[156:159], v[60:63]
    v_mfma_f32_16x16x32_bf16 v[64:67], v[136:139], v[144:147], v[64:67]
    v_mfma_f32_16x16x32_bf16 v[68:71], v[136:139], v[148:151], v[68:71]
    v_mfma_f32_16x16x32_bf16 v[72:75], v[136:139], v[152:155], v[72:75]
    v_mfma_f32_16x16x32_bf16 v[76:79], v[136:139], v[156:159], v[76:79]
    v_mfma_f32_16x16x32_bf16 v[80:83], v[140:143], v[144:147], v[80:83]
    v_mfma_f32_16x16x32_bf16 v[84:87], v[140:143], v[148:151], v[84:87]
    v_mfma_f32_16x16x32_bf16 v[88:91], v[140:143], v[152:155], v[88:91]
    v_mfma_f32_16x16x32_bf16 v[92:95], v[140:143], v[156:159], v[92:95]
    s_add_u32 s52, s33, 315392
    buffer_load_dwordx4 v[144:147], v6, s[12:15], s52 offen
    buffer_load_dwordx4 v[128:131], v5, s[8:11], s66 offen offset:3072
    buffer_load_dwordx4 v[148:151], v6, s[12:15], s52 offen offset:1024
    buffer_load_dwordx4 v[132:135], v5, s[8:11], s70 offen offset:3072
    buffer_load_dwordx4 v[152:155], v6, s[12:15], s52 offen offset:2048
    buffer_load_dwordx4 v[136:139], v5, s[8:11], s74 offen offset:3072
    buffer_load_dwordx4 v[156:159], v6, s[12:15], s52 offen offset:3072
    buffer_load_dwordx4 v[140:143], v5, s[8:11], s78 offen offset:3072
    s_waitcnt vmcnt(32)
    v_mfma_f32_16x16x32_bf16 v[32:35], v[160:163], v[176:179], v[32:35]
    v_mfma_f32_16x16x32_bf16 v[36:39], v[160:163], v[180:183], v[36:39]
    v_mfma_f32_16x16x32_bf16 v[40:43], v[160:163], v[184:187], v[40:43]
    v_mfma_f32_16x16x32_bf16 v[44:47], v[160:163], v[188:191], v[44:47]
    v_mfma_f32_16x16x32_bf16 v[48:51], v[164:167], v[176:179], v[48:51]
    v_mfma_f32_16x16x32_bf16 v[52:55], v[164:167], v[180:183], v[52:55]
    v_mfma_f32_16x16x32_bf16 v[56:59], v[164:167], v[184:187], v[56:59]
    v_mfma_f32_16x16x32_bf16 v[60:63], v[164:167], v[188:191], v[60:63]
    v_mfma_f32_16x16x32_bf16 v[64:67], v[168:171], v[176:179], v[64:67]
    v_mfma_f32_16x16x32_bf16 v[68:71], v[168:171], v[180:183], v[68:71]
    v_mfma_f32_16x16x32_bf16 v[72:75], v[168:171], v[184:187], v[72:75]
    v_mfma_f32_16x16x32_bf16 v[76:79], v[168:171], v[188:191], v[76:79]
    v_mfma_f32_16x16x32_bf16 v[80:83], v[172:175], v[176:179], v[80:83]
    v_mfma_f32_16x16x32_bf16 v[84:87], v[172:175], v[180:183], v[84:87]
    v_mfma_f32_16x16x32_bf16 v[88:91], v[172:175], v[184:187], v[88:91]
    v_mfma_f32_16x16x32_bf16 v[92:95], v[172:175], v[188:191], v[92:95]
    s_add_u32 s53, s33, 344064
    buffer_load_dwordx4 v[176:179], v6, s[12:15], s53 offen
    buffer_load_dwordx4 v[160:163], v5, s[8:11], s67 offen
    buffer_load_dwordx4 v[180:183], v6, s[12:15], s53 offen offset:1024
    buffer_load_dwordx4 v[164:167], v5, s[8:11], s71 offen
    buffer_load_dwordx4 v[184:187], v6, s[12:15], s53 offen offset:2048
    buffer_load_dwordx4 v[168:171], v5, s[8:11], s75 offen
    buffer_load_dwordx4 v[188:191], v6, s[12:15], s53 offen offset:3072
    buffer_load_dwordx4 v[172:175], v5, s[8:11], s79 offen
    s_waitcnt vmcnt(32)
    v_mfma_f32_16x16x32_bf16 v[32:35], v[192:195], v[208:211], v[32:35]
    v_mfma_f32_16x16x32_bf16 v[36:39], v[192:195], v[212:215], v[36:39]
    v_mfma_f32_16x16x32_bf16 v[40:43], v[192:195], v[216:219], v[40:43]
    v_mfma_f32_16x16x32_bf16 v[44:47], v[192:195], v[220:223], v[44:47]
    v_mfma_f32_16x16x32_bf16 v[48:51], v[196:199], v[208:211], v[48:51]
    v_mfma_f32_16x16x32_bf16 v[52:55], v[196:199], v[212:215], v[52:55]
    v_mfma_f32_16x16x32_bf16 v[56:59], v[196:199], v[216:219], v[56:59]
    v_mfma_f32_16x16x32_bf16 v[60:63], v[196:199], v[220:223], v[60:63]
    v_mfma_f32_16x16x32_bf16 v[64:67], v[200:203], v[208:211], v[64:67]
    v_mfma_f32_16x16x32_bf16 v[68:71], v[200:203], v[212:215], v[68:71]
    v_mfma_f32_16x16x32_bf16 v[72:75], v[200:203], v[216:219], v[72:75]
    v_mfma_f32_16x16x32_bf16 v[76:79], v[200:203], v[220:223], v[76:79]
    v_mfma_f32_16x16x32_bf16 v[80:83], v[204:207], v[208:211], v[80:83]
    v_mfma_f32_16x16x32_bf16 v[84:87], v[204:207], v[212:215], v[84:87]
    v_mfma_f32_16x16x32_bf16 v[88:91], v[204:207], v[216:219], v[88:91]
    v_mfma_f32_16x16x32_bf16 v[92:95], v[204:207], v[220:223], v[92:95]
    s_add_u32 s54, s33, 372736
    buffer_load_dwordx4 v[208:211], v6, s[12:15], s54 offen
    buffer_load_dwordx4 v[192:195], v5, s[8:11], s67 offen offset:1024
    buffer_load_dwordx4 v[212:215], v6, s[12:15], s54 offen offset:1024
    buffer_load_dwordx4 v[196:199], v5, s[8:11], s71 offen offset:1024
    buffer_load_dwordx4 v[216:219], v6, s[12:15], s54 offen offset:2048
    buffer_load_dwordx4 v[200:203], v5, s[8:11], s75 offen offset:1024
    buffer_load_dwordx4 v[220:223], v6, s[12:15], s54 offen offset:3072
    buffer_load_dwordx4 v[204:207], v5, s[8:11], s79 offen offset:1024
    s_waitcnt vmcnt(32)
    v_mfma_f32_16x16x32_bf16 v[32:35], v[224:227], v[240:243], v[32:35]
    v_mfma_f32_16x16x32_bf16 v[36:39], v[224:227], v[244:247], v[36:39]
    v_mfma_f32_16x16x32_bf16 v[40:43], v[224:227], v[248:251], v[40:43]
    v_mfma_f32_16x16x32_bf16 v[44:47], v[224:227], v[252:255], v[44:47]
    v_mfma_f32_16x16x32_bf16 v[48:51], v[228:231], v[240:243], v[48:51]
    v_mfma_f32_16x16x32_bf16 v[52:55], v[228:231], v[244:247], v[52:55]
    v_mfma_f32_16x16x32_bf16 v[56:59], v[228:231], v[248:251], v[56:59]
    v_mfma_f32_16x16x32_bf16 v[60:63], v[228:231], v[252:255], v[60:63]
    v_mfma_f32_16x16x32_bf16 v[64:67], v[232:235], v[240:243], v[64:67]
    v_mfma_f32_16x16x32_bf16 v[68:71], v[232:235], v[244:247], v[68:71]
    v_mfma_f32_16x16x32_bf16 v[72:75], v[232:235], v[248:251], v[72:75]
    v_mfma_f32_16x16x32_bf16 v[76:79], v[232:235], v[252:255], v[76:79]
    v_mfma_f32_16x16x32_bf16 v[80:83], v[236:239], v[240:243], v[80:83]
    v_mfma_f32_16x16x32_bf16 v[84:87], v[236:239], v[244:247], v[84:87]
    v_mfma_f32_16x16x32_bf16 v[88:91], v[236:239], v[248:251], v[88:91]
    v_mfma_f32_16x16x32_bf16 v[92:95], v[236:239], v[252:255], v[92:95]
    s_add_u32 s55, s33, 401408
    buffer_load_dwordx4 v[240:243], v6, s[12:15], s55 offen
    buffer_load_dwordx4 v[224:227], v5, s[8:11], s67 offen offset:2048
    buffer_load_dwordx4 v[244:247], v6, s[12:15], s55 offen offset:1024
    buffer_load_dwordx4 v[228:231], v5, s[8:11], s71 offen offset:2048
    buffer_load_dwordx4 v[248:251], v6, s[12:15], s55 offen offset:2048
    buffer_load_dwordx4 v[232:235], v5, s[8:11], s75 offen offset:2048
    buffer_load_dwordx4 v[252:255], v6, s[12:15], s55 offen offset:3072
    buffer_load_dwordx4 v[236:239], v5, s[8:11], s79 offen offset:2048
    s_waitcnt vmcnt(32)
    v_mfma_f32_16x16x32_bf16 v[32:35], v[96:99], v[112:115], v[32:35]
    v_mfma_f32_16x16x32_bf16 v[36:39], v[96:99], v[116:119], v[36:39]
    v_mfma_f32_16x16x32_bf16 v[40:43], v[96:99], v[120:123], v[40:43]
    v_mfma_f32_16x16x32_bf16 v[44:47], v[96:99], v[124:127], v[44:47]
    v_mfma_f32_16x16x32_bf16 v[48:51], v[100:103], v[112:115], v[48:51]
    v_mfma_f32_16x16x32_bf16 v[52:55], v[100:103], v[116:119], v[52:55]
    v_mfma_f32_16x16x32_bf16 v[56:59], v[100:103], v[120:123], v[56:59]
    v_mfma_f32_16x16x32_bf16 v[60:63], v[100:103], v[124:127], v[60:63]
    v_mfma_f32_16x16x32_bf16 v[64:67], v[104:107], v[112:115], v[64:67]
    v_mfma_f32_16x16x32_bf16 v[68:71], v[104:107], v[116:119], v[68:71]
    v_mfma_f32_16x16x32_bf16 v[72:75], v[104:107], v[120:123], v[72:75]
    v_mfma_f32_16x16x32_bf16 v[76:79], v[104:107], v[124:127], v[76:79]
    v_mfma_f32_16x16x32_bf16 v[80:83], v[108:111], v[112:115], v[80:83]
    v_mfma_f32_16x16x32_bf16 v[84:87], v[108:111], v[116:119], v[84:87]
    v_mfma_f32_16x16x32_bf16 v[88:91], v[108:111], v[120:123], v[88:91]
    v_mfma_f32_16x16x32_bf16 v[92:95], v[108:111], v[124:127], v[92:95]
    s_add_u32 s52, s33, 430080
    buffer_load_dwordx4 v[112:115], v6, s[12:15], s52 offen
    buffer_load_dwordx4 v[96:99], v5, s[8:11], s67 offen offset:3072
    buffer_load_dwordx4 v[116:119], v6, s[12:15], s52 offen offset:1024
    buffer_load_dwordx4 v[100:103], v5, s[8:11], s71 offen offset:3072
    buffer_load_dwordx4 v[120:123], v6, s[12:15], s52 offen offset:2048
    buffer_load_dwordx4 v[104:107], v5, s[8:11], s75 offen offset:3072
    buffer_load_dwordx4 v[124:127], v6, s[12:15], s52 offen offset:3072
    buffer_load_dwordx4 v[108:111], v5, s[8:11], s79 offen offset:3072
    s_waitcnt vmcnt(32)
    v_mfma_f32_16x16x32_bf16 v[32:35], v[128:131], v[144:147], v[32:35]
    v_mfma_f32_16x16x32_bf16 v[36:39], v[128:131], v[148:151], v[36:39]
    v_mfma_f32_16x16x32_bf16 v[40:43], v[128:131], v[152:155], v[40:43]
    v_mfma_f32_16x16x32_bf16 v[44:47], v[128:131], v[156:159], v[44:47]
    v_mfma_f32_16x16x32_bf16 v[48:51], v[132:135], v[144:147], v[48:51]
    v_mfma_f32_16x16x32_bf16 v[52:55], v[132:135], v[148:151], v[52:55]
    v_mfma_f32_16x16x32_bf16 v[56:59], v[132:135], v[152:155], v[56:59]
    v_mfma_f32_16x16x32_bf16 v[60:63], v[132:135], v[156:159], v[60:63]
    v_mfma_f32_16x16x32_bf16 v[64:67], v[136:139], v[144:147], v[64:67]
    v_mfma_f32_16x16x32_bf16 v[68:71], v[136:139], v[148:151], v[68:71]
    v_mfma_f32_16x16x32_bf16 v[72:75], v[136:139], v[152:155], v[72:75]
    v_mfma_f32_16x16x32_bf16 v[76:79], v[136:139], v[156:159], v[76:79]
    v_mfma_f32_16x16x32_bf16 v[80:83], v[140:143], v[144:147], v[80:83]
    v_mfma_f32_16x16x32_bf16 v[84:87], v[140:143], v[148:151], v[84:87]
    v_mfma_f32_16x16x32_bf16 v[88:91], v[140:143], v[152:155], v[88:91]
    v_mfma_f32_16x16x32_bf16 v[92:95], v[140:143], v[156:159], v[92:95]
    s_waitcnt vmcnt(24)
    v_mfma_f32_16x16x32_bf16 v[32:35], v[160:163], v[176:179], v[32:35]
    v_mfma_f32_16x16x32_bf16 v[36:39], v[160:163], v[180:183], v[36:39]
    v_mfma_f32_16x16x32_bf16 v[40:43], v[160:163], v[184:187], v[40:43]
    v_mfma_f32_16x16x32_bf16 v[44:47], v[160:163], v[188:191], v[44:47]
    v_mfma_f32_16x16x32_bf16 v[48:51], v[164:167], v[176:179], v[48:51]
    v_mfma_f32_16x16x32_bf16 v[52:55], v[164:167], v[180:183], v[52:55]
    v_mfma_f32_16x16x32_bf16 v[56:59], v[164:167], v[184:187], v[56:59]
    v_mfma_f32_16x16x32_bf16 v[60:63], v[164:167], v[188:191], v[60:63]
    v_mfma_f32_16x16x32_bf16 v[64:67], v[168:171], v[176:179], v[64:67]
    v_mfma_f32_16x16x32_bf16 v[68:71], v[168:171], v[180:183], v[68:71]
    v_mfma_f32_16x16x32_bf16 v[72:75], v[168:171], v[184:187], v[72:75]
    v_mfma_f32_16x16x32_bf16 v[76:79], v[168:171], v[188:191], v[76:79]
    v_mfma_f32_16x16x32_bf16 v[80:83], v[172:175], v[176:179], v[80:83]
    v_mfma_f32_16x16x32_bf16 v[84:87], v[172:175], v[180:183], v[84:87]
    v_mfma_f32_16x16x32_bf16 v[88:91], v[172:175], v[184:187], v[88:91]
    v_mfma_f32_16x16x32_bf16 v[92:95], v[172:175], v[188:191], v[92:95]
    s_waitcnt vmcnt(16)
    v_mfma_f32_16x16x32_bf16 v[32:35], v[192:195], v[208:211], v[32:35]
    v_mfma_f32_16x16x32_bf16 v[36:39], v[192:195], v[212:215], v[36:39]
    v_mfma_f32_16x16x32_bf16 v[40:43], v[192:195], v[216:219], v[40:43]
    v_mfma_f32_16x16x32_bf16 v[44:47], v[192:195], v[220:223], v[44:47]
    v_mfma_f32_16x16x32_bf16 v[48:51], v[196:199], v[208:211], v[48:51]
    v_mfma_f32_16x16x32_bf16 v[52:55], v[196:199], v[212:215], v[52:55]
    v_mfma_f32_16x16x32_bf16 v[56:59], v[196:199], v[216:219], v[56:59]
    v_mfma_f32_16x16x32_bf16 v[60:63], v[196:199], v[220:223], v[60:63]
    v_mfma_f32_16x16x32_bf16 v[64:67], v[200:203], v[208:211], v[64:67]
    v_mfma_f32_16x16x32_bf16 v[68:71], v[200:203], v[212:215], v[68:71]
    v_mfma_f32_16x16x32_bf16 v[72:75], v[200:203], v[216:219], v[72:75]
    v_mfma_f32_16x16x32_bf16 v[76:79], v[200:203], v[220:223], v[76:79]
    v_mfma_f32_16x16x32_bf16 v[80:83], v[204:207], v[208:211], v[80:83]
    v_mfma_f32_16x16x32_bf16 v[84:87], v[204:207], v[212:215], v[84:87]
    v_mfma_f32_16x16x32_bf16 v[88:91], v[204:207], v[216:219], v[88:91]
    v_mfma_f32_16x16x32_bf16 v[92:95], v[204:207], v[220:223], v[92:95]
    s_waitcnt vmcnt(8)
    v_mfma_f32_16x16x32_bf16 v[32:35], v[224:227], v[240:243], v[32:35]
    v_mfma_f32_16x16x32_bf16 v[36:39], v[224:227], v[244:247], v[36:39]
    v_mfma_f32_16x16x32_bf16 v[40:43], v[224:227], v[248:251], v[40:43]
    v_mfma_f32_16x16x32_bf16 v[44:47], v[224:227], v[252:255], v[44:47]
    v_mfma_f32_16x16x32_bf16 v[48:51], v[228:231], v[240:243], v[48:51]
    v_mfma_f32_16x16x32_bf16 v[52:55], v[228:231], v[244:247], v[52:55]
    v_mfma_f32_16x16x32_bf16 v[56:59], v[228:231], v[248:251], v[56:59]
    v_mfma_f32_16x16x32_bf16 v[60:63], v[228:231], v[252:255], v[60:63]
    v_mfma_f32_16x16x32_bf16 v[64:67], v[232:235], v[240:243], v[64:67]
    v_mfma_f32_16x16x32_bf16 v[68:71], v[232:235], v[244:247], v[68:71]
    v_mfma_f32_16x16x32_bf16 v[72:75], v[232:235], v[248:251], v[72:75]
    v_mfma_f32_16x16x32_bf16 v[76:79], v[232:235], v[252:255], v[76:79]
    v_mfma_f32_16x16x32_bf16 v[80:83], v[236:239], v[240:243], v[80:83]
    v_mfma_f32_16x16x32_bf16 v[84:87], v[236:239], v[244:247], v[84:87]
    v_mfma_f32_16x16x32_bf16 v[88:91], v[236:239], v[248:251], v[88:91]
    v_mfma_f32_16x16x32_bf16 v[92:95], v[236:239], v[252:255], v[92:95]
    s_waitcnt vmcnt(0)
    v_mfma_f32_16x16x32_bf16 v[32:35], v[96:99], v[112:115], v[32:35]
    v_mfma_f32_16x16x32_bf16 v[36:39], v[96:99], v[116:119], v[36:39]
    v_mfma_f32_16x16x32_bf16 v[40:43], v[96:99], v[120:123], v[40:43]
    v_mfma_f32_16x16x32_bf16 v[44:47], v[96:99], v[124:127], v[44:47]
    v_mfma_f32_16x16x32_bf16 v[48:51], v[100:103], v[112:115], v[48:51]
    v_mfma_f32_16x16x32_bf16 v[52:55], v[100:103], v[116:119], v[52:55]
    v_mfma_f32_16x16x32_bf16 v[56:59], v[100:103], v[120:123], v[56:59]
    v_mfma_f32_16x16x32_bf16 v[60:63], v[100:103], v[124:127], v[60:63]
    v_mfma_f32_16x16x32_bf16 v[64:67], v[104:107], v[112:115], v[64:67]
    v_mfma_f32_16x16x32_bf16 v[68:71], v[104:107], v[116:119], v[68:71]
    v_mfma_f32_16x16x32_bf16 v[72:75], v[104:107], v[120:123], v[72:75]
    v_mfma_f32_16x16x32_bf16 v[76:79], v[104:107], v[124:127], v[76:79]
    v_mfma_f32_16x16x32_bf16 v[80:83], v[108:111], v[112:115], v[80:83]
    v_mfma_f32_16x16x32_bf16 v[84:87], v[108:111], v[116:119], v[84:87]
    v_mfma_f32_16x16x32_bf16 v[88:91], v[108:111], v[120:123], v[88:91]
    v_mfma_f32_16x16x32_bf16 v[92:95], v[108:111], v[124:127], v[92:95]
    v_lshlrev_b32 v8, 4, v1
    v_lshl_add_u32 v8, v4, 14, v8
    ds_write_b128 v8, v[32:35]
    ds_write_b128 v8, v[36:39] offset:1024
    ds_write_b128 v8, v[40:43] offset:2048
    ds_write_b128 v8, v[44:47] offset:3072
    ds_write_b128 v8, v[48:51] offset:4096
    ds_write_b128 v8, v[52:55] offset:5120
    ds_write_b128 v8, v[56:59] offset:6144
    ds_write_b128 v8, v[60:63] offset:7168
    ds_write_b128 v8, v[64:67] offset:8192
    ds_write_b128 v8, v[68:71] offset:9216
    ds_write_b128 v8, v[72:75] offset:10240
    ds_write_b128 v8, v[76:79] offset:11264
    ds_write_b128 v8, v[80:83] offset:12288
    ds_write_b128 v8, v[84:87] offset:13312
    ds_write_b128 v8, v[88:91] offset:14336
    ds_write_b128 v8, v[92:95] offset:15360
    s_waitcnt lgkmcnt(0)
    s_barrier
    v_lshrrev_b32 v9, 1, v4
    v_and_b32 v10, 1, v4
    v_lshlrev_b32 v8, 4, v1
    v_lshl_add_u32 v8, v9, 12, v8
    v_lshl_add_u32 v8, v10, 3, v8
    v_add_u32 v11, 65536, v8
    ds_read_b64 v[96:97], v8
    ds_read_b64 v[98:99], v8 offset:16384
    ds_read_b64 v[100:101], v8 offset:32768
    ds_read_b64 v[102:103], v8 offset:49152
    ds_read_b64 v[104:105], v11
    ds_read_b64 v[106:107], v11 offset:16384
    ds_read_b64 v[108:109], v11 offset:32768
    ds_read_b64 v[110:111], v11 offset:49152
    ds_read_b64 v[112:113], v8 offset:1024
    ds_read_b64 v[114:115], v8 offset:17408
    ds_read_b64 v[116:117], v8 offset:33792
    ds_read_b64 v[118:119], v8 offset:50176
    ds_read_b64 v[120:121], v11 offset:1024
    ds_read_b64 v[122:123], v11 offset:17408
    ds_read_b64 v[124:125], v11 offset:33792
    ds_read_b64 v[126:127], v11 offset:50176
    ds_read_b64 v[128:129], v8 offset:2048
    ds_read_b64 v[130:131], v8 offset:18432
    ds_read_b64 v[132:133], v8 offset:34816
    ds_read_b64 v[134:135], v8 offset:51200
    ds_read_b64 v[136:137], v11 offset:2048
    ds_read_b64 v[138:139], v11 offset:18432
    ds_read_b64 v[140:141], v11 offset:34816
    ds_read_b64 v[142:143], v11 offset:51200
    ds_read_b64 v[144:145], v8 offset:3072
    ds_read_b64 v[146:147], v8 offset:19456
    ds_read_b64 v[148:149], v8 offset:35840
    ds_read_b64 v[150:151], v8 offset:52224
    ds_read_b64 v[152:153], v11 offset:3072
    ds_read_b64 v[154:155], v11 offset:19456
    ds_read_b64 v[156:157], v11 offset:35840
    ds_read_b64 v[158:159], v11 offset:52224
    s_waitcnt lgkmcnt(0)
    v_add_f32 v96, v96, v98
    v_add_f32 v100, v100, v102
    v_add_f32 v104, v104, v106
    v_add_f32 v108, v108, v110
    v_add_f32 v97, v97, v99
    v_add_f32 v101, v101, v103
    v_add_f32 v105, v105, v107
    v_add_f32 v109, v109, v111
    v_add_f32 v96, v96, v100
    v_add_f32 v104, v104, v108
    v_add_f32 v97, v97, v101
    v_add_f32 v105, v105, v109
    v_add_f32 v96, v96, v104
    v_add_f32 v97, v97, v105
    v_add_f32 v112, v112, v114
    v_add_f32 v116, v116, v118
    v_add_f32 v120, v120, v122
    v_add_f32 v124, v124, v126
    v_add_f32 v113, v113, v115
    v_add_f32 v117, v117, v119
    v_add_f32 v121, v121, v123
    v_add_f32 v125, v125, v127
    v_add_f32 v112, v112, v116
    v_add_f32 v120, v120, v124
    v_add_f32 v113, v113, v117
    v_add_f32 v121, v121, v125
    v_add_f32 v112, v112, v120
    v_add_f32 v113, v113, v121
    v_add_f32 v128, v128, v130
    v_add_f32 v132, v132, v134
    v_add_f32 v136, v136, v138
    v_add_f32 v140, v140, v142
    v_add_f32 v129, v129, v131
    v_add_f32 v133, v133, v135
    v_add_f32 v137, v137, v139
    v_add_f32 v141, v141, v143
    v_add_f32 v128, v128, v132
    v_add_f32 v136, v136, v140
    v_add_f32 v129, v129, v133
    v_add_f32 v137, v137, v141
    v_add_f32 v128, v128, v136
    v_add_f32 v129, v129, v137
    v_add_f32 v144, v144, v146
    v_add_f32 v148, v148, v150
    v_add_f32 v152, v152, v154
    v_add_f32 v156, v156, v158
    v_add_f32 v145, v145, v147
    v_add_f32 v149, v149, v151
    v_add_f32 v153, v153, v155
    v_add_f32 v157, v157, v159
    v_add_f32 v144, v144, v148
    v_add_f32 v152, v152, v156
    v_add_f32 v145, v145, v149
    v_add_f32 v153, v153, v157
    v_add_f32 v144, v144, v152
    v_add_f32 v145, v145, v153
    v_lshlrev_b32 v12, 4, v9
    v_lshl_add_u32 v12, v3, 2, v12
    v_lshl_add_u32 v12, v10, 1, v12
    v_mul_u32_u24 v12, 896, v12
    v_lshl_add_u32 v12, v2, 3, v12
    s_mul_i32 s6, s4, 57344
    s_add_u32 s6, s6, s7
    v_cvt_pk_bf16_f32 v16, v96, v112
    v_cvt_pk_bf16_f32 v17, v128, v144
    buffer_store_dwordx2 v[16:17], v12, s[16:19], s6 offen
    v_cvt_pk_bf16_f32 v18, v97, v113
    v_cvt_pk_bf16_f32 v19, v129, v145
    buffer_store_dwordx2 v[18:19], v12, s[16:19], s6 offen offset:896
    s_waitcnt vmcnt(0)
L_op_end:
    s_endpgm
.section .rodata,"a"
.p2align 6
.amdhsa_kernel standalone__mha_block_cached__near_ridge_kernel
  .amdhsa_next_free_vgpr 512
  .amdhsa_next_free_sgpr 96
  .amdhsa_accum_offset 256
  .amdhsa_group_segment_fixed_size 0
  .amdhsa_kernarg_size 64
  .amdhsa_user_sgpr_count 2
  .amdhsa_user_sgpr_kernarg_segment_ptr 1
  .amdhsa_system_sgpr_workgroup_id_x 1
.end_amdhsa_kernel
.p2align 6
.amdhsa_kernel oproj_kernel
  .amdhsa_next_free_vgpr 256
  .amdhsa_next_free_sgpr 96
  .amdhsa_accum_offset 256
  .amdhsa_group_segment_fixed_size 0
  .amdhsa_kernarg_size 64
  .amdhsa_user_sgpr_count 2
  .amdhsa_user_sgpr_kernarg_segment_ptr 1
  .amdhsa_system_sgpr_workgroup_id_x 1
.end_amdhsa_kernel
```
